```python
import torch

def _softmax(x, axis=-1):
    return torch.softmax(x, dim=axis)

def _gelu(x):
    return torch.nn.functional.gelu(x, approximate='tanh')

def _silu(x):
    return torch.nn.functional.silu(x)

def _sigmoid(x):
    return torch.sigmoid(x)

def _layernorm(x, axis=-1, eps=1e-05):
    m = x.mean(dim=axis, keepdim=True)
    v = x.var(dim=axis, keepdim=True, unbiased=False)
    return (x - m) / torch.sqrt(v + eps)

def _scatter_add(tgt, idx, src, axis=0):
    return tgt.clone().index_add_(axis, idx, src)

def _segment_sum(src, seg, n):
    out = torch.zeros((n,) + src.shape[1:], dtype=src.dtype)
    return out.index_add_(0, seg, src)

def _pad(x, pw):
    flat = tuple((v for pair in reversed(pw) for v in pair))
    return torch.nn.functional.pad(x, flat)
kernel_name = 'standalone__conformer_family_zipformer__speech'

def setup_inputs():

    _w = lambda a: (lambda t: t.to(torch.bfloat16) if t.is_floating_point() else t)(torch.as_tensor(a))
    B, T, D, K, H = (2, 4000, 256, 15, 4)
    sc = 0.1
    return {'x': _w((lambda *s: torch.randn(*s, dtype=torch.bfloat16) * 0.8)(B, T, D)), 'w_ff1a': _w((lambda *s: torch.randn(*s, dtype=torch.bfloat16) * 0.8)(D, 4 * D) * sc), 'w_ff1b': _w((lambda *s: torch.randn(*s, dtype=torch.bfloat16) * 0.8)(4 * D, D) * sc), 'w_qkv': _w((lambda *s: torch.randn(*s, dtype=torch.bfloat16) * 0.8)(D, 3 * D) * sc), 'w_o': _w((lambda *s: torch.randn(*s, dtype=torch.bfloat16) * 1.6)(D, D) * sc), 'w_pw1': _w((lambda *s: torch.randn(*s, dtype=torch.bfloat16) * 1.6)(D, 2 * D) * sc), 'dw': _w((lambda *s: torch.randn(*s, dtype=torch.bfloat16) * 0.4)(K, D)), 'w_pw2': _w((lambda *s: torch.randn(*s, dtype=torch.bfloat16) * 0.4)(D, D) * sc), 'w_ff2a': _w((lambda *s: torch.randn(*s, dtype=torch.bfloat16) * 0.8)(D, 4 * D) * sc), 'w_ff2b': _w((lambda *s: torch.randn(*s, dtype=torch.bfloat16) * 0.8)(4 * D, D) * sc)}

def reference(x, w_ff1a, w_ff1b, w_qkv, w_o, w_pw1, dw, w_pw2, w_ff2a, w_ff2b):
    B, T, D = x.shape
    K = dw.shape[0]
    H = 4
    Dh = D // H
    h = _layernorm(x, axis=-1)
    h = _silu(h @ w_ff1a) @ w_ff1b
    x = x + 0.5 * h
    h = _layernorm(x, axis=-1)
    qkv = h @ w_qkv
    q = (lambda x, *d: x.permute(*d))(qkv[..., :D].reshape(B, T, H, Dh), 0, 2, 1, 3)
    k = (lambda x, *d: x.permute(*d))(qkv[..., D:2 * D].reshape(B, T, H, Dh), 0, 2, 1, 3)
    v = (lambda x, *d: x.permute(*d))(qkv[..., 2 * D:].reshape(B, T, H, Dh), 0, 2, 1, 3)
    scale = Dh ** (-0.5)
    scores = torch.einsum('bhqd,bhkd->bhqk', q, k) * scale
    p = _softmax(scores, axis=-1)
    att = torch.einsum('bhqk,bhkd->bhqd', p, v)
    att = (lambda x, *d: x.permute(*d))(att, 0, 2, 1, 3).reshape(B, T, D)
    x = x + att @ w_o
    h = _layernorm(x, axis=-1)
    h = h @ w_pw1
    a, b = (h[..., :D].clone(), h[..., D:].clone())
    h = a * _sigmoid(b)
    pad = K // 2
    hp = _pad(h, ((0, 0), (pad, pad), (0, 0)))
    c = torch.zeros_like(h)
    for i in range(K):
        c = c + hp[:, i:i + T, :] * dw[i][None, None, :]
    x = x + _silu(c) @ w_pw2
    h = _layernorm(x, axis=-1)
    h = _silu(h @ w_ff2a) @ w_ff2b
    x = x + 0.5 * h
    return _layernorm(x, axis=-1)
```

```asm
; @launch kernel=zf_k1_kernel grid=(256,1,1) block=(256,1,1) lds=149504
.amdgcn_target "amdgcn-amd-amdhsa--gfx950"
.text
.globl zf_k1_kernel
.p2align 8
.type zf_k1_kernel,@function
zf_k1_kernel:
    s_cmp_ge_u32 s2, 256
    s_cbranch_scc1 K1_END
    s_mov_b32 s62, 0
    s_mov_b32 s63, s2
K1_RS:
    s_load_dwordx8 s[8:15], s[0:1], 0
    s_load_dwordx2 s[16:17], s[0:1], 96
    s_load_dwordx2 s[18:19], s[0:1], 88
    v_lshrrev_b32 v1, 6, v0
    v_and_b32 v2, 63, v0
    v_readfirstlane_b32 s3, v1
    v_and_b32 v3, 15, v2
    v_lshrrev_b32 v4, 4, v2
    v_lshlrev_b32 v7, 4, v2
    s_cmp_ge_u32 s63, 248
    s_cselect_b32 s4, 3, 0
    s_sub_u32 s61, s63, s4
    s_xor_b32 s7, s63, 8
    s_cmp_ge_u32 s7, 248
    s_cselect_b32 s4, 3, 0
    s_sub_u32 s65, s7, s4
    s_lshl_b32 s7, s65, 14
    s_lshl_b32 s4, s61, 14
    v_lshl_add_u32 v8, v1, 3, v4
    v_lshlrev_b32 v9, 4, v8
    v_lshlrev_b32 v8, 9, v8
    v_lshl_add_u32 v8, v3, 4, v8
    v_add_u32 v12, s7, v8
    v_add_u32 v8, s4, v8
    s_lshr_b32 s5, s2, 3
    s_lshl_b32 s5, s5, 2
    s_add_u32 s5, s5, s3
    s_mul_i32 s6, s5, 3072
    s_lshl_b32 s5, s5, 12
    v_lshl_add_u32 v10, v2, 6, s5
    v_mul_u32_u24 v11, 48, v2
    v_add_u32 v11, s6, v11
    s_and_b32 s6, s2, 0xf7
    s_cmp_ge_u32 s6, 245
    s_cbranch_scc1 K1_PRE
    s_bfe_u32 s7, s63, 0x10003
    s_lshl_b32 s6, s7, 10
    s_add_u32 s6, s6, 4096
    v_lshlrev_b32 v5, 4, v3
    v_lshlrev_b32 v0, 14, v4
    v_lshl_add_u32 v0, v1, 8, v0
    v_add3_u32 v0, v0, v5, s6
    v_mul_u32_u24 v6, 528, v3
    v_add_u32 v9, v9, v6
    s_waitcnt lgkmcnt(0)
    global_load_dwordx4 v[32:35], v8, s[8:9] offset:0
    global_load_dwordx4 v[36:39], v8, s[8:9] offset:256
    global_load_dwordx4 v[40:43], v8, s[8:9] offset:2048
    global_load_dwordx4 v[44:47], v8, s[8:9] offset:2304
    global_load_dwordx4 v[48:51], v12, s[8:9] offset:0
    global_load_dwordx4 v[52:55], v12, s[8:9] offset:256
    global_load_dwordx4 v[56:59], v12, s[8:9] offset:2048
    global_load_dwordx4 v[60:63], v12, s[8:9] offset:2304
    s_add_u32 s20, s10, 8192
    s_addc_u32 s21, s11, 0
    s_and_b32 s30, s3, 1
    s_lshr_b32 s31, s3, 1
    s_mov_b32 s40, 0x05040100
    s_mov_b32 s41, 0x07060302
    s_mov_b32 s42, 0xffff0000
    s_mov_b32 s43, 0x3f803f80
    s_add_u32 s24, s14, 6144
    s_addc_u32 s25, s15, 0
    s_lshl_b32 s29, s30, 17
    s_sub_u32 s28, 53248, s29
    s_lshl_b32 s29, s7, 18
    s_lshl_b32 s32, s30, 8
    s_lshl_b32 s33, s3, 16
    s_add_u32 s33, s33, s32
    s_add_u32 s33, s33, s29
    v_lshl_add_u32 v12, v4, 14, v5
    v_add_u32 v12, s33, v12
    v_accvgpr_write_b32 a200, v12
    v_mul_u32_u24 v12, 12288, v4
    s_mul_i32 s33, s31, 196608
    s_add_u32 s33, s33, s32
    s_add_u32 s33, s33, 4096
    v_lshl_add_u32 v13, v3, 4, v12
    v_add_u32 v13, s33, v13
    v_accvgpr_write_b32 a192, v13
    s_mov_b32 s34, 12
    s_add_u32 s33, s3, s34
    s_lshl_b32 s33, s33, 8
    v_add3_u32 v13, v12, v5, s33
    v_accvgpr_write_b32 a193, v13
    s_lshl_b32 s33, s3, 14
    s_add_u32 s34, s33, 53760
    v_add_u32 v13, s34, v7
    v_accvgpr_write_b32 a201, v13
    s_xor_b32 s33, s33, 16384
    s_add_u32 s34, s33, 53760
    v_add_u32 v13, s34, v7
    v_accvgpr_write_b32 a202, v13
    s_lshl_b32 s33, s3, 13
    v_add_u32 v13, s33, v7
    v_accvgpr_write_b32 a210, v13
    v_xor_b32 v14, 16384, v13
    v_accvgpr_write_b32 a211, v14
    s_mul_i32 s35, s31, 70144
    s_add_u32 s34, s35, 32768
    s_sub_u32 s35, 102912, s35
    v_add_u32 v15, s34, v13
    v_accvgpr_write_b32 a203, v15
    v_add_u32 v15, s35, v14
    v_accvgpr_write_b32 a204, v15
    s_lshl_b32 s34, s62, 8
    s_add_u32 s34, s34, s2
    s_lshl_b32 s34, s34, 15
    s_add_u32 s34, s34, 67108864
    v_add_u32 v15, s34, v13
    v_accvgpr_write_b32 a212, v15
    s_xor_b32 s35, s2, 8
    s_add_u32 s34, s2, 256
    s_cmp_eq_u32 s62, 0
    s_cselect_b32 s34, s35, s34
    s_lshl_b32 s34, s34, 15
    s_add_u32 s34, s34, 67108864
    v_add_u32 v15, s34, v13
    v_accvgpr_write_b32 a213, v15
    s_lshl_b32 s33, s3, 5
    s_add_u32 s33, s33, 25325824
    s_lshl_b32 s34, s61, 7
    s_add_u32 s34, s34, s33
    v_mov_b32 v15, s34
    v_accvgpr_write_b32 a214, v15
    s_lshl_b32 s34, s65, 7
    s_add_u32 s34, s34, s33
    v_mov_b32 v15, s34
    v_accvgpr_write_b32 a215, v15
    s_mov_b32 s36, 1.0
    s_mov_b32 s37, 1.0
    s_getreg_b32 s64, hwreg(HW_REG_XCC_ID, 0, 4)
    s_add_u32 s64, s64, 1
    v_lshrrev_b32 v13, 5, v2
    v_mul_u32_u24 v13, 512000, v13
    v_and_b32 v14, 31, v2
    v_lshl_add_u32 v13, v14, 4, v13
    v_accvgpr_write_b32 a195, v13
    s_lshl_b32 s33, s31, 9
    s_add_u32 s33, s33, 50688
    v_lshl_add_u32 v13, v3, 4, s33
    v_accvgpr_write_b32 a206, v13
    v_lshrrev_b32 v14, 1, v4
    v_lshl_add_u32 v13, v14, 8, v13
    v_and_b32 v14, 1, v4
    v_lshl_add_u32 v13, v14, 2, v13
    s_lshl_b32 s33, s30, 3
    v_add_u32 v13, s33, v13
    v_accvgpr_write_b32 a205, v13
    v_lshrrev_b32 v13, 3, v3
    v_and_b32 v14, 7, v3
    v_lshlrev_b32 v14, 4, v14
    v_lshl_add_u32 v15, v4, 8, v14
    s_mov_b32 s33, 512000
    v_mul_lo_u32 v12, v13, s33
    v_add_u32 v15, v15, v12
    v_accvgpr_write_b32 a194, v15
    v_lshl_add_u32 v13, v13, 12, v14
    v_lshl_add_u32 v13, v4, 9, v13
    s_lshl_b32 s33, s31, 13
    s_lshl_b32 s34, s30, 11
    s_add_u32 s33, s33, s34
    s_add_u32 s33, s33, s4
    v_add_u32 v13, s33, v13
    v_accvgpr_write_b32 a207, v13
    v_mul_u32_u24 v12, 528, v4
    v_lshl_add_u32 v12, v3, 4, v12
    v_accvgpr_write_b32 a209, v12
    s_lshl_b32 s33, s31, 8
    s_mul_i32 s34, s30, 8448
    v_mul_u32_u24 v6, 1584, v4
    v_add_u32 v4, s33, v12
    v_add3_u32 v13, s34, v4, v6
    v_accvgpr_write_b32 a208, v13
    s_xor_b32 s33, s33, 256
    v_add_u32 v5, s33, v12
    v_add3_u32 v6, s34, v5, v6
    s_cmp_ge_u32 s61, 125
    s_cselect_b32 s33, 375, 0
    s_add_u32 s33, s33, s61
    s_lshl_b32 s33, s33, 12
    s_mul_i32 s34, s30, 1024000
    s_add_u32 s33, s33, s34
    s_add_u32 s34, s33, 16777216
    s_add_u32 s48, s16, s34
    s_addc_u32 s49, s17, 0
    s_add_u32 s34, s33, 8388608
    s_lshl_b32 s33, s31, 22
    s_add_u32 s33, s33, s34
    s_add_u32 s44, s16, s33
    s_addc_u32 s45, s17, 0
    s_mov_b32 s50, 0x3e38aa3b
    s_mov_b32 s51, s50
    s_mov_b32 s52, 0xc038aa3b
    s_mov_b32 s53, 0x3b800000
    s_and_b32 s54, s2, 6
    s_min_u32 s54, s54, 1
    global_load_dword a254, v10, s[10:11]
    global_load_dwordx4 v[160:163], v0, s[10:11] offset:-4096
    global_load_dwordx4 v[164:167], v0, s[10:11] offset:-2048
    global_load_dwordx4 v[168:171], v0, s[10:11] offset:0
    global_load_dwordx4 v[172:175], v0, s[10:11] offset:2048
    global_load_dwordx4 v[176:179], v0, s[20:21] offset:-4096
    s_and_b32 s55, s61, 7
    s_lshr_b32 s56, s61, 3
    s_sub_i32 s57, s55, 5
    s_max_i32 s57, s57, 0
    s_sub_i32 s58, s55, 2
    s_max_i32 s58, s58, 0
    s_min_i32 s58, s58, 3
    s_cmp_lt_u32 s55, 5
    s_cselect_b32 s59, 16, 15
    s_add_u32 s58, s58, s59
    s_cmp_ge_u32 s61, 125
    s_cselect_b32 s57, s58, s57
    s_cselect_b32 s59, 1, 0
    s_lshl_b32 s55, s55, 4
    s_add_u32 s55, s55, s56
    s_sub_u32 s55, s55, s57
    s_mul_i32 s33, s59, 125
    s_add_u32 s33, s33, s55
    s_lshl_b32 s60, s33, 7
    s_add_u32 s60, s60, 25293824
    v_mov_b32 v13, s60
    v_accvgpr_write_b32 a196, v13
    s_sub_u32 s33, s33, s61
    s_lshl_b32 s33, s33, 12
    s_ashr_i32 s34, s33, 31
    s_add_u32 s48, s48, s33
    s_addc_u32 s49, s49, s34
    s_cmp_eq_u32 s31, 0
    s_cselect_b32 s33, 0, s33
    s_cselect_b32 s34, 0, s34
    s_add_u32 s44, s44, s33
    s_addc_u32 s45, s45, s34
    s_waitcnt vmcnt(13)
    ds_write_b128 v9, v[32:35] offset:33792
    global_load_dwordx4 v[180:183], v0, s[20:21] offset:-2048
    s_waitcnt vmcnt(13)
    ds_write_b128 v9, v[36:39] offset:42240
    s_waitcnt vmcnt(12)
    ds_write_b128 v9, v[40:43] offset:33856
    s_waitcnt vmcnt(11)
    ds_write_b128 v9, v[44:47] offset:42304
    v_mov_b32 v12, 52736
    v_mov_b32 v13, 0
    ds_write_b32 v12, v13
    v_dot2_f32_bf16 v128, v32, s43, 0
    v_dot2_f32_bf16 v129, v32, v32, 0
    v_dot2_f32_bf16 v130, v40, s43, 0
    v_dot2_f32_bf16 v131, v40, v40, 0
    s_waitcnt vmcnt(10)
    v_dot2_f32_bf16 v132, v48, s43, 0
    v_dot2_f32_bf16 v133, v48, v48, 0
    global_load_dwordx4 v[184:187], v0, s[20:21] offset:0
    s_waitcnt vmcnt(9)
    v_dot2_f32_bf16 v134, v56, s43, 0
    v_dot2_f32_bf16 v135, v56, v56, 0
    v_dot2c_f32_bf16 v128, s43, v33
    v_dot2c_f32_bf16 v129, v33, v33
    v_dot2c_f32_bf16 v130, s43, v41
    v_dot2c_f32_bf16 v131, v41, v41
    v_dot2c_f32_bf16 v132, s43, v49
    v_dot2c_f32_bf16 v133, v49, v49
    v_dot2c_f32_bf16 v134, s43, v57
    v_dot2c_f32_bf16 v135, v57, v57
    v_dot2c_f32_bf16 v128, s43, v34
    v_dot2c_f32_bf16 v129, v34, v34
    v_dot2c_f32_bf16 v130, s43, v42
    v_dot2c_f32_bf16 v131, v42, v42
    v_dot2c_f32_bf16 v132, s43, v50
    v_dot2c_f32_bf16 v133, v50, v50
    v_dot2c_f32_bf16 v134, s43, v58
    v_dot2c_f32_bf16 v135, v58, v58
    global_load_dwordx4 v[188:191], v0, s[20:21] offset:2048
    v_dot2c_f32_bf16 v128, s43, v35
    v_dot2c_f32_bf16 v129, v35, v35
    v_dot2c_f32_bf16 v130, s43, v43
    v_dot2c_f32_bf16 v131, v43, v43
    v_dot2c_f32_bf16 v132, s43, v51
    v_dot2c_f32_bf16 v133, v51, v51
    v_dot2c_f32_bf16 v134, s43, v59
    v_dot2c_f32_bf16 v135, v59, v59
    v_dot2c_f32_bf16 v128, s43, v36
    v_dot2c_f32_bf16 v129, v36, v36
    v_dot2c_f32_bf16 v130, s43, v44
    v_dot2c_f32_bf16 v131, v44, v44
    v_dot2c_f32_bf16 v132, s43, v52
    v_dot2c_f32_bf16 v133, v52, v52
    s_waitcnt vmcnt(9)
    v_dot2c_f32_bf16 v134, s43, v60
    v_dot2c_f32_bf16 v135, v60, v60
    v_dot2c_f32_bf16 v128, s43, v37
    v_dot2c_f32_bf16 v129, v37, v37
    v_add_u32 v0, 65536, v0
    global_load_dwordx4 v[192:195], v0, s[10:11] offset:-4096
    v_dot2c_f32_bf16 v130, s43, v45
    v_dot2c_f32_bf16 v131, v45, v45
    v_dot2c_f32_bf16 v132, s43, v53
    v_dot2c_f32_bf16 v133, v53, v53
    v_dot2c_f32_bf16 v134, s43, v61
    v_dot2c_f32_bf16 v135, v61, v61
    v_dot2c_f32_bf16 v128, s43, v38
    v_dot2c_f32_bf16 v129, v38, v38
    v_dot2c_f32_bf16 v130, s43, v46
    v_dot2c_f32_bf16 v131, v46, v46
    v_dot2c_f32_bf16 v132, s43, v54
    v_dot2c_f32_bf16 v133, v54, v54
    v_dot2c_f32_bf16 v134, s43, v62
    v_dot2c_f32_bf16 v135, v62, v62
    v_dot2c_f32_bf16 v128, s43, v39
    v_dot2c_f32_bf16 v129, v39, v39
    v_dot2c_f32_bf16 v130, s43, v47
    v_dot2c_f32_bf16 v131, v47, v47
    global_load_dwordx4 v[196:199], v0, s[10:11] offset:-2048
    v_dot2c_f32_bf16 v132, s43, v55
    v_dot2c_f32_bf16 v133, v55, v55
    v_dot2c_f32_bf16 v134, s43, v63
    v_dot2c_f32_bf16 v135, v63, v63
    v_add_f32_dpp v128, v128, v128 row_ror:8 row_mask:0xf bank_mask:0xf
    v_add_f32_dpp v129, v129, v129 row_ror:8 row_mask:0xf bank_mask:0xf
    v_add_f32_dpp v130, v130, v130 row_ror:8 row_mask:0xf bank_mask:0xf
    v_add_f32_dpp v131, v131, v131 row_ror:8 row_mask:0xf bank_mask:0xf
    v_add_f32_dpp v132, v132, v132 row_ror:8 row_mask:0xf bank_mask:0xf
    v_add_f32_dpp v133, v133, v133 row_ror:8 row_mask:0xf bank_mask:0xf
    v_add_f32_dpp v134, v134, v134 row_ror:8 row_mask:0xf bank_mask:0xf
    v_add_f32_dpp v135, v135, v135 row_ror:8 row_mask:0xf bank_mask:0xf
    v_add_f32_dpp v128, v128, v128 row_ror:4 row_mask:0xf bank_mask:0xf
    v_add_f32_dpp v129, v129, v129 row_ror:4 row_mask:0xf bank_mask:0xf
    v_add_f32_dpp v130, v130, v130 row_ror:4 row_mask:0xf bank_mask:0xf
    v_add_f32_dpp v131, v131, v131 row_ror:4 row_mask:0xf bank_mask:0xf
    v_add_f32_dpp v132, v132, v132 row_ror:4 row_mask:0xf bank_mask:0xf
    v_add_f32_dpp v133, v133, v133 row_ror:4 row_mask:0xf bank_mask:0xf
    global_load_dwordx4 v[200:203], v0, s[10:11] offset:0
    v_add_f32_dpp v134, v134, v134 row_ror:4 row_mask:0xf bank_mask:0xf
    v_add_f32_dpp v135, v135, v135 row_ror:4 row_mask:0xf bank_mask:0xf
    v_add_f32_dpp v128, v128, v128 row_ror:2 row_mask:0xf bank_mask:0xf
    v_add_f32_dpp v129, v129, v129 row_ror:2 row_mask:0xf bank_mask:0xf
    v_add_f32_dpp v130, v130, v130 row_ror:2 row_mask:0xf bank_mask:0xf
    v_add_f32_dpp v131, v131, v131 row_ror:2 row_mask:0xf bank_mask:0xf
    v_add_f32_dpp v132, v132, v132 row_ror:2 row_mask:0xf bank_mask:0xf
    v_add_f32_dpp v133, v133, v133 row_ror:2 row_mask:0xf bank_mask:0xf
    v_add_f32_dpp v134, v134, v134 row_ror:2 row_mask:0xf bank_mask:0xf
    v_add_f32_dpp v135, v135, v135 row_ror:2 row_mask:0xf bank_mask:0xf
    v_add_f32_dpp v128, v128, v128 row_ror:1 row_mask:0xf bank_mask:0xf
    v_add_f32_dpp v129, v129, v129 row_ror:1 row_mask:0xf bank_mask:0xf
    v_add_f32_dpp v130, v130, v130 row_ror:1 row_mask:0xf bank_mask:0xf
    v_add_f32_dpp v131, v131, v131 row_ror:1 row_mask:0xf bank_mask:0xf
    v_add_f32_dpp v132, v132, v132 row_ror:1 row_mask:0xf bank_mask:0xf
    v_add_f32_dpp v133, v133, v133 row_ror:1 row_mask:0xf bank_mask:0xf
    v_add_f32_dpp v134, v134, v134 row_ror:1 row_mask:0xf bank_mask:0xf
    v_add_f32_dpp v135, v135, v135 row_ror:1 row_mask:0xf bank_mask:0xf
    global_load_dwordx4 v[204:207], v0, s[10:11] offset:2048
    v_mul_f32 v128, s53, v128
    v_lshlrev_b32 v64, 16, v32
    v_and_b32 v65, s42, v32
    v_mul_f32 v130, s53, v130
    v_lshlrev_b32 v66, 16, v33
    v_and_b32 v67, s42, v33
    v_mul_f32 v132, s53, v132
    v_lshlrev_b32 v68, 16, v34
    v_and_b32 v69, s42, v34
    v_mul_f32 v134, s53, v134
    v_lshlrev_b32 v70, 16, v35
    v_and_b32 v71, s42, v35
    v_mul_f32 v136, v128, v128
    v_lshlrev_b32 v72, 16, v36
    v_and_b32 v73, s42, v36
    v_mul_f32 v138, v130, v130
    v_lshlrev_b32 v74, 16, v37
    v_and_b32 v75, s42, v37
    global_load_dwordx4 v[208:211], v0, s[20:21] offset:-4096
    v_mul_f32 v140, v132, v132
    v_lshlrev_b32 v76, 16, v38
    v_and_b32 v77, s42, v38
    v_mul_f32 v142, v134, v134
    v_lshlrev_b32 v78, 16, v39
    v_and_b32 v79, s42, v39
    v_fma_f32 v129, v129, s53, -v136
    v_lshlrev_b32 v80, 16, v40
    v_and_b32 v81, s42, v40
    v_fma_f32 v131, v131, s53, -v138
    v_lshlrev_b32 v82, 16, v41
    v_and_b32 v83, s42, v41
    v_fma_f32 v133, v133, s53, -v140
    v_lshlrev_b32 v84, 16, v42
    v_and_b32 v85, s42, v42
    v_fma_f32 v135, v135, s53, -v142
    v_lshlrev_b32 v86, 16, v43
    v_and_b32 v87, s42, v43
    global_load_dwordx4 v[212:215], v0, s[20:21] offset:-2048
    v_max_f32 v129, 0, v129
    v_lshlrev_b32 v88, 16, v44
    v_and_b32 v89, s42, v44
    v_max_f32 v131, 0, v131
    v_lshlrev_b32 v90, 16, v45
    v_and_b32 v91, s42, v45
    v_max_f32 v133, 0, v133
    v_lshlrev_b32 v92, 16, v46
    v_and_b32 v93, s42, v46
    v_max_f32 v135, 0, v135
    v_lshlrev_b32 v94, 16, v47
    v_and_b32 v95, s42, v47
    v_add_f32 v129, 0x3727c5ac, v129
    v_lshlrev_b32 v96, 16, v48
    v_and_b32 v97, s42, v48
    v_add_f32 v131, 0x3727c5ac, v131
    v_lshlrev_b32 v98, 16, v49
    v_and_b32 v99, s42, v49
    global_load_dwordx4 v[216:219], v0, s[20:21] offset:0
    v_add_f32 v133, 0x3727c5ac, v133
    v_lshlrev_b32 v100, 16, v50
    v_and_b32 v101, s42, v50
    v_add_f32 v135, 0x3727c5ac, v135
    v_lshlrev_b32 v102, 16, v51
    v_and_b32 v103, s42, v51
    v_rsq_f32 v129, v129
    v_lshlrev_b32 v104, 16, v52
    v_and_b32 v105, s42, v52
    v_rsq_f32 v131, v131
    v_lshlrev_b32 v106, 16, v53
    v_and_b32 v107, s42, v53
    v_rsq_f32 v133, v133
    v_lshlrev_b32 v108, 16, v54
    v_and_b32 v109, s42, v54
    global_load_dwordx4 v[220:223], v0, s[20:21] offset:2048
    v_rsq_f32 v135, v135
    v_lshlrev_b32 v110, 16, v55
    v_and_b32 v111, s42, v55
    v_mul_f32 v136, 0xbfb8aa3b, v129
    v_lshlrev_b32 v112, 16, v56
    v_and_b32 v113, s42, v56
    v_mul_f32 v138, 0xbfb8aa3b, v131
    v_lshlrev_b32 v114, 16, v57
    v_and_b32 v115, s42, v57
    v_mul_f32 v140, 0xbfb8aa3b, v133
    v_lshlrev_b32 v116, 16, v58
    v_and_b32 v117, s42, v58
    v_mul_f32 v142, 0xbfb8aa3b, v135
    v_lshlrev_b32 v118, 16, v59
    v_and_b32 v119, s42, v59
    v_mul_f32_e64 v137, -v128, v136
    v_lshlrev_b32 v120, 16, v60
    v_add_u32 v0, 65536, v0
    global_load_dwordx4 v[224:227], v0, s[10:11] offset:-4096
    v_and_b32 v121, s42, v60
    v_mul_f32_e64 v139, -v130, v138
    v_lshlrev_b32 v122, 16, v61
    v_and_b32 v123, s42, v61
    v_mul_f32_e64 v141, -v132, v140
    v_lshlrev_b32 v124, 16, v62
    v_and_b32 v125, s42, v62
    v_mul_f32_e64 v143, -v134, v142
    v_lshlrev_b32 v126, 16, v63
    v_and_b32 v127, s42, v63
    v_pk_fma_f32 v[64:65], v[64:65], v[136:137], v[136:137] op_sel:[0,0,1] op_sel_hi:[1,0,1]
    v_pk_fma_f32 v[66:67], v[66:67], v[136:137], v[136:137] op_sel:[0,0,1] op_sel_hi:[1,0,1]
    v_pk_fma_f32 v[68:69], v[68:69], v[136:137], v[136:137] op_sel:[0,0,1] op_sel_hi:[1,0,1]
    v_pk_fma_f32 v[70:71], v[70:71], v[136:137], v[136:137] op_sel:[0,0,1] op_sel_hi:[1,0,1]
    v_cvt_pk_bf16_f32 v32, v64, v65
    v_cvt_pk_bf16_f32 v33, v66, v67
    v_cvt_pk_bf16_f32 v34, v68, v69
    v_cvt_pk_bf16_f32 v35, v70, v71
    global_load_dwordx4 v[228:231], v0, s[10:11] offset:-2048
    ds_write_b128 v9, v[32:35] offset:0
    v_pk_fma_f32 v[72:73], v[72:73], v[136:137], v[136:137] op_sel:[0,0,1] op_sel_hi:[1,0,1]
    v_pk_fma_f32 v[74:75], v[74:75], v[136:137], v[136:137] op_sel:[0,0,1] op_sel_hi:[1,0,1]
    v_pk_fma_f32 v[76:77], v[76:77], v[136:137], v[136:137] op_sel:[0,0,1] op_sel_hi:[1,0,1]
    v_pk_fma_f32 v[78:79], v[78:79], v[136:137], v[136:137] op_sel:[0,0,1] op_sel_hi:[1,0,1]
    v_cvt_pk_bf16_f32 v36, v72, v73
    v_cvt_pk_bf16_f32 v37, v74, v75
    v_cvt_pk_bf16_f32 v38, v76, v77
    v_cvt_pk_bf16_f32 v39, v78, v79
    ds_write_b128 v9, v[36:39] offset:8448
    v_pk_fma_f32 v[80:81], v[80:81], v[138:139], v[138:139] op_sel:[0,0,1] op_sel_hi:[1,0,1]
    v_pk_fma_f32 v[82:83], v[82:83], v[138:139], v[138:139] op_sel:[0,0,1] op_sel_hi:[1,0,1]
    v_pk_fma_f32 v[84:85], v[84:85], v[138:139], v[138:139] op_sel:[0,0,1] op_sel_hi:[1,0,1]
    v_pk_fma_f32 v[86:87], v[86:87], v[138:139], v[138:139] op_sel:[0,0,1] op_sel_hi:[1,0,1]
    global_load_dwordx4 v[232:235], v0, s[10:11] offset:0
    v_cvt_pk_bf16_f32 v40, v80, v81
    v_cvt_pk_bf16_f32 v41, v82, v83
    v_cvt_pk_bf16_f32 v42, v84, v85
    v_cvt_pk_bf16_f32 v43, v86, v87
    ds_write_b128 v9, v[40:43] offset:64
    v_pk_fma_f32 v[88:89], v[88:89], v[138:139], v[138:139] op_sel:[0,0,1] op_sel_hi:[1,0,1]
    v_pk_fma_f32 v[90:91], v[90:91], v[138:139], v[138:139] op_sel:[0,0,1] op_sel_hi:[1,0,1]
    v_pk_fma_f32 v[92:93], v[92:93], v[138:139], v[138:139] op_sel:[0,0,1] op_sel_hi:[1,0,1]
    v_pk_fma_f32 v[94:95], v[94:95], v[138:139], v[138:139] op_sel:[0,0,1] op_sel_hi:[1,0,1]
    v_cvt_pk_bf16_f32 v44, v88, v89
    v_cvt_pk_bf16_f32 v45, v90, v91
    v_cvt_pk_bf16_f32 v46, v92, v93
    v_cvt_pk_bf16_f32 v47, v94, v95
    ds_write_b128 v9, v[44:47] offset:8512
    global_load_dwordx4 v[236:239], v0, s[10:11] offset:2048
    v_pk_fma_f32 v[96:97], v[96:97], v[140:141], v[140:141] op_sel:[0,0,1] op_sel_hi:[1,0,1]
    v_pk_fma_f32 v[98:99], v[98:99], v[140:141], v[140:141] op_sel:[0,0,1] op_sel_hi:[1,0,1]
    v_pk_fma_f32 v[100:101], v[100:101], v[140:141], v[140:141] op_sel:[0,0,1] op_sel_hi:[1,0,1]
    v_pk_fma_f32 v[102:103], v[102:103], v[140:141], v[140:141] op_sel:[0,0,1] op_sel_hi:[1,0,1]
    v_cvt_pk_bf16_f32 v48, v96, v97
    v_cvt_pk_bf16_f32 v49, v98, v99
    v_cvt_pk_bf16_f32 v50, v100, v101
    v_cvt_pk_bf16_f32 v51, v102, v103
    ds_write_b128 v9, v[48:51] offset:16896
    v_pk_fma_f32 v[104:105], v[104:105], v[140:141], v[140:141] op_sel:[0,0,1] op_sel_hi:[1,0,1]
    v_pk_fma_f32 v[106:107], v[106:107], v[140:141], v[140:141] op_sel:[0,0,1] op_sel_hi:[1,0,1]
    v_pk_fma_f32 v[108:109], v[108:109], v[140:141], v[140:141] op_sel:[0,0,1] op_sel_hi:[1,0,1]
    v_pk_fma_f32 v[110:111], v[110:111], v[140:141], v[140:141] op_sel:[0,0,1] op_sel_hi:[1,0,1]
    v_cvt_pk_bf16_f32 v52, v104, v105
    v_cvt_pk_bf16_f32 v53, v106, v107
    v_cvt_pk_bf16_f32 v54, v108, v109
    global_load_dwordx4 v[240:243], v0, s[20:21] offset:-4096
    v_cvt_pk_bf16_f32 v55, v110, v111
    ds_write_b128 v9, v[52:55] offset:25344
    v_pk_fma_f32 v[112:113], v[112:113], v[142:143], v[142:143] op_sel:[0,0,1] op_sel_hi:[1,0,1]
    v_pk_fma_f32 v[114:115], v[114:115], v[142:143], v[142:143] op_sel:[0,0,1] op_sel_hi:[1,0,1]
    v_pk_fma_f32 v[116:117], v[116:117], v[142:143], v[142:143] op_sel:[0,0,1] op_sel_hi:[1,0,1]
    v_pk_fma_f32 v[118:119], v[118:119], v[142:143], v[142:143] op_sel:[0,0,1] op_sel_hi:[1,0,1]
    v_cvt_pk_bf16_f32 v56, v112, v113
    v_cvt_pk_bf16_f32 v57, v114, v115
    v_cvt_pk_bf16_f32 v58, v116, v117
    v_cvt_pk_bf16_f32 v59, v118, v119
    ds_write_b128 v9, v[56:59] offset:16960
    v_pk_fma_f32 v[120:121], v[120:121], v[142:143], v[142:143] op_sel:[0,0,1] op_sel_hi:[1,0,1]
    v_pk_fma_f32 v[122:123], v[122:123], v[142:143], v[142:143] op_sel:[0,0,1] op_sel_hi:[1,0,1]
    v_pk_fma_f32 v[124:125], v[124:125], v[142:143], v[142:143] op_sel:[0,0,1] op_sel_hi:[1,0,1]
    global_load_dwordx4 v[244:247], v0, s[20:21] offset:-2048
    v_pk_fma_f32 v[126:127], v[126:127], v[142:143], v[142:143] op_sel:[0,0,1] op_sel_hi:[1,0,1]
    v_cvt_pk_bf16_f32 v60, v120, v121
    v_cvt_pk_bf16_f32 v61, v122, v123
    v_cvt_pk_bf16_f32 v62, v124, v125
    v_cvt_pk_bf16_f32 v63, v126, v127
    ds_write_b128 v9, v[60:63] offset:25408
    s_waitcnt lgkmcnt(0)
    s_barrier
    global_load_dwordx4 v[248:251], v0, s[20:21] offset:0
    ds_read_b128 a[0:3], v4 offset:0
    ds_read_b128 a[4:7], v5 offset:0
    ds_read_b128 a[8:11], v4 offset:16896
    ds_read_b128 a[12:15], v5 offset:16896
    ds_read_b128 a[16:19], v4 offset:2112
    ds_read_b128 a[20:23], v5 offset:2112
    ds_read_b128 a[24:27], v4 offset:19008
    ds_read_b128 a[28:31], v5 offset:19008
    s_waitcnt vmcnt(15)
    global_load_dwordx4 v[252:255], v0, s[20:21] offset:2048
    v_perm_b32 v16, v164, v160, s40
    v_perm_b32 v17, v172, v168, s40
    v_perm_b32 v18, v180, v176, s40
    v_perm_b32 v19, v188, v184, s40
    v_perm_b32 v20, v164, v160, s41
    v_perm_b32 v21, v172, v168, s41
    v_perm_b32 v22, v180, v176, s41
    v_perm_b32 v23, v188, v184, s41
    s_waitcnt lgkmcnt(7)
    v_mfma_f32_16x16x32_bf16 v[32:35], v[16:19], a[0:3], 0
    v_perm_b32 v24, v165, v161, s40
    s_waitcnt lgkmcnt(6)
    v_mfma_f32_16x16x32_bf16 v[64:67], v[16:19], a[4:7], 0
    ds_read_b128 a[32:35], v4 offset:4224
    ds_read_b128 a[36:39], v5 offset:4224
    v_perm_b32 v25, v173, v169, s40
    s_waitcnt lgkmcnt(7)
    v_mfma_f32_16x16x32_bf16 a[160:163], v[16:19], a[8:11], 0
    v_add_u32 v0, 65536, v0
    global_load_dwordx4 v[96:99], v0, s[10:11] offset:-4096
    v_perm_b32 v26, v181, v177, s40
    s_waitcnt lgkmcnt(6)
    v_mfma_f32_16x16x32_bf16 a[216:219], v[16:19], a[12:15], 0
    v_perm_b32 v27, v189, v185, s40
    v_mfma_f32_16x16x32_bf16 v[36:39], v[20:23], a[0:3], 0
    ds_read_b128 a[40:43], v4 offset:21120
    ds_read_b128 a[44:47], v5 offset:21120
    v_perm_b32 v28, v165, v161, s41
    v_mfma_f32_16x16x32_bf16 v[68:71], v[20:23], a[4:7], 0
    v_perm_b32 v29, v173, v169, s41
    v_mfma_f32_16x16x32_bf16 a[164:167], v[20:23], a[8:11], 0
    v_perm_b32 v30, v181, v177, s41
    v_mfma_f32_16x16x32_bf16 a[220:223], v[20:23], a[12:15], 0
    global_load_dwordx4 v[100:103], v0, s[10:11] offset:-2048
    v_perm_b32 v31, v189, v185, s41
    v_mfma_f32_16x16x32_bf16 v[40:43], v[24:27], a[0:3], 0
    v_perm_b32 v16, v166, v162, s40
    v_mfma_f32_16x16x32_bf16 v[72:75], v[24:27], a[4:7], 0
    v_perm_b32 v17, v174, v170, s40
    v_mfma_f32_16x16x32_bf16 a[168:171], v[24:27], a[8:11], 0
    v_perm_b32 v18, v182, v178, s40
    v_mfma_f32_16x16x32_bf16 a[224:227], v[24:27], a[12:15], 0
    global_load_dwordx4 v[104:107], v0, s[10:11] offset:0
    v_perm_b32 v19, v190, v186, s40
    v_mfma_f32_16x16x32_bf16 v[44:47], v[28:31], a[0:3], 0
    v_perm_b32 v20, v166, v162, s41
    v_mfma_f32_16x16x32_bf16 v[76:79], v[28:31], a[4:7], 0
    v_perm_b32 v21, v174, v170, s41
    v_mfma_f32_16x16x32_bf16 a[172:175], v[28:31], a[8:11], 0
    v_perm_b32 v22, v182, v178, s41
    v_mfma_f32_16x16x32_bf16 a[228:231], v[28:31], a[12:15], 0
    global_load_dwordx4 v[108:111], v0, s[10:11] offset:2048
    v_perm_b32 v23, v190, v186, s41
    v_mfma_f32_16x16x32_bf16 v[48:51], v[16:19], a[0:3], 0
    v_perm_b32 v24, v167, v163, s40
    v_mfma_f32_16x16x32_bf16 v[80:83], v[16:19], a[4:7], 0
    v_perm_b32 v25, v175, v171, s40
    v_mfma_f32_16x16x32_bf16 a[176:179], v[16:19], a[8:11], 0
    v_perm_b32 v26, v183, v179, s40
    v_mfma_f32_16x16x32_bf16 a[232:235], v[16:19], a[12:15], 0
    global_load_dwordx4 v[112:115], v0, s[20:21] offset:-4096
    v_perm_b32 v27, v191, v187, s40
    v_mfma_f32_16x16x32_bf16 v[52:55], v[20:23], a[0:3], 0
    v_perm_b32 v28, v167, v163, s41
    v_mfma_f32_16x16x32_bf16 v[84:87], v[20:23], a[4:7], 0
    v_perm_b32 v29, v175, v171, s41
    v_mfma_f32_16x16x32_bf16 a[180:183], v[20:23], a[8:11], 0
    v_perm_b32 v30, v183, v179, s41
    v_mfma_f32_16x16x32_bf16 a[236:239], v[20:23], a[12:15], 0
    global_load_dwordx4 v[116:119], v0, s[20:21] offset:-2048
    v_perm_b32 v31, v191, v187, s41
    v_mfma_f32_16x16x32_bf16 v[56:59], v[24:27], a[0:3], 0
    s_waitcnt vmcnt(14)
    v_perm_b32 v16, v196, v192, s40
    v_mfma_f32_16x16x32_bf16 v[88:91], v[24:27], a[4:7], 0
    global_load_dwordx4 v[120:123], v0, s[20:21] offset:0
    v_perm_b32 v17, v204, v200, s40
    v_mfma_f32_16x16x32_bf16 a[184:187], v[24:27], a[8:11], 0
    global_load_dwordx4 v[124:127], v0, s[20:21] offset:2048
    v_perm_b32 v18, v212, v208, s40
    v_mfma_f32_16x16x32_bf16 a[240:243], v[24:27], a[12:15], 0
    v_perm_b32 v19, v220, v216, s40
    v_mfma_f32_16x16x32_bf16 v[60:63], v[28:31], a[0:3], 0
    v_add_u32 v0, 65536, v0
    global_load_dwordx4 v[128:131], v0, s[10:11] offset:-4096
    v_perm_b32 v20, v196, v192, s41
    v_mfma_f32_16x16x32_bf16 v[92:95], v[28:31], a[4:7], 0
    v_perm_b32 v21, v204, v200, s41
    v_mfma_f32_16x16x32_bf16 a[188:191], v[28:31], a[8:11], 0
    v_perm_b32 v22, v212, v208, s41
    v_mfma_f32_16x16x32_bf16 a[244:247], v[28:31], a[12:15], 0
    v_perm_b32 v23, v220, v216, s41
    s_waitcnt lgkmcnt(7)
    v_mfma_f32_16x16x32_bf16 v[32:35], v[16:19], a[16:19], v[32:35]
    global_load_dwordx4 v[132:135], v0, s[10:11] offset:-2048
    v_perm_b32 v24, v197, v193, s40
    s_waitcnt lgkmcnt(6)
    v_mfma_f32_16x16x32_bf16 v[64:67], v[16:19], a[20:23], v[64:67]
    ds_read_b128 a[48:51], v4 offset:6336
    ds_read_b128 a[52:55], v5 offset:6336
    v_perm_b32 v25, v205, v201, s40
    s_waitcnt lgkmcnt(7)
    v_mfma_f32_16x16x32_bf16 a[160:163], v[16:19], a[24:27], a[160:163]
    v_perm_b32 v26, v213, v209, s40
    s_waitcnt lgkmcnt(6)
    v_mfma_f32_16x16x32_bf16 a[216:219], v[16:19], a[28:31], a[216:219]
    v_perm_b32 v27, v221, v217, s40
    v_mfma_f32_16x16x32_bf16 v[36:39], v[20:23], a[16:19], v[36:39]
    global_load_dwordx4 v[136:139], v0, s[10:11] offset:0
    ds_read_b128 a[56:59], v4 offset:23232
    ds_read_b128 a[60:63], v5 offset:23232
    v_perm_b32 v28, v197, v193, s41
    v_mfma_f32_16x16x32_bf16 v[68:71], v[20:23], a[20:23], v[68:71]
    v_perm_b32 v29, v205, v201, s41
    v_mfma_f32_16x16x32_bf16 a[164:167], v[20:23], a[24:27], a[164:167]
    v_perm_b32 v30, v213, v209, s41
    v_mfma_f32_16x16x32_bf16 a[220:223], v[20:23], a[28:31], a[220:223]
    v_perm_b32 v31, v221, v217, s41
    v_mfma_f32_16x16x32_bf16 v[40:43], v[24:27], a[16:19], v[40:43]
    global_load_dwordx4 v[140:143], v0, s[10:11] offset:2048
    v_perm_b32 v16, v198, v194, s40
    v_mfma_f32_16x16x32_bf16 v[72:75], v[24:27], a[20:23], v[72:75]
    v_perm_b32 v17, v206, v202, s40
    v_mfma_f32_16x16x32_bf16 a[168:171], v[24:27], a[24:27], a[168:171]
    v_perm_b32 v18, v214, v210, s40
    v_mfma_f32_16x16x32_bf16 a[224:227], v[24:27], a[28:31], a[224:227]
    v_perm_b32 v19, v222, v218, s40
    v_mfma_f32_16x16x32_bf16 v[44:47], v[28:31], a[16:19], v[44:47]
    global_load_dwordx4 v[144:147], v0, s[20:21] offset:-4096
    v_perm_b32 v20, v198, v194, s41
    v_mfma_f32_16x16x32_bf16 v[76:79], v[28:31], a[20:23], v[76:79]
    v_perm_b32 v21, v206, v202, s41
    v_mfma_f32_16x16x32_bf16 a[172:175], v[28:31], a[24:27], a[172:175]
    v_perm_b32 v22, v214, v210, s41
    v_mfma_f32_16x16x32_bf16 a[228:231], v[28:31], a[28:31], a[228:231]
    v_perm_b32 v23, v222, v218, s41
    v_mfma_f32_16x16x32_bf16 v[48:51], v[16:19], a[16:19], v[48:51]
    global_load_dwordx4 v[148:151], v0, s[20:21] offset:-2048
    v_perm_b32 v24, v199, v195, s40
    v_mfma_f32_16x16x32_bf16 v[80:83], v[16:19], a[20:23], v[80:83]
    v_perm_b32 v25, v207, v203, s40
    v_mfma_f32_16x16x32_bf16 a[176:179], v[16:19], a[24:27], a[176:179]
    v_perm_b32 v26, v215, v211, s40
    v_mfma_f32_16x16x32_bf16 a[232:235], v[16:19], a[28:31], a[232:235]
    v_perm_b32 v27, v223, v219, s40
    v_mfma_f32_16x16x32_bf16 v[52:55], v[20:23], a[16:19], v[52:55]
    global_load_dwordx4 v[152:155], v0, s[20:21] offset:0
    v_perm_b32 v28, v199, v195, s41
    v_mfma_f32_16x16x32_bf16 v[84:87], v[20:23], a[20:23], v[84:87]
    v_perm_b32 v29, v207, v203, s41
    v_mfma_f32_16x16x32_bf16 a[180:183], v[20:23], a[24:27], a[180:183]
    v_perm_b32 v30, v215, v211, s41
    v_mfma_f32_16x16x32_bf16 a[236:239], v[20:23], a[28:31], a[236:239]
    v_perm_b32 v31, v223, v219, s41
    v_mfma_f32_16x16x32_bf16 v[56:59], v[24:27], a[16:19], v[56:59]
    global_load_dwordx4 v[156:159], v0, s[20:21] offset:2048
    s_waitcnt vmcnt(16)
    v_perm_b32 v16, v228, v224, s40
    v_mfma_f32_16x16x32_bf16 v[88:91], v[24:27], a[20:23], v[88:91]
    v_perm_b32 v17, v236, v232, s40
    v_mfma_f32_16x16x32_bf16 a[184:187], v[24:27], a[24:27], a[184:187]
    v_perm_b32 v18, v244, v240, s40
    v_mfma_f32_16x16x32_bf16 a[240:243], v[24:27], a[28:31], a[240:243]
    v_perm_b32 v19, v252, v248, s40
    v_mfma_f32_16x16x32_bf16 v[60:63], v[28:31], a[16:19], v[60:63]
    v_add_u32 v0, 65536, v0
    global_load_dwordx4 v[160:163], v0, s[10:11] offset:-4096
    v_perm_b32 v20, v228, v224, s41
    v_mfma_f32_16x16x32_bf16 v[92:95], v[28:31], a[20:23], v[92:95]
    v_perm_b32 v21, v236, v232, s41
    v_mfma_f32_16x16x32_bf16 a[188:191], v[28:31], a[24:27], a[188:191]
    v_perm_b32 v22, v244, v240, s41
    v_mfma_f32_16x16x32_bf16 a[244:247], v[28:31], a[28:31], a[244:247]
    v_perm_b32 v23, v252, v248, s41
    s_waitcnt lgkmcnt(7)
    v_mfma_f32_16x16x32_bf16 v[32:35], v[16:19], a[32:35], v[32:35]
    global_load_dwordx4 v[164:167], v0, s[10:11] offset:-2048
    v_perm_b32 v24, v229, v225, s40
    s_waitcnt lgkmcnt(6)
    v_mfma_f32_16x16x32_bf16 v[64:67], v[16:19], a[36:39], v[64:67]
    ds_read_b128 a[64:67], v4 offset:8448
    ds_read_b128 a[68:71], v5 offset:8448
    v_perm_b32 v25, v237, v233, s40
    s_waitcnt lgkmcnt(7)
    v_mfma_f32_16x16x32_bf16 a[160:163], v[16:19], a[40:43], a[160:163]
    v_perm_b32 v26, v245, v241, s40
    s_waitcnt lgkmcnt(6)
    v_mfma_f32_16x16x32_bf16 a[216:219], v[16:19], a[44:47], a[216:219]
    v_perm_b32 v27, v253, v249, s40
    v_mfma_f32_16x16x32_bf16 v[36:39], v[20:23], a[32:35], v[36:39]
    global_load_dwordx4 v[168:171], v0, s[10:11] offset:0
    ds_read_b128 a[72:75], v4 offset:25344
    ds_read_b128 a[76:79], v5 offset:25344
    v_perm_b32 v28, v229, v225, s41
    v_mfma_f32_16x16x32_bf16 v[68:71], v[20:23], a[36:39], v[68:71]
    v_perm_b32 v29, v237, v233, s41
    v_mfma_f32_16x16x32_bf16 a[164:167], v[20:23], a[40:43], a[164:167]
    global_load_dword a253, v10, s[12:13]
    global_load_dword a252, v11, s[14:15]
    v_perm_b32 v30, v245, v241, s41
    v_mfma_f32_16x16x32_bf16 a[220:223], v[20:23], a[44:47], a[220:223]
    v_perm_b32 v31, v253, v249, s41
    v_mfma_f32_16x16x32_bf16 v[40:43], v[24:27], a[32:35], v[40:43]
    global_load_dwordx4 v[172:175], v0, s[10:11] offset:2048
    v_perm_b32 v16, v230, v226, s40
    v_mfma_f32_16x16x32_bf16 v[72:75], v[24:27], a[36:39], v[72:75]
    v_perm_b32 v17, v238, v234, s40
    v_mfma_f32_16x16x32_bf16 a[168:171], v[24:27], a[40:43], a[168:171]
    ds_read_b128 v[8:11], v6 offset:33792
    v_perm_b32 v18, v246, v242, s40
    v_mfma_f32_16x16x32_bf16 a[224:227], v[24:27], a[44:47], a[224:227]
    v_perm_b32 v19, v254, v250, s40
    v_mfma_f32_16x16x32_bf16 v[44:47], v[28:31], a[32:35], v[44:47]
    global_load_dwordx4 v[176:179], v0, s[20:21] offset:-4096
    v_perm_b32 v20, v230, v226, s41
    v_mfma_f32_16x16x32_bf16 v[76:79], v[28:31], a[36:39], v[76:79]
    v_perm_b32 v21, v238, v234, s41
    v_mfma_f32_16x16x32_bf16 a[172:175], v[28:31], a[40:43], a[172:175]
    v_perm_b32 v22, v246, v242, s41
    v_mfma_f32_16x16x32_bf16 a[228:231], v[28:31], a[44:47], a[228:231]
    v_perm_b32 v23, v254, v250, s41
    v_mfma_f32_16x16x32_bf16 v[48:51], v[16:19], a[32:35], v[48:51]
    global_load_dwordx4 v[180:183], v0, s[20:21] offset:-2048
    v_perm_b32 v24, v231, v227, s40
    v_mfma_f32_16x16x32_bf16 v[80:83], v[16:19], a[36:39], v[80:83]
    v_perm_b32 v25, v239, v235, s40
    v_mfma_f32_16x16x32_bf16 a[176:179], v[16:19], a[40:43], a[176:179]
    v_perm_b32 v26, v247, v243, s40
    v_mfma_f32_16x16x32_bf16 a[232:235], v[16:19], a[44:47], a[232:235]
    v_perm_b32 v27, v255, v251, s40
    v_mfma_f32_16x16x32_bf16 v[52:55], v[20:23], a[32:35], v[52:55]
    global_load_dwordx4 v[184:187], v0, s[20:21] offset:0
    v_perm_b32 v28, v231, v227, s41
    v_mfma_f32_16x16x32_bf16 v[84:87], v[20:23], a[36:39], v[84:87]
    v_perm_b32 v29, v239, v235, s41
    v_mfma_f32_16x16x32_bf16 a[180:183], v[20:23], a[40:43], a[180:183]
    v_perm_b32 v30, v247, v243, s41
    v_mfma_f32_16x16x32_bf16 a[236:239], v[20:23], a[44:47], a[236:239]
    v_perm_b32 v31, v255, v251, s41
    v_mfma_f32_16x16x32_bf16 v[56:59], v[24:27], a[32:35], v[56:59]
    global_load_dwordx4 v[188:191], v0, s[20:21] offset:2048
    s_waitcnt vmcnt(18)
    v_perm_b32 v16, v100, v96, s40
    v_mfma_f32_16x16x32_bf16 v[88:91], v[24:27], a[36:39], v[88:91]
    v_perm_b32 v17, v108, v104, s40
    v_mfma_f32_16x16x32_bf16 a[184:187], v[24:27], a[40:43], a[184:187]
    v_perm_b32 v18, v116, v112, s40
    s_waitcnt lgkmcnt(0)
    v_lshlrev_b32 v2, 16, v8
    v_mfma_f32_16x16x32_bf16 a[240:243], v[24:27], a[44:47], a[240:243]
    v_perm_b32 v19, v124, v120, s40
    v_and_b32 v3, s42, v8
    v_mfma_f32_16x16x32_bf16 v[60:63], v[28:31], a[32:35], v[60:63]
    v_add_u32 v0, 65536, v0
    global_load_dwordx4 v[192:195], v0, s[10:11] offset:-4096
    v_perm_b32 v20, v100, v96, s41
    v_mul_f32 v2, s52, v2
    v_mfma_f32_16x16x32_bf16 v[92:95], v[28:31], a[36:39], v[92:95]
    v_perm_b32 v21, v108, v104, s41
    v_mfma_f32_16x16x32_bf16 a[188:191], v[28:31], a[40:43], a[188:191]
    v_perm_b32 v22, v116, v112, s41
    v_mul_f32 v3, s52, v3
    v_mfma_f32_16x16x32_bf16 a[244:247], v[28:31], a[44:47], a[244:247]
    v_perm_b32 v23, v124, v120, s41
    v_accvgpr_write_b32 a0, v2
    v_mfma_f32_16x16x32_bf16 v[32:35], v[16:19], a[48:51], v[32:35]
    global_load_dwordx4 v[196:199], v0, s[10:11] offset:-2048
    v_perm_b32 v24, v101, v97, s40
    v_accvgpr_write_b32 a4, v3
    v_mfma_f32_16x16x32_bf16 v[64:67], v[16:19], a[52:55], v[64:67]
    ds_read_b128 a[80:83], v4 offset:10560
    ds_read_b128 a[84:87], v5 offset:10560
    v_perm_b32 v25, v109, v105, s40
    v_mfma_f32_16x16x32_bf16 a[160:163], v[16:19], a[56:59], a[160:163]
    v_perm_b32 v26, v117, v113, s40
    v_lshlrev_b32 v2, 16, v9
    v_mfma_f32_16x16x32_bf16 a[216:219], v[16:19], a[60:63], a[216:219]
    v_perm_b32 v27, v125, v121, s40
    v_and_b32 v3, s42, v9
    v_mfma_f32_16x16x32_bf16 v[36:39], v[20:23], a[48:51], v[36:39]
    global_load_dwordx4 v[200:203], v0, s[10:11] offset:0
    ds_read_b128 a[88:91], v4 offset:27456
    ds_read_b128 a[92:95], v5 offset:27456
    v_perm_b32 v28, v101, v97, s41
    v_mul_f32 v2, s52, v2
    v_mfma_f32_16x16x32_bf16 v[68:71], v[20:23], a[52:55], v[68:71]
    v_perm_b32 v29, v109, v105, s41
    v_mul_f32 v3, s52, v3
    v_mfma_f32_16x16x32_bf16 a[164:167], v[20:23], a[56:59], a[164:167]
    v_perm_b32 v30, v117, v113, s41
    v_mfma_f32_16x16x32_bf16 a[220:223], v[20:23], a[60:63], a[220:223]
    v_perm_b32 v31, v125, v121, s41
    v_accvgpr_write_b32 a8, v2
    v_mfma_f32_16x16x32_bf16 v[40:43], v[24:27], a[48:51], v[40:43]
    global_load_dwordx4 v[204:207], v0, s[10:11] offset:2048
    v_perm_b32 v16, v102, v98, s40
    v_accvgpr_write_b32 a12, v3
    v_mfma_f32_16x16x32_bf16 v[72:75], v[24:27], a[52:55], v[72:75]
    v_perm_b32 v17, v110, v106, s40
    v_lshlrev_b32 v2, 16, v10
    v_mfma_f32_16x16x32_bf16 a[168:171], v[24:27], a[56:59], a[168:171]
    ds_read_b128 v[12:15], v6 offset:34320
    v_perm_b32 v18, v118, v114, s40
    v_mfma_f32_16x16x32_bf16 a[224:227], v[24:27], a[60:63], a[224:227]
    v_perm_b32 v19, v126, v122, s40
    v_and_b32 v3, s42, v10
    v_mfma_f32_16x16x32_bf16 v[44:47], v[28:31], a[48:51], v[44:47]
    global_load_dwordx4 v[208:211], v0, s[20:21] offset:-4096
    v_perm_b32 v20, v102, v98, s41
    v_mul_f32 v2, s52, v2
    v_mfma_f32_16x16x32_bf16 v[76:79], v[28:31], a[52:55], v[76:79]
    v_perm_b32 v21, v110, v106, s41
    v_mul_f32 v3, s52, v3
    v_mfma_f32_16x16x32_bf16 a[172:175], v[28:31], a[56:59], a[172:175]
    v_perm_b32 v22, v118, v114, s41
    v_accvgpr_write_b32 a16, v2
    v_mfma_f32_16x16x32_bf16 a[228:231], v[28:31], a[60:63], a[228:231]
    v_perm_b32 v23, v126, v122, s41
    v_mfma_f32_16x16x32_bf16 v[48:51], v[16:19], a[48:51], v[48:51]
    global_load_dwordx4 v[212:215], v0, s[20:21] offset:-2048
    v_perm_b32 v24, v103, v99, s40
    v_accvgpr_write_b32 a20, v3
    v_mfma_f32_16x16x32_bf16 v[80:83], v[16:19], a[52:55], v[80:83]
    v_perm_b32 v25, v111, v107, s40
    v_lshlrev_b32 v2, 16, v11
    v_mfma_f32_16x16x32_bf16 a[176:179], v[16:19], a[56:59], a[176:179]
    v_perm_b32 v26, v119, v115, s40
    v_and_b32 v3, s42, v11
    v_mfma_f32_16x16x32_bf16 a[232:235], v[16:19], a[60:63], a[232:235]
    v_perm_b32 v27, v127, v123, s40
    v_mfma_f32_16x16x32_bf16 v[52:55], v[20:23], a[48:51], v[52:55]
    global_load_dwordx4 v[216:219], v0, s[20:21] offset:0
    v_perm_b32 v28, v103, v99, s41
    v_mul_f32 v2, s52, v2
    v_mfma_f32_16x16x32_bf16 v[84:87], v[20:23], a[52:55], v[84:87]
    v_perm_b32 v29, v111, v107, s41
    v_mul_f32 v3, s52, v3
    v_mfma_f32_16x16x32_bf16 a[180:183], v[20:23], a[56:59], a[180:183]
    v_perm_b32 v30, v119, v115, s41
    v_accvgpr_write_b32 a24, v2
    v_mfma_f32_16x16x32_bf16 a[236:239], v[20:23], a[60:63], a[236:239]
    v_perm_b32 v31, v127, v123, s41
    v_accvgpr_write_b32 a28, v3
    v_mfma_f32_16x16x32_bf16 v[56:59], v[24:27], a[48:51], v[56:59]
    global_load_dwordx4 v[220:223], v0, s[20:21] offset:2048
    s_waitcnt vmcnt(18)
    v_perm_b32 v16, v132, v128, s40
    v_mfma_f32_16x16x32_bf16 v[88:91], v[24:27], a[52:55], v[88:91]
    v_perm_b32 v17, v140, v136, s40
    v_mfma_f32_16x16x32_bf16 a[184:187], v[24:27], a[56:59], a[184:187]
    v_perm_b32 v18, v148, v144, s40
    s_waitcnt lgkmcnt(0)
    v_lshlrev_b32 v2, 16, v12
    v_mfma_f32_16x16x32_bf16 a[240:243], v[24:27], a[60:63], a[240:243]
    v_perm_b32 v19, v156, v152, s40
    v_and_b32 v3, s42, v12
    v_mfma_f32_16x16x32_bf16 v[60:63], v[28:31], a[48:51], v[60:63]
    v_add_u32 v0, 65536, v0
    global_load_dwordx4 v[224:227], v0, s[10:11] offset:-4096
    v_perm_b32 v20, v132, v128, s41
    v_mul_f32 v2, s52, v2
    v_mfma_f32_16x16x32_bf16 v[92:95], v[28:31], a[52:55], v[92:95]
    v_perm_b32 v21, v140, v136, s41
    v_mfma_f32_16x16x32_bf16 a[188:191], v[28:31], a[56:59], a[188:191]
    v_perm_b32 v22, v148, v144, s41
    v_mul_f32 v3, s52, v3
    v_mfma_f32_16x16x32_bf16 a[244:247], v[28:31], a[60:63], a[244:247]
    v_perm_b32 v23, v156, v152, s41
    v_accvgpr_write_b32 a1, v2
    v_mfma_f32_16x16x32_bf16 v[32:35], v[16:19], a[64:67], v[32:35]
    global_load_dwordx4 v[228:231], v0, s[10:11] offset:-2048
    v_perm_b32 v24, v133, v129, s40
    v_accvgpr_write_b32 a5, v3
    v_mfma_f32_16x16x32_bf16 v[64:67], v[16:19], a[68:71], v[64:67]
    ds_read_b128 a[96:99], v4 offset:12672
    ds_read_b128 a[100:103], v5 offset:12672
    v_perm_b32 v25, v141, v137, s40
    v_mfma_f32_16x16x32_bf16 a[160:163], v[16:19], a[72:75], a[160:163]
    v_perm_b32 v26, v149, v145, s40
    v_lshlrev_b32 v2, 16, v13
    v_mfma_f32_16x16x32_bf16 a[216:219], v[16:19], a[76:79], a[216:219]
    v_perm_b32 v27, v157, v153, s40
    v_and_b32 v3, s42, v13
    v_mfma_f32_16x16x32_bf16 v[36:39], v[20:23], a[64:67], v[36:39]
    global_load_dwordx4 v[232:235], v0, s[10:11] offset:0
    ds_read_b128 a[104:107], v4 offset:29568
    ds_read_b128 a[108:111], v5 offset:29568
    v_perm_b32 v28, v133, v129, s41
    v_mul_f32 v2, s52, v2
    v_mfma_f32_16x16x32_bf16 v[68:71], v[20:23], a[68:71], v[68:71]
    v_perm_b32 v29, v141, v137, s41
    v_mul_f32 v3, s52, v3
    v_mfma_f32_16x16x32_bf16 a[164:167], v[20:23], a[72:75], a[164:167]
    v_perm_b32 v30, v149, v145, s41
    v_mfma_f32_16x16x32_bf16 a[220:223], v[20:23], a[76:79], a[220:223]
    v_perm_b32 v31, v157, v153, s41
    v_accvgpr_write_b32 a9, v2
    v_mfma_f32_16x16x32_bf16 v[40:43], v[24:27], a[64:67], v[40:43]
    global_load_dwordx4 v[236:239], v0, s[10:11] offset:2048
    v_perm_b32 v16, v134, v130, s40
    v_accvgpr_write_b32 a13, v3
    v_mfma_f32_16x16x32_bf16 v[72:75], v[24:27], a[68:71], v[72:75]
    v_perm_b32 v17, v142, v138, s40
    v_lshlrev_b32 v2, 16, v14
    v_mfma_f32_16x16x32_bf16 a[168:171], v[24:27], a[72:75], a[168:171]
    ds_read_b128 v[8:11], v6 offset:34848
    v_perm_b32 v18, v150, v146, s40
    v_mfma_f32_16x16x32_bf16 a[224:227], v[24:27], a[76:79], a[224:227]
    v_perm_b32 v19, v158, v154, s40
    v_and_b32 v3, s42, v14
    v_mfma_f32_16x16x32_bf16 v[44:47], v[28:31], a[64:67], v[44:47]
    global_load_dwordx4 v[240:243], v0, s[20:21] offset:-4096
    v_perm_b32 v20, v134, v130, s41
    v_mul_f32 v2, s52, v2
    v_mfma_f32_16x16x32_bf16 v[76:79], v[28:31], a[68:71], v[76:79]
    v_perm_b32 v21, v142, v138, s41
    v_mul_f32 v3, s52, v3
    v_mfma_f32_16x16x32_bf16 a[172:175], v[28:31], a[72:75], a[172:175]
    v_perm_b32 v22, v150, v146, s41
    v_accvgpr_write_b32 a17, v2
    v_mfma_f32_16x16x32_bf16 a[228:231], v[28:31], a[76:79], a[228:231]
    v_perm_b32 v23, v158, v154, s41
    v_mfma_f32_16x16x32_bf16 v[48:51], v[16:19], a[64:67], v[48:51]
    global_load_dwordx4 v[244:247], v0, s[20:21] offset:-2048
    v_perm_b32 v24, v135, v131, s40
    v_accvgpr_write_b32 a21, v3
    v_mfma_f32_16x16x32_bf16 v[80:83], v[16:19], a[68:71], v[80:83]
    v_perm_b32 v25, v143, v139, s40
    v_lshlrev_b32 v2, 16, v15
    v_mfma_f32_16x16x32_bf16 a[176:179], v[16:19], a[72:75], a[176:179]
    v_perm_b32 v26, v151, v147, s40
    v_and_b32 v3, s42, v15
    v_mfma_f32_16x16x32_bf16 a[232:235], v[16:19], a[76:79], a[232:235]
    v_perm_b32 v27, v159, v155, s40
    v_mfma_f32_16x16x32_bf16 v[52:55], v[20:23], a[64:67], v[52:55]
    global_load_dwordx4 v[248:251], v0, s[20:21] offset:0
    v_perm_b32 v28, v135, v131, s41
    v_mul_f32 v2, s52, v2
    v_mfma_f32_16x16x32_bf16 v[84:87], v[20:23], a[68:71], v[84:87]
    v_perm_b32 v29, v143, v139, s41
    v_mul_f32 v3, s52, v3
    v_mfma_f32_16x16x32_bf16 a[180:183], v[20:23], a[72:75], a[180:183]
    v_perm_b32 v30, v151, v147, s41
    v_accvgpr_write_b32 a25, v2
    v_mfma_f32_16x16x32_bf16 a[236:239], v[20:23], a[76:79], a[236:239]
    v_perm_b32 v31, v159, v155, s41
    v_accvgpr_write_b32 a29, v3
    v_mfma_f32_16x16x32_bf16 v[56:59], v[24:27], a[64:67], v[56:59]
    global_load_dwordx4 v[252:255], v0, s[20:21] offset:2048
    s_waitcnt vmcnt(16)
    v_perm_b32 v16, v164, v160, s40
    v_mfma_f32_16x16x32_bf16 v[88:91], v[24:27], a[68:71], v[88:91]
    v_perm_b32 v17, v172, v168, s40
    v_mfma_f32_16x16x32_bf16 a[184:187], v[24:27], a[72:75], a[184:187]
    v_perm_b32 v18, v180, v176, s40
    s_waitcnt lgkmcnt(0)
    v_lshlrev_b32 v2, 16, v8
    v_mfma_f32_16x16x32_bf16 a[240:243], v[24:27], a[76:79], a[240:243]
    v_perm_b32 v19, v188, v184, s40
    v_and_b32 v3, s42, v8
    v_mfma_f32_16x16x32_bf16 v[60:63], v[28:31], a[64:67], v[60:63]
    v_accvgpr_read_b32 v0, a200
    global_load_dwordx4 v[96:99], v0, s[12:13] offset:0
    v_perm_b32 v20, v164, v160, s41
    v_mul_f32 v2, s52, v2
    v_mfma_f32_16x16x32_bf16 v[92:95], v[28:31], a[68:71], v[92:95]
    v_perm_b32 v21, v172, v168, s41
    v_mfma_f32_16x16x32_bf16 a[188:191], v[28:31], a[72:75], a[188:191]
    v_perm_b32 v22, v180, v176, s41
    v_mul_f32 v3, s52, v3
    v_mfma_f32_16x16x32_bf16 a[244:247], v[28:31], a[76:79], a[244:247]
    v_perm_b32 v23, v188, v184, s41
    v_accvgpr_write_b32 a2, v2
    v_mfma_f32_16x16x32_bf16 v[32:35], v[16:19], a[80:83], v[32:35]
    global_load_dwordx4 v[100:103], v0, s[12:13] offset:512
    v_perm_b32 v24, v165, v161, s40
    v_accvgpr_write_b32 a6, v3
    v_mfma_f32_16x16x32_bf16 v[64:67], v[16:19], a[84:87], v[64:67]
    ds_read_b128 a[112:115], v4 offset:14784
    ds_read_b128 a[116:119], v5 offset:14784
    v_perm_b32 v25, v173, v169, s40
    v_mfma_f32_16x16x32_bf16 a[160:163], v[16:19], a[88:91], a[160:163]
    v_perm_b32 v26, v181, v177, s40
    v_lshlrev_b32 v2, 16, v9
    v_mfma_f32_16x16x32_bf16 a[216:219], v[16:19], a[92:95], a[216:219]
    v_perm_b32 v27, v189, v185, s40
    v_and_b32 v3, s42, v9
    v_mfma_f32_16x16x32_bf16 v[36:39], v[20:23], a[80:83], v[36:39]
    global_load_dwordx4 v[104:107], v0, s[12:13] offset:1024
    ds_read_b128 a[120:123], v4 offset:31680
    ds_read_b128 a[124:127], v5 offset:31680
    v_perm_b32 v28, v165, v161, s41
    v_mul_f32 v2, s52, v2
    v_mfma_f32_16x16x32_bf16 v[68:71], v[20:23], a[84:87], v[68:71]
    v_perm_b32 v29, v173, v169, s41
    v_mul_f32 v3, s52, v3
    v_mfma_f32_16x16x32_bf16 a[164:167], v[20:23], a[88:91], a[164:167]
    v_perm_b32 v30, v181, v177, s41
    v_mfma_f32_16x16x32_bf16 a[220:223], v[20:23], a[92:95], a[220:223]
    v_perm_b32 v31, v189, v185, s41
    v_accvgpr_write_b32 a10, v2
    v_mfma_f32_16x16x32_bf16 v[40:43], v[24:27], a[80:83], v[40:43]
    global_load_dwordx4 v[108:111], v0, s[12:13] offset:1536
    v_perm_b32 v16, v166, v162, s40
    v_accvgpr_write_b32 a14, v3
    v_mfma_f32_16x16x32_bf16 v[72:75], v[24:27], a[84:87], v[72:75]
    v_perm_b32 v17, v174, v170, s40
    v_lshlrev_b32 v2, 16, v10
    v_mfma_f32_16x16x32_bf16 a[168:171], v[24:27], a[88:91], a[168:171]
    ds_read_b128 v[12:15], v6 offset:35376
    v_perm_b32 v18, v182, v178, s40
    v_mfma_f32_16x16x32_bf16 a[224:227], v[24:27], a[92:95], a[224:227]
    v_perm_b32 v19, v190, v186, s40
    v_and_b32 v3, s42, v10
    v_mfma_f32_16x16x32_bf16 v[44:47], v[28:31], a[80:83], v[44:47]
    global_load_dwordx4 v[112:115], v0, s[12:13] offset:2048
    v_perm_b32 v20, v166, v162, s41
    v_mul_f32 v2, s52, v2
    v_mfma_f32_16x16x32_bf16 v[76:79], v[28:31], a[84:87], v[76:79]
    v_perm_b32 v21, v174, v170, s41
    v_mul_f32 v3, s52, v3
    v_mfma_f32_16x16x32_bf16 a[172:175], v[28:31], a[88:91], a[172:175]
    v_perm_b32 v22, v182, v178, s41
    v_accvgpr_write_b32 a18, v2
    v_mfma_f32_16x16x32_bf16 a[228:231], v[28:31], a[92:95], a[228:231]
    v_perm_b32 v23, v190, v186, s41
    v_mfma_f32_16x16x32_bf16 v[48:51], v[16:19], a[80:83], v[48:51]
    global_load_dwordx4 v[116:119], v0, s[12:13] offset:2560
    v_perm_b32 v24, v167, v163, s40
    v_accvgpr_write_b32 a22, v3
    v_mfma_f32_16x16x32_bf16 v[80:83], v[16:19], a[84:87], v[80:83]
    v_perm_b32 v25, v175, v171, s40
    v_lshlrev_b32 v2, 16, v11
    v_mfma_f32_16x16x32_bf16 a[176:179], v[16:19], a[88:91], a[176:179]
    v_perm_b32 v26, v183, v179, s40
    v_and_b32 v3, s42, v11
    v_mfma_f32_16x16x32_bf16 a[232:235], v[16:19], a[92:95], a[232:235]
    v_perm_b32 v27, v191, v187, s40
    v_mfma_f32_16x16x32_bf16 v[52:55], v[20:23], a[80:83], v[52:55]
    global_load_dwordx4 v[120:123], v0, s[12:13] offset:3072
    v_perm_b32 v28, v167, v163, s41
    v_mul_f32 v2, s52, v2
    v_mfma_f32_16x16x32_bf16 v[84:87], v[20:23], a[84:87], v[84:87]
    v_perm_b32 v29, v175, v171, s41
    v_mul_f32 v3, s52, v3
    v_mfma_f32_16x16x32_bf16 a[180:183], v[20:23], a[88:91], a[180:183]
    v_perm_b32 v30, v183, v179, s41
    v_accvgpr_write_b32 a26, v2
    v_mfma_f32_16x16x32_bf16 a[236:239], v[20:23], a[92:95], a[236:239]
    v_perm_b32 v31, v191, v187, s41
    v_accvgpr_write_b32 a30, v3
    v_mfma_f32_16x16x32_bf16 v[56:59], v[24:27], a[80:83], v[56:59]
    global_load_dwordx4 v[124:127], v0, s[12:13] offset:3584
    s_waitcnt vmcnt(16)
    v_perm_b32 v16, v196, v192, s40
    v_mfma_f32_16x16x32_bf16 v[88:91], v[24:27], a[84:87], v[88:91]
    v_perm_b32 v17, v204, v200, s40
    v_mfma_f32_16x16x32_bf16 a[184:187], v[24:27], a[88:91], a[184:187]
    v_perm_b32 v18, v212, v208, s40
    s_waitcnt lgkmcnt(0)
    v_lshlrev_b32 v2, 16, v12
    v_mfma_f32_16x16x32_bf16 a[240:243], v[24:27], a[92:95], a[240:243]
    v_perm_b32 v19, v220, v216, s40
    v_and_b32 v3, s42, v12
    v_mfma_f32_16x16x32_bf16 v[60:63], v[28:31], a[80:83], v[60:63]
    v_add_u32 v0, 4096, v0
    global_load_dwordx4 v[128:131], v0, s[12:13] offset:0
    v_perm_b32 v20, v196, v192, s41
    v_mul_f32 v2, s52, v2
    v_mfma_f32_16x16x32_bf16 v[92:95], v[28:31], a[84:87], v[92:95]
    v_perm_b32 v21, v204, v200, s41
    v_mfma_f32_16x16x32_bf16 a[188:191], v[28:31], a[88:91], a[188:191]
    v_perm_b32 v22, v212, v208, s41
    v_mul_f32 v3, s52, v3
    v_mfma_f32_16x16x32_bf16 a[244:247], v[28:31], a[92:95], a[244:247]
    v_perm_b32 v23, v220, v216, s41
    v_accvgpr_write_b32 a3, v2
    v_mfma_f32_16x16x32_bf16 v[32:35], v[16:19], a[96:99], v[32:35]
    global_load_dwordx4 v[132:135], v0, s[12:13] offset:512
    v_perm_b32 v24, v197, v193, s40
    v_accvgpr_write_b32 a7, v3
    v_mfma_f32_16x16x32_bf16 v[64:67], v[16:19], a[100:103], v[64:67]
    v_perm_b32 v25, v205, v201, s40
    v_mfma_f32_16x16x32_bf16 a[160:163], v[16:19], a[104:107], a[160:163]
    v_perm_b32 v26, v213, v209, s40
    v_lshlrev_b32 v2, 16, v13
    v_mfma_f32_16x16x32_bf16 a[216:219], v[16:19], a[108:111], a[216:219]
    v_perm_b32 v27, v221, v217, s40
    v_and_b32 v3, s42, v13
    v_mfma_f32_16x16x32_bf16 v[36:39], v[20:23], a[96:99], v[36:39]
    global_load_dwordx4 v[136:139], v0, s[12:13] offset:1024
    v_perm_b32 v28, v197, v193, s41
    v_mul_f32 v2, s52, v2
    v_mfma_f32_16x16x32_bf16 v[68:71], v[20:23], a[100:103], v[68:71]
    v_perm_b32 v29, v205, v201, s41
    v_mul_f32 v3, s52, v3
    v_mfma_f32_16x16x32_bf16 a[164:167], v[20:23], a[104:107], a[164:167]
    v_perm_b32 v30, v213, v209, s41
    v_mfma_f32_16x16x32_bf16 a[220:223], v[20:23], a[108:111], a[220:223]
    v_perm_b32 v31, v221, v217, s41
    v_accvgpr_write_b32 a11, v2
    v_mfma_f32_16x16x32_bf16 v[40:43], v[24:27], a[96:99], v[40:43]
    global_load_dwordx4 v[140:143], v0, s[12:13] offset:1536
    v_perm_b32 v16, v198, v194, s40
    v_accvgpr_write_b32 a15, v3
    v_mfma_f32_16x16x32_bf16 v[72:75], v[24:27], a[100:103], v[72:75]
    v_perm_b32 v17, v206, v202, s40
    v_lshlrev_b32 v2, 16, v14
    v_mfma_f32_16x16x32_bf16 a[168:171], v[24:27], a[104:107], a[168:171]
    v_perm_b32 v18, v214, v210, s40
    v_mfma_f32_16x16x32_bf16 a[224:227], v[24:27], a[108:111], a[224:227]
    v_perm_b32 v19, v222, v218, s40
    v_and_b32 v3, s42, v14
    v_mfma_f32_16x16x32_bf16 v[44:47], v[28:31], a[96:99], v[44:47]
    global_load_dwordx4 v[144:147], v0, s[12:13] offset:2048
    v_perm_b32 v20, v198, v194, s41
    v_mul_f32 v2, s52, v2
    v_mfma_f32_16x16x32_bf16 v[76:79], v[28:31], a[100:103], v[76:79]
    v_perm_b32 v21, v206, v202, s41
    v_mul_f32 v3, s52, v3
    v_mfma_f32_16x16x32_bf16 a[172:175], v[28:31], a[104:107], a[172:175]
    v_perm_b32 v22, v214, v210, s41
    v_accvgpr_write_b32 a19, v2
    v_mfma_f32_16x16x32_bf16 a[228:231], v[28:31], a[108:111], a[228:231]
    v_perm_b32 v23, v222, v218, s41
    v_mfma_f32_16x16x32_bf16 v[48:51], v[16:19], a[96:99], v[48:51]
    global_load_dwordx4 v[148:151], v0, s[12:13] offset:2560
    v_perm_b32 v24, v199, v195, s40
    v_accvgpr_write_b32 a23, v3
    v_mfma_f32_16x16x32_bf16 v[80:83], v[16:19], a[100:103], v[80:83]
    v_perm_b32 v25, v207, v203, s40
    v_lshlrev_b32 v2, 16, v15
    v_mfma_f32_16x16x32_bf16 a[176:179], v[16:19], a[104:107], a[176:179]
    v_perm_b32 v26, v215, v211, s40
    v_and_b32 v3, s42, v15
    v_mfma_f32_16x16x32_bf16 a[232:235], v[16:19], a[108:111], a[232:235]
    v_perm_b32 v27, v223, v219, s40
    v_mfma_f32_16x16x32_bf16 v[52:55], v[20:23], a[96:99], v[52:55]
    global_load_dwordx4 v[152:155], v0, s[12:13] offset:3072
    v_perm_b32 v28, v199, v195, s41
    v_mul_f32 v2, s52, v2
    v_mfma_f32_16x16x32_bf16 v[84:87], v[20:23], a[100:103], v[84:87]
    v_perm_b32 v29, v207, v203, s41
    v_mul_f32 v3, s52, v3
    v_mfma_f32_16x16x32_bf16 a[180:183], v[20:23], a[104:107], a[180:183]
    v_perm_b32 v30, v215, v211, s41
    v_accvgpr_write_b32 a27, v2
    v_mfma_f32_16x16x32_bf16 a[236:239], v[20:23], a[108:111], a[236:239]
    v_perm_b32 v31, v223, v219, s41
    v_accvgpr_write_b32 a31, v3
    v_mfma_f32_16x16x32_bf16 v[56:59], v[24:27], a[96:99], v[56:59]
    global_load_dwordx4 v[156:159], v0, s[12:13] offset:3584
    s_waitcnt vmcnt(16)
    v_perm_b32 v16, v228, v224, s40
    v_mfma_f32_16x16x32_bf16 v[88:91], v[24:27], a[100:103], v[88:91]
    v_perm_b32 v17, v236, v232, s40
    v_mfma_f32_16x16x32_bf16 a[184:187], v[24:27], a[104:107], a[184:187]
    v_perm_b32 v18, v244, v240, s40
    v_mfma_f32_16x16x32_bf16 a[240:243], v[24:27], a[108:111], a[240:243]
    v_perm_b32 v19, v252, v248, s40
    v_mfma_f32_16x16x32_bf16 v[60:63], v[28:31], a[96:99], v[60:63]
    v_add_u32 v0, 4096, v0
    global_load_dwordx4 v[160:163], v0, s[12:13] offset:0
    v_perm_b32 v20, v228, v224, s41
    v_mfma_f32_16x16x32_bf16 v[92:95], v[28:31], a[100:103], v[92:95]
    v_perm_b32 v21, v236, v232, s41
    v_mfma_f32_16x16x32_bf16 a[188:191], v[28:31], a[104:107], a[188:191]
    v_perm_b32 v22, v244, v240, s41
    v_accvgpr_read_b32 v1, a201
    v_mfma_f32_16x16x32_bf16 a[244:247], v[28:31], a[108:111], a[244:247]
    v_perm_b32 v23, v252, v248, s41
    v_mfma_f32_16x16x32_bf16 v[32:35], v[16:19], a[112:115], v[32:35]
    global_load_dwordx4 v[164:167], v0, s[12:13] offset:512
    v_perm_b32 v24, v229, v225, s40
    v_mfma_f32_16x16x32_bf16 v[64:67], v[16:19], a[116:119], v[64:67]
    v_perm_b32 v25, v237, v233, s40
    v_mfma_f32_16x16x32_bf16 a[160:163], v[16:19], a[120:123], a[160:163]
    v_perm_b32 v26, v245, v241, s40
    v_mfma_f32_16x16x32_bf16 a[216:219], v[16:19], a[124:127], a[216:219]
    v_perm_b32 v27, v253, v249, s40
    v_accvgpr_read_b32 v2, a202
    v_mfma_f32_16x16x32_bf16 v[36:39], v[20:23], a[112:115], v[36:39]
    global_load_dwordx4 v[168:171], v0, s[12:13] offset:1024
    v_perm_b32 v28, v229, v225, s41
    v_mfma_f32_16x16x32_bf16 v[68:71], v[20:23], a[116:119], v[68:71]
    v_perm_b32 v29, v237, v233, s41
    v_mfma_f32_16x16x32_bf16 a[164:167], v[20:23], a[120:123], a[164:167]
    v_perm_b32 v30, v245, v241, s41
    v_mfma_f32_16x16x32_bf16 a[220:223], v[20:23], a[124:127], a[220:223]
    v_perm_b32 v31, v253, v249, s41
    v_mfma_f32_16x16x32_bf16 v[40:43], v[24:27], a[112:115], v[40:43]
    global_load_dwordx4 v[172:175], v0, s[12:13] offset:1536
    v_perm_b32 v16, v230, v226, s40
    v_mbcnt_lo_u32_b32 v3, -1, 0
    v_mfma_f32_16x16x32_bf16 v[72:75], v[24:27], a[116:119], v[72:75]
    v_perm_b32 v17, v238, v234, s40
    v_mfma_f32_16x16x32_bf16 a[168:171], v[24:27], a[120:123], a[168:171]
    v_perm_b32 v18, v246, v242, s40
    v_mfma_f32_16x16x32_bf16 a[224:227], v[24:27], a[124:127], a[224:227]
    v_perm_b32 v19, v254, v250, s40
    v_mfma_f32_16x16x32_bf16 v[44:47], v[28:31], a[112:115], v[44:47]
    global_load_dwordx4 v[176:179], v0, s[12:13] offset:2048
    v_perm_b32 v20, v230, v226, s41
    v_mfma_f32_16x16x32_bf16 v[76:79], v[28:31], a[116:119], v[76:79]
    v_perm_b32 v21, v238, v234, s41
    v_mbcnt_hi_u32_b32 v3, -1, v3
    v_mfma_f32_16x16x32_bf16 a[172:175], v[28:31], a[120:123], a[172:175]
    v_perm_b32 v22, v246, v242, s41
    v_mfma_f32_16x16x32_bf16 a[228:231], v[28:31], a[124:127], a[228:231]
    v_perm_b32 v23, v254, v250, s41
    v_mfma_f32_16x16x32_bf16 v[48:51], v[16:19], a[112:115], v[48:51]
    global_load_dwordx4 v[180:183], v0, s[12:13] offset:2560
    v_perm_b32 v24, v231, v227, s40
    v_mfma_f32_16x16x32_bf16 v[80:83], v[16:19], a[116:119], v[80:83]
    v_perm_b32 v25, v239, v235, s40
    v_mfma_f32_16x16x32_bf16 a[176:179], v[16:19], a[120:123], a[176:179]
    v_perm_b32 v26, v247, v243, s40
    v_min_u32 v3, 23, v3
    v_mfma_f32_16x16x32_bf16 a[232:235], v[16:19], a[124:127], a[232:235]
    v_perm_b32 v27, v255, v251, s40
    v_mfma_f32_16x16x32_bf16 v[52:55], v[20:23], a[112:115], v[52:55]
    global_load_dwordx4 v[184:187], v0, s[12:13] offset:3072
    v_perm_b32 v28, v231, v227, s41
    v_mfma_f32_16x16x32_bf16 v[84:87], v[20:23], a[116:119], v[84:87]
    v_perm_b32 v29, v239, v235, s41
    v_mfma_f32_16x16x32_bf16 a[180:183], v[20:23], a[120:123], a[180:183]
    v_perm_b32 v30, v247, v243, s41
    v_mfma_f32_16x16x32_bf16 a[236:239], v[20:23], a[124:127], a[236:239]
    v_perm_b32 v31, v255, v251, s41
    v_lshlrev_b32 v3, 2, v3
    v_mfma_f32_16x16x32_bf16 v[56:59], v[24:27], a[112:115], v[56:59]
    global_load_dwordx4 v[188:191], v0, s[12:13] offset:3584
    v_mfma_f32_16x16x32_bf16 v[60:63], v[28:31], a[112:115], v[60:63]
    v_mfma_f32_16x16x32_bf16 v[88:91], v[24:27], a[116:119], v[88:91]
    v_mfma_f32_16x16x32_bf16 v[92:95], v[28:31], a[116:119], v[92:95]
    v_mfma_f32_16x16x32_bf16 a[184:187], v[24:27], a[120:123], a[184:187]
    v_mfma_f32_16x16x32_bf16 a[188:191], v[28:31], a[120:123], a[188:191]
    v_mfma_f32_16x16x32_bf16 a[240:243], v[24:27], a[124:127], a[240:243]
    v_mfma_f32_16x16x32_bf16 a[244:247], v[28:31], a[124:127], a[244:247]
    s_cmp_eq_u32 s3, 0
    s_cselect_b64 exec, -1, 0
    global_load_dword v3, v3, s[18:19] sc1
    s_mov_b64 exec, -1
    v_exp_f32 v4, v32
    v_exp_f32 v5, v33
    v_exp_f32 v6, v36
    v_exp_f32 v7, v37
    v_pk_add_f32 v[4:5], v[4:5], s[36:37]
    v_exp_f32 v8, v40
    v_exp_f32 v9, v41
    v_pk_add_f32 v[6:7], v[6:7], s[36:37]
    v_rcp_f32 v4, v4
    v_rcp_f32 v5, v5
    v_exp_f32 v10, v44
    v_exp_f32 v11, v45
    v_pk_add_f32 v[8:9], v[8:9], s[36:37]
    v_rcp_f32 v6, v6
    v_rcp_f32 v7, v7
    v_pk_mul_f32 v[32:33], v[32:33], v[4:5]
    v_exp_f32 v4, v48
    v_exp_f32 v5, v49
    v_pk_add_f32 v[10:11], v[10:11], s[36:37]
    v_rcp_f32 v8, v8
    v_rcp_f32 v9, v9
    v_pk_mul_f32 v[36:37], v[36:37], v[6:7]
    v_cvt_pk_bf16_f32 v12, v32, v36
    v_cvt_pk_bf16_f32 v16, v33, v37
    v_exp_f32 v6, v52
    v_exp_f32 v7, v53
    v_pk_add_f32 v[4:5], v[4:5], s[36:37]
    v_rcp_f32 v10, v10
    v_rcp_f32 v11, v11
    v_pk_mul_f32 v[40:41], v[40:41], v[8:9]
    v_exp_f32 v8, v56
    v_exp_f32 v9, v57
    v_pk_add_f32 v[6:7], v[6:7], s[36:37]
    v_rcp_f32 v4, v4
    v_rcp_f32 v5, v5
    v_pk_mul_f32 v[44:45], v[44:45], v[10:11]
    v_add_u32 v0, 4096, v0
    global_load_dwordx4 v[192:195], v0, s[12:13] offset:0
    v_cvt_pk_bf16_f32 v13, v40, v44
    v_cvt_pk_bf16_f32 v17, v41, v45
    v_exp_f32 v10, v60
    v_exp_f32 v11, v61
    v_pk_add_f32 v[8:9], v[8:9], s[36:37]
    v_rcp_f32 v6, v6
    v_rcp_f32 v7, v7
    v_pk_mul_f32 v[48:49], v[48:49], v[4:5]
    v_exp_f32 v4, v34
    v_exp_f32 v5, v35
    v_pk_add_f32 v[10:11], v[10:11], s[36:37]
    v_rcp_f32 v8, v8
    global_load_dwordx4 v[196:199], v0, s[12:13] offset:512
    v_rcp_f32 v9, v9
    v_pk_mul_f32 v[52:53], v[52:53], v[6:7]
    v_cvt_pk_bf16_f32 v14, v48, v52
    v_cvt_pk_bf16_f32 v18, v49, v53
    v_exp_f32 v6, v38
    v_exp_f32 v7, v39
    v_pk_add_f32 v[4:5], v[4:5], s[36:37]
    v_rcp_f32 v10, v10
    v_rcp_f32 v11, v11
    v_pk_mul_f32 v[56:57], v[56:57], v[8:9]
    v_exp_f32 v8, v42
    v_exp_f32 v9, v43
    global_load_dwordx4 v[200:203], v0, s[12:13] offset:1024
    v_pk_add_f32 v[6:7], v[6:7], s[36:37]
    v_rcp_f32 v4, v4
    v_rcp_f32 v5, v5
    v_pk_mul_f32 v[60:61], v[60:61], v[10:11]
    v_cvt_pk_bf16_f32 v15, v56, v60
    v_cvt_pk_bf16_f32 v19, v57, v61
    ds_write_b128 v1, v[12:15] offset:0
    ds_write_b128 v1, v[16:19] offset:4096
    v_exp_f32 v10, v46
    v_exp_f32 v11, v47
    global_load_dwordx4 v[204:207], v0, s[12:13] offset:1536
    v_pk_add_f32 v[8:9], v[8:9], s[36:37]
    v_rcp_f32 v6, v6
    v_rcp_f32 v7, v7
    v_pk_mul_f32 v[34:35], v[34:35], v[4:5]
    v_exp_f32 v4, v50
    v_exp_f32 v5, v51
    v_pk_add_f32 v[10:11], v[10:11], s[36:37]
    v_rcp_f32 v8, v8
    v_rcp_f32 v9, v9
    v_pk_mul_f32 v[38:39], v[38:39], v[6:7]
    v_cvt_pk_bf16_f32 v12, v34, v38
    v_cvt_pk_bf16_f32 v16, v35, v39
    global_load_dwordx4 v[208:211], v0, s[12:13] offset:2048
    v_exp_f32 v6, v54
    v_exp_f32 v7, v55
    v_pk_add_f32 v[4:5], v[4:5], s[36:37]
    v_rcp_f32 v10, v10
    v_rcp_f32 v11, v11
    v_pk_mul_f32 v[42:43], v[42:43], v[8:9]
    v_exp_f32 v8, v58
    v_exp_f32 v9, v59
    v_pk_add_f32 v[6:7], v[6:7], s[36:37]
    v_rcp_f32 v4, v4
    v_rcp_f32 v5, v5
    global_load_dwordx4 v[212:215], v0, s[12:13] offset:2560
    v_pk_mul_f32 v[46:47], v[46:47], v[10:11]
    v_cvt_pk_bf16_f32 v13, v42, v46
    v_cvt_pk_bf16_f32 v17, v43, v47
    v_exp_f32 v10, v62
    v_exp_f32 v11, v63
    v_pk_add_f32 v[8:9], v[8:9], s[36:37]
    v_rcp_f32 v6, v6
    v_rcp_f32 v7, v7
    v_pk_mul_f32 v[50:51], v[50:51], v[4:5]
    v_exp_f32 v4, v64
    v_exp_f32 v5, v65
    v_pk_add_f32 v[10:11], v[10:11], s[36:37]
    global_load_dwordx4 v[216:219], v0, s[12:13] offset:3072
    v_rcp_f32 v8, v8
    v_rcp_f32 v9, v9
    v_pk_mul_f32 v[54:55], v[54:55], v[6:7]
    v_cvt_pk_bf16_f32 v14, v50, v54
    v_cvt_pk_bf16_f32 v18, v51, v55
    v_exp_f32 v6, v68
    v_exp_f32 v7, v69
    v_pk_add_f32 v[4:5], v[4:5], s[36:37]
    v_rcp_f32 v10, v10
    v_rcp_f32 v11, v11
    v_pk_mul_f32 v[58:59], v[58:59], v[8:9]
    v_exp_f32 v8, v72
    global_load_dwordx4 v[220:223], v0, s[12:13] offset:3584
    v_exp_f32 v9, v73
    v_pk_add_f32 v[6:7], v[6:7], s[36:37]
    v_rcp_f32 v4, v4
    v_rcp_f32 v5, v5
    v_pk_mul_f32 v[62:63], v[62:63], v[10:11]
    v_cvt_pk_bf16_f32 v15, v58, v62
    v_cvt_pk_bf16_f32 v19, v59, v63
    ds_write_b128 v1, v[12:15] offset:8192
    ds_write_b128 v1, v[16:19] offset:12288
    v_exp_f32 v10, v76
    v_add_u32 v0, s28, v0
    global_load_dwordx4 v[224:227], v0, s[12:13] offset:0
    v_exp_f32 v11, v77
    v_pk_add_f32 v[8:9], v[8:9], s[36:37]
    v_rcp_f32 v6, v6
    v_rcp_f32 v7, v7
    v_pk_mul_f32 v[64:65], v[64:65], v[4:5]
    v_exp_f32 v4, v80
    v_exp_f32 v5, v81
    v_pk_add_f32 v[10:11], v[10:11], s[36:37]
    v_rcp_f32 v8, v8
    v_rcp_f32 v9, v9
    v_pk_mul_f32 v[68:69], v[68:69], v[6:7]
    global_load_dwordx4 v[228:231], v0, s[12:13] offset:512
    v_cvt_pk_bf16_f32 v12, v64, v68
    v_cvt_pk_bf16_f32 v16, v65, v69
    v_exp_f32 v6, v84
    v_exp_f32 v7, v85
    v_pk_add_f32 v[4:5], v[4:5], s[36:37]
    v_rcp_f32 v10, v10
    v_rcp_f32 v11, v11
    v_pk_mul_f32 v[72:73], v[72:73], v[8:9]
    v_exp_f32 v8, v88
    v_exp_f32 v9, v89
    v_pk_add_f32 v[6:7], v[6:7], s[36:37]
    v_rcp_f32 v4, v4
    global_load_dwordx4 v[232:235], v0, s[12:13] offset:1024
    v_rcp_f32 v5, v5
    v_pk_mul_f32 v[76:77], v[76:77], v[10:11]
    v_cvt_pk_bf16_f32 v13, v72, v76
    v_cvt_pk_bf16_f32 v17, v73, v77
    v_exp_f32 v10, v92
    v_exp_f32 v11, v93
    v_pk_add_f32 v[8:9], v[8:9], s[36:37]
    v_rcp_f32 v6, v6
    v_rcp_f32 v7, v7
    v_pk_mul_f32 v[80:81], v[80:81], v[4:5]
    v_exp_f32 v4, v66
    v_exp_f32 v5, v67
    global_load_dwordx4 v[236:239], v0, s[12:13] offset:1536
    v_pk_add_f32 v[10:11], v[10:11], s[36:37]
    v_rcp_f32 v8, v8
    v_rcp_f32 v9, v9
    v_pk_mul_f32 v[84:85], v[84:85], v[6:7]
    v_cvt_pk_bf16_f32 v14, v80, v84
    v_cvt_pk_bf16_f32 v18, v81, v85
    v_exp_f32 v6, v70
    v_exp_f32 v7, v71
    v_pk_add_f32 v[4:5], v[4:5], s[36:37]
    v_rcp_f32 v10, v10
    v_rcp_f32 v11, v11
    v_pk_mul_f32 v[88:89], v[88:89], v[8:9]
    global_load_dwordx4 v[240:243], v0, s[12:13] offset:2048
    v_exp_f32 v8, v74
    v_exp_f32 v9, v75
    v_pk_add_f32 v[6:7], v[6:7], s[36:37]
    v_rcp_f32 v4, v4
    v_rcp_f32 v5, v5
    v_pk_mul_f32 v[92:93], v[92:93], v[10:11]
    v_cvt_pk_bf16_f32 v15, v88, v92
    v_cvt_pk_bf16_f32 v19, v89, v93
    ds_write_b128 v1, v[12:15] offset:1024
    ds_write_b128 v1, v[16:19] offset:5120
    global_load_dwordx4 v[244:247], v0, s[12:13] offset:2560
    v_exp_f32 v10, v78
    v_exp_f32 v11, v79
    v_pk_add_f32 v[8:9], v[8:9], s[36:37]
    v_rcp_f32 v6, v6
    v_rcp_f32 v7, v7
    v_pk_mul_f32 v[66:67], v[66:67], v[4:5]
    v_exp_f32 v4, v82
    v_exp_f32 v5, v83
    v_pk_add_f32 v[10:11], v[10:11], s[36:37]
    v_rcp_f32 v8, v8
    v_rcp_f32 v9, v9
    global_load_dwordx4 v[248:251], v0, s[12:13] offset:3072
    v_pk_mul_f32 v[70:71], v[70:71], v[6:7]
    v_cvt_pk_bf16_f32 v12, v66, v70
    v_cvt_pk_bf16_f32 v16, v67, v71
    v_exp_f32 v6, v86
    v_exp_f32 v7, v87
    v_pk_add_f32 v[4:5], v[4:5], s[36:37]
    v_rcp_f32 v10, v10
    v_rcp_f32 v11, v11
    v_pk_mul_f32 v[74:75], v[74:75], v[8:9]
    v_exp_f32 v8, v90
    v_exp_f32 v9, v91
    v_pk_add_f32 v[6:7], v[6:7], s[36:37]
    global_load_dwordx4 v[252:255], v0, s[12:13] offset:3584
    v_rcp_f32 v4, v4
    v_rcp_f32 v5, v5
    v_pk_mul_f32 v[78:79], v[78:79], v[10:11]
    v_cvt_pk_bf16_f32 v13, v74, v78
    v_cvt_pk_bf16_f32 v17, v75, v79
    v_accvgpr_read_b32 v24, a160
    v_accvgpr_read_b32 v25, a161
    v_exp_f32 v10, v94
    v_exp_f32 v11, v95
    v_pk_add_f32 v[8:9], v[8:9], s[36:37]
    v_rcp_f32 v6, v6
    v_rcp_f32 v7, v7
    v_pk_mul_f32 v[82:83], v[82:83], v[4:5]
    v_accvgpr_read_b32 v26, a164
    v_accvgpr_read_b32 v27, a165
    v_exp_f32 v4, v24
    v_exp_f32 v5, v25
    v_pk_add_f32 v[10:11], v[10:11], s[36:37]
    v_rcp_f32 v8, v8
    v_rcp_f32 v9, v9
    v_pk_mul_f32 v[86:87], v[86:87], v[6:7]
    v_cvt_pk_bf16_f32 v14, v82, v86
    v_cvt_pk_bf16_f32 v18, v83, v87
    v_accvgpr_read_b32 v28, a168
    v_accvgpr_read_b32 v29, a169
    v_exp_f32 v6, v26
    v_exp_f32 v7, v27
    v_pk_add_f32 v[4:5], v[4:5], s[36:37]
    v_rcp_f32 v10, v10
    v_rcp_f32 v11, v11
    v_pk_mul_f32 v[90:91], v[90:91], v[8:9]
    v_accvgpr_read_b32 v30, a172
    v_accvgpr_read_b32 v31, a173
    v_exp_f32 v8, v28
    v_exp_f32 v9, v29
    v_pk_add_f32 v[6:7], v[6:7], s[36:37]
    v_rcp_f32 v4, v4
    v_rcp_f32 v5, v5
    v_pk_mul_f32 v[94:95], v[94:95], v[10:11]
    v_cvt_pk_bf16_f32 v15, v90, v94
    v_cvt_pk_bf16_f32 v19, v91, v95
    ds_write_b128 v1, v[12:15] offset:9216
    ds_write_b128 v1, v[16:19] offset:13312
    s_waitcnt vmcnt(16)
    v_cmp_eq_u32 vcc, 0, v3
    v_accvgpr_read_b32 v3, a215
    s_cmp_eq_u32 s3, 0
    s_cselect_b64 s[34:35], vcc, 0
    s_cselect_b32 s33, 1, 0
    s_cmp_eq_u64 s[34:35], 0
    s_cselect_b32 s33, s33, 0
    s_cmp_lg_u32 s33, 0
    s_cselect_b64 exec, 1, 0
    global_load_dword a251, v3, s[16:17] sc1
    s_mov_b64 exec, -1
    v_accvgpr_read_b32 v20, a176
    v_accvgpr_read_b32 v21, a177
    v_exp_f32 v10, v30
    v_exp_f32 v11, v31
    v_pk_add_f32 v[8:9], v[8:9], s[36:37]
    v_rcp_f32 v6, v6
    v_rcp_f32 v7, v7
    v_pk_mul_f32 v[24:25], v[24:25], v[4:5]
    v_accvgpr_read_b32 v22, a180
    v_accvgpr_read_b32 v23, a181
    v_exp_f32 v4, v20
    v_exp_f32 v5, v21
    v_pk_add_f32 v[10:11], v[10:11], s[36:37]
    v_rcp_f32 v8, v8
    v_rcp_f32 v9, v9
    v_pk_mul_f32 v[26:27], v[26:27], v[6:7]
    v_cvt_pk_bf16_f32 v12, v24, v26
    v_cvt_pk_bf16_f32 v16, v25, v27
    v_accvgpr_read_b32 v24, a184
    v_accvgpr_read_b32 v25, a185
    v_exp_f32 v6, v22
    v_exp_f32 v7, v23
    v_pk_add_f32 v[4:5], v[4:5], s[36:37]
    v_rcp_f32 v10, v10
    v_rcp_f32 v11, v11
    v_pk_mul_f32 v[28:29], v[28:29], v[8:9]
    v_accvgpr_read_b32 v26, a188
    v_accvgpr_read_b32 v27, a189
    v_exp_f32 v8, v24
    v_exp_f32 v9, v25
    v_pk_add_f32 v[6:7], v[6:7], s[36:37]
    v_rcp_f32 v4, v4
    v_rcp_f32 v5, v5
    v_pk_mul_f32 v[30:31], v[30:31], v[10:11]
    v_cvt_pk_bf16_f32 v13, v28, v30
    v_cvt_pk_bf16_f32 v17, v29, v31
    v_accvgpr_read_b32 v28, a162
    v_accvgpr_read_b32 v29, a163
    v_exp_f32 v10, v26
    v_exp_f32 v11, v27
    v_pk_add_f32 v[8:9], v[8:9], s[36:37]
    v_rcp_f32 v6, v6
    v_rcp_f32 v7, v7
    v_pk_mul_f32 v[20:21], v[20:21], v[4:5]
    v_accvgpr_read_b32 v30, a166
    v_accvgpr_read_b32 v31, a167
    v_exp_f32 v4, v28
    v_exp_f32 v5, v29
    v_pk_add_f32 v[10:11], v[10:11], s[36:37]
    v_rcp_f32 v8, v8
    v_rcp_f32 v9, v9
    v_pk_mul_f32 v[22:23], v[22:23], v[6:7]
    v_cvt_pk_bf16_f32 v14, v20, v22
    v_cvt_pk_bf16_f32 v18, v21, v23
    v_accvgpr_read_b32 v20, a170
    v_accvgpr_read_b32 v21, a171
    v_exp_f32 v6, v30
    v_exp_f32 v7, v31
    v_pk_add_f32 v[4:5], v[4:5], s[36:37]
    v_rcp_f32 v10, v10
    v_rcp_f32 v11, v11
    v_pk_mul_f32 v[24:25], v[24:25], v[8:9]
    v_accvgpr_read_b32 v22, a174
    v_accvgpr_read_b32 v23, a175
    v_exp_f32 v8, v20
    v_exp_f32 v9, v21
    v_pk_add_f32 v[6:7], v[6:7], s[36:37]
    v_rcp_f32 v4, v4
    v_rcp_f32 v5, v5
    v_pk_mul_f32 v[26:27], v[26:27], v[10:11]
    v_cvt_pk_bf16_f32 v15, v24, v26
    v_cvt_pk_bf16_f32 v19, v25, v27
    ds_write_b128 v1, v[12:15] offset:2048
    ds_write_b128 v1, v[16:19] offset:6144
    v_accvgpr_read_b32 v24, a178
    v_accvgpr_read_b32 v25, a179
    v_exp_f32 v10, v22
    v_exp_f32 v11, v23
    v_pk_add_f32 v[8:9], v[8:9], s[36:37]
    v_rcp_f32 v6, v6
    v_rcp_f32 v7, v7
    v_pk_mul_f32 v[28:29], v[28:29], v[4:5]
    v_accvgpr_read_b32 v26, a182
    v_accvgpr_read_b32 v27, a183
    v_exp_f32 v4, v24
    v_exp_f32 v5, v25
    v_pk_add_f32 v[10:11], v[10:11], s[36:37]
    v_rcp_f32 v8, v8
    v_rcp_f32 v9, v9
    v_pk_mul_f32 v[30:31], v[30:31], v[6:7]
    v_cvt_pk_bf16_f32 v12, v28, v30
    v_cvt_pk_bf16_f32 v16, v29, v31
    v_accvgpr_read_b32 v28, a186
    v_accvgpr_read_b32 v29, a187
    v_exp_f32 v6, v26
    v_exp_f32 v7, v27
    v_pk_add_f32 v[4:5], v[4:5], s[36:37]
    v_rcp_f32 v10, v10
    v_rcp_f32 v11, v11
    v_pk_mul_f32 v[20:21], v[20:21], v[8:9]
    v_accvgpr_read_b32 v30, a190
    v_accvgpr_read_b32 v31, a191
    v_exp_f32 v8, v28
    v_exp_f32 v9, v29
    v_pk_add_f32 v[6:7], v[6:7], s[36:37]
    v_rcp_f32 v4, v4
    v_rcp_f32 v5, v5
    v_pk_mul_f32 v[22:23], v[22:23], v[10:11]
    v_cvt_pk_bf16_f32 v13, v20, v22
    v_cvt_pk_bf16_f32 v17, v21, v23
    v_accvgpr_read_b32 v20, a216
    v_accvgpr_read_b32 v21, a217
    v_exp_f32 v10, v30
    v_exp_f32 v11, v31
    v_pk_add_f32 v[8:9], v[8:9], s[36:37]
    v_rcp_f32 v6, v6
    v_rcp_f32 v7, v7
    v_pk_mul_f32 v[24:25], v[24:25], v[4:5]
    v_accvgpr_read_b32 v22, a220
    v_accvgpr_read_b32 v23, a221
    v_exp_f32 v4, v20
    v_exp_f32 v5, v21
    v_pk_add_f32 v[10:11], v[10:11], s[36:37]
    v_rcp_f32 v8, v8
    v_rcp_f32 v9, v9
    v_pk_mul_f32 v[26:27], v[26:27], v[6:7]
    v_cvt_pk_bf16_f32 v14, v24, v26
    v_cvt_pk_bf16_f32 v18, v25, v27
    v_accvgpr_read_b32 v24, a224
    v_accvgpr_read_b32 v25, a225
    v_exp_f32 v6, v22
    v_exp_f32 v7, v23
    v_pk_add_f32 v[4:5], v[4:5], s[36:37]
    v_rcp_f32 v10, v10
    v_rcp_f32 v11, v11
    v_pk_mul_f32 v[28:29], v[28:29], v[8:9]
    v_accvgpr_read_b32 v26, a228
    v_accvgpr_read_b32 v27, a229
    v_exp_f32 v8, v24
    v_exp_f32 v9, v25
    v_pk_add_f32 v[6:7], v[6:7], s[36:37]
    v_rcp_f32 v4, v4
    v_rcp_f32 v5, v5
    v_pk_mul_f32 v[30:31], v[30:31], v[10:11]
    v_cvt_pk_bf16_f32 v15, v28, v30
    v_cvt_pk_bf16_f32 v19, v29, v31
    ds_write_b128 v1, v[12:15] offset:10240
    ds_write_b128 v1, v[16:19] offset:14336
    v_accvgpr_read_b32 v28, a232
    v_accvgpr_read_b32 v29, a233
    v_exp_f32 v10, v26
    v_exp_f32 v11, v27
    v_pk_add_f32 v[8:9], v[8:9], s[36:37]
    v_rcp_f32 v6, v6
    v_rcp_f32 v7, v7
    v_pk_mul_f32 v[20:21], v[20:21], v[4:5]
    v_accvgpr_read_b32 v30, a236
    v_accvgpr_read_b32 v31, a237
    v_exp_f32 v4, v28
    v_exp_f32 v5, v29
    v_pk_add_f32 v[10:11], v[10:11], s[36:37]
    v_rcp_f32 v8, v8
    v_rcp_f32 v9, v9
    v_pk_mul_f32 v[22:23], v[22:23], v[6:7]
    v_cvt_pk_bf16_f32 v12, v20, v22
    v_cvt_pk_bf16_f32 v16, v21, v23
    v_accvgpr_read_b32 v20, a240
    v_accvgpr_read_b32 v21, a241
    v_exp_f32 v6, v30
    v_exp_f32 v7, v31
    v_pk_add_f32 v[4:5], v[4:5], s[36:37]
    v_rcp_f32 v10, v10
    v_rcp_f32 v11, v11
    v_pk_mul_f32 v[24:25], v[24:25], v[8:9]
    v_accvgpr_read_b32 v22, a244
    v_accvgpr_read_b32 v23, a245
    v_exp_f32 v8, v20
    v_exp_f32 v9, v21
    v_pk_add_f32 v[6:7], v[6:7], s[36:37]
    v_rcp_f32 v4, v4
    v_rcp_f32 v5, v5
    v_pk_mul_f32 v[26:27], v[26:27], v[10:11]
    v_cvt_pk_bf16_f32 v13, v24, v26
    v_cvt_pk_bf16_f32 v17, v25, v27
    v_accvgpr_read_b32 v24, a218
    v_accvgpr_read_b32 v25, a219
    v_exp_f32 v10, v22
    v_exp_f32 v11, v23
    v_pk_add_f32 v[8:9], v[8:9], s[36:37]
    v_rcp_f32 v6, v6
    v_rcp_f32 v7, v7
    v_pk_mul_f32 v[28:29], v[28:29], v[4:5]
    v_accvgpr_read_b32 v26, a222
    v_accvgpr_read_b32 v27, a223
    v_exp_f32 v4, v24
    v_exp_f32 v5, v25
    v_pk_add_f32 v[10:11], v[10:11], s[36:37]
    v_rcp_f32 v8, v8
    v_rcp_f32 v9, v9
    v_pk_mul_f32 v[30:31], v[30:31], v[6:7]
    v_cvt_pk_bf16_f32 v14, v28, v30
    v_cvt_pk_bf16_f32 v18, v29, v31
    v_accvgpr_read_b32 v28, a226
    v_accvgpr_read_b32 v29, a227
    v_exp_f32 v6, v26
    v_exp_f32 v7, v27
    v_pk_add_f32 v[4:5], v[4:5], s[36:37]
    v_rcp_f32 v10, v10
    v_rcp_f32 v11, v11
    v_pk_mul_f32 v[20:21], v[20:21], v[8:9]
    v_accvgpr_read_b32 v30, a230
    v_accvgpr_read_b32 v31, a231
    v_exp_f32 v8, v28
    v_exp_f32 v9, v29
    v_pk_add_f32 v[6:7], v[6:7], s[36:37]
    v_rcp_f32 v4, v4
    v_rcp_f32 v5, v5
    v_pk_mul_f32 v[22:23], v[22:23], v[10:11]
    v_cvt_pk_bf16_f32 v15, v20, v22
    v_cvt_pk_bf16_f32 v19, v21, v23
    ds_write_b128 v1, v[12:15] offset:3072
    ds_write_b128 v1, v[16:19] offset:7168
    ds_read_b128 a[140:143], v1 offset:3072
    ds_read_b128 a[132:135], v1 offset:1024
    ds_read_b128 a[136:139], v1 offset:2048
    ds_read_b128 a[128:131], v1 offset:0
    v_accvgpr_read_b32 v20, a234
    v_accvgpr_read_b32 v21, a235
    v_exp_f32 v10, v30
    v_exp_f32 v11, v31
    v_pk_add_f32 v[8:9], v[8:9], s[36:37]
    v_rcp_f32 v6, v6
    v_rcp_f32 v7, v7
    v_pk_mul_f32 v[24:25], v[24:25], v[4:5]
    v_accvgpr_read_b32 v22, a238
    v_accvgpr_read_b32 v23, a239
    v_exp_f32 v4, v20
    v_exp_f32 v5, v21
    v_pk_add_f32 v[10:11], v[10:11], s[36:37]
    v_rcp_f32 v8, v8
    v_rcp_f32 v9, v9
    v_pk_mul_f32 v[26:27], v[26:27], v[6:7]
    v_cvt_pk_bf16_f32 v12, v24, v26
    v_cvt_pk_bf16_f32 v16, v25, v27
    v_accvgpr_read_b32 v24, a242
    v_accvgpr_read_b32 v25, a243
    v_exp_f32 v6, v22
    v_exp_f32 v7, v23
    v_pk_add_f32 v[4:5], v[4:5], s[36:37]
    v_rcp_f32 v10, v10
    v_rcp_f32 v11, v11
    v_pk_mul_f32 v[28:29], v[28:29], v[8:9]
    v_accvgpr_read_b32 v26, a246
    v_accvgpr_read_b32 v27, a247
    v_exp_f32 v8, v24
    v_exp_f32 v9, v25
    v_pk_add_f32 v[6:7], v[6:7], s[36:37]
    v_rcp_f32 v4, v4
    v_rcp_f32 v5, v5
    v_pk_mul_f32 v[30:31], v[30:31], v[10:11]
    v_cvt_pk_bf16_f32 v13, v28, v30
    v_cvt_pk_bf16_f32 v17, v29, v31
    v_exp_f32 v10, v26
    v_exp_f32 v11, v27
    v_pk_add_f32 v[8:9], v[8:9], s[36:37]
    v_rcp_f32 v6, v6
    v_rcp_f32 v7, v7
    v_pk_mul_f32 v[20:21], v[20:21], v[4:5]
    v_pk_add_f32 v[10:11], v[10:11], s[36:37]
    v_rcp_f32 v8, v8
    v_rcp_f32 v9, v9
    v_pk_mul_f32 v[22:23], v[22:23], v[6:7]
    v_cvt_pk_bf16_f32 v14, v20, v22
    v_cvt_pk_bf16_f32 v18, v21, v23
    v_rcp_f32 v10, v10
    v_rcp_f32 v11, v11
    v_pk_mul_f32 v[24:25], v[24:25], v[8:9]
    v_pk_mul_f32 v[26:27], v[26:27], v[10:11]
    v_cvt_pk_bf16_f32 v15, v24, v26
    v_cvt_pk_bf16_f32 v19, v25, v27
    ds_write_b128 v1, v[12:15] offset:11264
    ds_write_b128 v1, v[16:19] offset:15360
    v_perm_b32 v16, v100, v96, s40
    v_perm_b32 v17, v108, v104, s40
    v_perm_b32 v18, v116, v112, s40
    v_perm_b32 v19, v124, v120, s40
    v_perm_b32 v20, v100, v96, s41
    v_perm_b32 v21, v108, v104, s41
    v_perm_b32 v22, v116, v112, s41
    v_perm_b32 v23, v124, v120, s41
    s_waitcnt lgkmcnt(5)
    v_mfma_f32_16x16x32_bf16 a[32:35], v[16:19], a[140:143], 0
    v_perm_b32 v24, v101, v97, s40
    s_waitcnt lgkmcnt(4)
    v_mfma_f32_16x16x32_bf16 a[0:3], v[16:19], a[132:135], a[0:3]
    v_perm_b32 v25, v109, v105, s40
    s_waitcnt lgkmcnt(3)
    v_mfma_f32_16x16x32_bf16 v[64:67], v[16:19], a[136:139], 0
    v_perm_b32 v26, v117, v113, s40
    s_waitcnt lgkmcnt(2)
    v_mfma_f32_16x16x32_bf16 v[32:35], v[16:19], a[128:131], 0
    v_perm_b32 v27, v125, v121, s40
    v_mfma_f32_16x16x32_bf16 a[36:39], v[20:23], a[140:143], 0
    v_perm_b32 v28, v101, v97, s41
    v_mfma_f32_16x16x32_bf16 a[4:7], v[20:23], a[132:135], a[4:7]
    v_perm_b32 v29, v109, v105, s41
    v_mfma_f32_16x16x32_bf16 v[68:71], v[20:23], a[136:139], 0
    v_perm_b32 v30, v117, v113, s41
    v_mfma_f32_16x16x32_bf16 v[36:39], v[20:23], a[128:131], 0
    v_perm_b32 v31, v125, v121, s41
    v_mfma_f32_16x16x32_bf16 a[40:43], v[24:27], a[140:143], 0
    v_perm_b32 v16, v102, v98, s40
    v_mfma_f32_16x16x32_bf16 a[8:11], v[24:27], a[132:135], a[8:11]
    v_perm_b32 v17, v110, v106, s40
    v_mfma_f32_16x16x32_bf16 v[72:75], v[24:27], a[136:139], 0
    v_perm_b32 v18, v118, v114, s40
    v_mfma_f32_16x16x32_bf16 v[40:43], v[24:27], a[128:131], 0
    v_perm_b32 v19, v126, v122, s40
    v_mfma_f32_16x16x32_bf16 a[44:47], v[28:31], a[140:143], 0
    ds_read_b128 a[156:159], v1 offset:7168
    ds_read_b128 a[148:151], v1 offset:5120
    v_perm_b32 v20, v102, v98, s41
    v_mfma_f32_16x16x32_bf16 a[12:15], v[28:31], a[132:135], a[12:15]
    v_perm_b32 v21, v110, v106, s41
    v_mfma_f32_16x16x32_bf16 v[76:79], v[28:31], a[136:139], 0
    v_perm_b32 v22, v118, v114, s41
    v_mfma_f32_16x16x32_bf16 v[44:47], v[28:31], a[128:131], 0
    ds_read_b128 a[152:155], v1 offset:6144
    ds_read_b128 a[144:147], v1 offset:4096
    v_perm_b32 v23, v126, v122, s41
    v_mfma_f32_16x16x32_bf16 a[48:51], v[16:19], a[140:143], 0
    v_perm_b32 v24, v103, v99, s40
    v_mfma_f32_16x16x32_bf16 a[16:19], v[16:19], a[132:135], a[16:19]
    v_perm_b32 v25, v111, v107, s40
    v_mfma_f32_16x16x32_bf16 v[80:83], v[16:19], a[136:139], 0
    v_perm_b32 v26, v119, v115, s40
    v_mfma_f32_16x16x32_bf16 v[48:51], v[16:19], a[128:131], 0
    v_perm_b32 v27, v127, v123, s40
    v_mfma_f32_16x16x32_bf16 a[52:55], v[20:23], a[140:143], 0
    v_perm_b32 v28, v103, v99, s41
    v_mfma_f32_16x16x32_bf16 a[20:23], v[20:23], a[132:135], a[20:23]
    v_perm_b32 v29, v111, v107, s41
    v_mfma_f32_16x16x32_bf16 v[84:87], v[20:23], a[136:139], 0
    v_perm_b32 v30, v119, v115, s41
    v_mfma_f32_16x16x32_bf16 v[52:55], v[20:23], a[128:131], 0
    v_perm_b32 v31, v127, v123, s41
    v_mfma_f32_16x16x32_bf16 a[56:59], v[24:27], a[140:143], 0
    v_add_u32 v0, 4096, v0
    global_load_dwordx4 v[96:99], v0, s[12:13] offset:0
    v_perm_b32 v16, v132, v128, s40
    v_mfma_f32_16x16x32_bf16 a[24:27], v[24:27], a[132:135], a[24:27]
    v_perm_b32 v17, v140, v136, s40
    v_mfma_f32_16x16x32_bf16 v[88:91], v[24:27], a[136:139], 0
    v_perm_b32 v18, v148, v144, s40
    v_mfma_f32_16x16x32_bf16 v[56:59], v[24:27], a[128:131], 0
    v_perm_b32 v19, v156, v152, s40
    v_mfma_f32_16x16x32_bf16 a[60:63], v[28:31], a[140:143], 0
    v_perm_b32 v20, v132, v128, s41
    v_mfma_f32_16x16x32_bf16 a[28:31], v[28:31], a[132:135], a[28:31]
    global_load_dwordx4 v[100:103], v0, s[12:13] offset:512
    v_perm_b32 v21, v140, v136, s41
    v_mfma_f32_16x16x32_bf16 v[92:95], v[28:31], a[136:139], 0
    v_perm_b32 v22, v148, v144, s41
    v_mfma_f32_16x16x32_bf16 v[60:63], v[28:31], a[128:131], 0
    v_perm_b32 v23, v156, v152, s41
    s_waitcnt lgkmcnt(3)
    v_mfma_f32_16x16x32_bf16 a[32:35], v[16:19], a[156:159], a[32:35]
    v_perm_b32 v24, v133, v129, s40
    s_waitcnt lgkmcnt(2)
    v_mfma_f32_16x16x32_bf16 a[0:3], v[16:19], a[148:151], a[0:3]
    v_perm_b32 v25, v141, v137, s40
    s_waitcnt lgkmcnt(1)
    v_mfma_f32_16x16x32_bf16 v[64:67], v[16:19], a[152:155], v[64:67]
    s_waitcnt lgkmcnt(0)
    s_barrier
    v_perm_b32 v26, v149, v145, s40
    v_mfma_f32_16x16x32_bf16 v[32:35], v[16:19], a[144:147], v[32:35]
    global_load_dwordx4 v[104:107], v0, s[12:13] offset:1024
    v_perm_b32 v27, v157, v153, s40
    v_mfma_f32_16x16x32_bf16 a[36:39], v[20:23], a[156:159], a[36:39]
    v_perm_b32 v28, v133, v129, s41
    v_mfma_f32_16x16x32_bf16 a[4:7], v[20:23], a[148:151], a[4:7]
    v_perm_b32 v29, v141, v137, s41
    v_mfma_f32_16x16x32_bf16 v[68:71], v[20:23], a[152:155], v[68:71]
    v_perm_b32 v30, v149, v145, s41
    v_mfma_f32_16x16x32_bf16 v[36:39], v[20:23], a[144:147], v[36:39]
    v_perm_b32 v31, v157, v153, s41
    v_mfma_f32_16x16x32_bf16 a[40:43], v[24:27], a[156:159], a[40:43]
    v_perm_b32 v16, v134, v130, s40
    v_mfma_f32_16x16x32_bf16 a[8:11], v[24:27], a[148:151], a[8:11]
    global_load_dwordx4 v[108:111], v0, s[12:13] offset:1536
    v_perm_b32 v17, v142, v138, s40
    v_mfma_f32_16x16x32_bf16 v[72:75], v[24:27], a[152:155], v[72:75]
    v_perm_b32 v18, v150, v146, s40
    v_mfma_f32_16x16x32_bf16 v[40:43], v[24:27], a[144:147], v[40:43]
    v_perm_b32 v19, v158, v154, s40
    v_mfma_f32_16x16x32_bf16 a[44:47], v[28:31], a[156:159], a[44:47]
    ds_read_b128 a[172:175], v1 offset:11264
    ds_read_b128 a[164:167], v1 offset:9216
    v_perm_b32 v20, v134, v130, s41
    v_mfma_f32_16x16x32_bf16 a[12:15], v[28:31], a[148:151], a[12:15]
    v_perm_b32 v21, v142, v138, s41
    v_mfma_f32_16x16x32_bf16 v[76:79], v[28:31], a[152:155], v[76:79]
    global_load_dwordx4 v[112:115], v0, s[12:13] offset:2048
    v_perm_b32 v22, v150, v146, s41
    v_mfma_f32_16x16x32_bf16 v[44:47], v[28:31], a[144:147], v[44:47]
    ds_read_b128 a[168:171], v1 offset:10240
    ds_read_b128 a[160:163], v1 offset:8192
    v_perm_b32 v23, v158, v154, s41
    v_mfma_f32_16x16x32_bf16 a[48:51], v[16:19], a[156:159], a[48:51]
    v_perm_b32 v24, v135, v131, s40
    v_mfma_f32_16x16x32_bf16 a[16:19], v[16:19], a[148:151], a[16:19]
    v_perm_b32 v25, v143, v139, s40
    v_mfma_f32_16x16x32_bf16 v[80:83], v[16:19], a[152:155], v[80:83]
    v_perm_b32 v26, v151, v147, s40
    v_mfma_f32_16x16x32_bf16 v[48:51], v[16:19], a[144:147], v[48:51]
    global_load_dwordx4 v[116:119], v0, s[12:13] offset:2560
    v_perm_b32 v27, v159, v155, s40
    v_mfma_f32_16x16x32_bf16 a[52:55], v[20:23], a[156:159], a[52:55]
    v_perm_b32 v28, v135, v131, s41
    v_mfma_f32_16x16x32_bf16 a[20:23], v[20:23], a[148:151], a[20:23]
    v_perm_b32 v29, v143, v139, s41
    v_mfma_f32_16x16x32_bf16 v[84:87], v[20:23], a[152:155], v[84:87]
    v_perm_b32 v30, v151, v147, s41
    v_mfma_f32_16x16x32_bf16 v[52:55], v[20:23], a[144:147], v[52:55]
    v_perm_b32 v31, v159, v155, s41
    v_mfma_f32_16x16x32_bf16 a[56:59], v[24:27], a[156:159], a[56:59]
    v_perm_b32 v16, v164, v160, s40
    v_mfma_f32_16x16x32_bf16 a[24:27], v[24:27], a[148:151], a[24:27]
    global_load_dwordx4 v[120:123], v0, s[12:13] offset:3072
    v_perm_b32 v17, v172, v168, s40
    v_mfma_f32_16x16x32_bf16 v[88:91], v[24:27], a[152:155], v[88:91]
    v_perm_b32 v18, v180, v176, s40
    v_mfma_f32_16x16x32_bf16 v[56:59], v[24:27], a[144:147], v[56:59]
    v_perm_b32 v19, v188, v184, s40
    v_mfma_f32_16x16x32_bf16 a[60:63], v[28:31], a[156:159], a[60:63]
    v_perm_b32 v20, v164, v160, s41
    v_mfma_f32_16x16x32_bf16 a[28:31], v[28:31], a[148:151], a[28:31]
    v_perm_b32 v21, v172, v168, s41
    v_mfma_f32_16x16x32_bf16 v[92:95], v[28:31], a[152:155], v[92:95]
    v_perm_b32 v22, v180, v176, s41
    v_mfma_f32_16x16x32_bf16 v[60:63], v[28:31], a[144:147], v[60:63]
    global_load_dwordx4 v[124:127], v0, s[12:13] offset:3584
    v_perm_b32 v23, v188, v184, s41
    s_waitcnt lgkmcnt(3)
    v_mfma_f32_16x16x32_bf16 a[32:35], v[16:19], a[172:175], a[32:35]
    v_perm_b32 v24, v165, v161, s40
    s_waitcnt lgkmcnt(2)
    v_mfma_f32_16x16x32_bf16 a[0:3], v[16:19], a[164:167], a[0:3]
    v_perm_b32 v25, v173, v169, s40
    s_waitcnt lgkmcnt(1)
    v_mfma_f32_16x16x32_bf16 v[64:67], v[16:19], a[168:171], v[64:67]
    v_perm_b32 v26, v181, v177, s40
    s_waitcnt lgkmcnt(0)
    v_mfma_f32_16x16x32_bf16 v[32:35], v[16:19], a[160:163], v[32:35]
    v_perm_b32 v27, v189, v185, s40
    v_mfma_f32_16x16x32_bf16 a[36:39], v[20:23], a[172:175], a[36:39]
    v_perm_b32 v28, v165, v161, s41
    v_mfma_f32_16x16x32_bf16 a[4:7], v[20:23], a[164:167], a[4:7]
    v_add_u32 v0, 4096, v0
    global_load_dwordx4 v[128:131], v0, s[12:13] offset:0
    v_perm_b32 v29, v173, v169, s41
    v_mfma_f32_16x16x32_bf16 v[68:71], v[20:23], a[168:171], v[68:71]
    v_perm_b32 v30, v181, v177, s41
    v_mfma_f32_16x16x32_bf16 v[36:39], v[20:23], a[160:163], v[36:39]
    v_perm_b32 v31, v189, v185, s41
    v_mfma_f32_16x16x32_bf16 a[40:43], v[24:27], a[172:175], a[40:43]
    v_perm_b32 v16, v166, v162, s40
    v_mfma_f32_16x16x32_bf16 a[8:11], v[24:27], a[164:167], a[8:11]
    v_perm_b32 v17, v174, v170, s40
    v_mfma_f32_16x16x32_bf16 v[72:75], v[24:27], a[168:171], v[72:75]
    v_perm_b32 v18, v182, v178, s40
    v_mfma_f32_16x16x32_bf16 v[40:43], v[24:27], a[160:163], v[40:43]
    global_load_dwordx4 v[132:135], v0, s[12:13] offset:512
    v_perm_b32 v19, v190, v186, s40
    v_mfma_f32_16x16x32_bf16 a[44:47], v[28:31], a[172:175], a[44:47]
    ds_read_b128 a[188:191], v1 offset:15360
    ds_read_b128 a[180:183], v1 offset:13312
    v_perm_b32 v20, v166, v162, s41
    v_mfma_f32_16x16x32_bf16 a[12:15], v[28:31], a[164:167], a[12:15]
    v_perm_b32 v21, v174, v170, s41
    v_mfma_f32_16x16x32_bf16 v[76:79], v[28:31], a[168:171], v[76:79]
    v_perm_b32 v22, v182, v178, s41
    v_mfma_f32_16x16x32_bf16 v[44:47], v[28:31], a[160:163], v[44:47]
    ds_read_b128 a[184:187], v1 offset:14336
    ds_read_b128 a[176:179], v1 offset:12288
    v_perm_b32 v23, v190, v186, s41
    v_mfma_f32_16x16x32_bf16 a[48:51], v[16:19], a[172:175], a[48:51]
    global_load_dwordx4 v[136:139], v0, s[12:13] offset:1024
    v_perm_b32 v24, v167, v163, s40
    v_mfma_f32_16x16x32_bf16 a[16:19], v[16:19], a[164:167], a[16:19]
    v_perm_b32 v25, v175, v171, s40
    v_mfma_f32_16x16x32_bf16 v[80:83], v[16:19], a[168:171], v[80:83]
    v_perm_b32 v26, v183, v179, s40
    v_mfma_f32_16x16x32_bf16 v[48:51], v[16:19], a[160:163], v[48:51]
    v_perm_b32 v27, v191, v187, s40
    v_mfma_f32_16x16x32_bf16 a[52:55], v[20:23], a[172:175], a[52:55]
    v_perm_b32 v28, v167, v163, s41
    v_mfma_f32_16x16x32_bf16 a[20:23], v[20:23], a[164:167], a[20:23]
    v_perm_b32 v29, v175, v171, s41
    v_mfma_f32_16x16x32_bf16 v[84:87], v[20:23], a[168:171], v[84:87]
    global_load_dwordx4 v[140:143], v0, s[12:13] offset:1536
    v_perm_b32 v30, v183, v179, s41
    v_mfma_f32_16x16x32_bf16 v[52:55], v[20:23], a[160:163], v[52:55]
    v_perm_b32 v31, v191, v187, s41
    v_mfma_f32_16x16x32_bf16 a[56:59], v[24:27], a[172:175], a[56:59]
    s_waitcnt vmcnt(20)
    v_perm_b32 v16, v196, v192, s40
    v_mfma_f32_16x16x32_bf16 a[24:27], v[24:27], a[164:167], a[24:27]
    v_perm_b32 v17, v204, v200, s40
    v_mfma_f32_16x16x32_bf16 v[88:91], v[24:27], a[168:171], v[88:91]
    v_perm_b32 v18, v212, v208, s40
    v_mfma_f32_16x16x32_bf16 v[56:59], v[24:27], a[160:163], v[56:59]
    v_perm_b32 v19, v220, v216, s40
    v_mfma_f32_16x16x32_bf16 a[60:63], v[28:31], a[172:175], a[60:63]
    global_load_dwordx4 v[144:147], v0, s[12:13] offset:2048
    v_perm_b32 v20, v196, v192, s41
    v_mfma_f32_16x16x32_bf16 a[28:31], v[28:31], a[164:167], a[28:31]
    v_perm_b32 v21, v204, v200, s41
    v_mfma_f32_16x16x32_bf16 v[92:95], v[28:31], a[168:171], v[92:95]
    v_perm_b32 v22, v212, v208, s41
    v_mfma_f32_16x16x32_bf16 v[60:63], v[28:31], a[160:163], v[60:63]
    v_perm_b32 v23, v220, v216, s41
    s_waitcnt lgkmcnt(3)
    v_mfma_f32_16x16x32_bf16 a[32:35], v[16:19], a[188:191], a[32:35]
    v_perm_b32 v24, v197, v193, s40
    s_waitcnt lgkmcnt(2)
    v_mfma_f32_16x16x32_bf16 a[0:3], v[16:19], a[180:183], a[0:3]
    v_perm_b32 v25, v205, v201, s40
    s_waitcnt lgkmcnt(1)
    v_mfma_f32_16x16x32_bf16 v[64:67], v[16:19], a[184:187], v[64:67]
    global_load_dwordx4 v[148:151], v0, s[12:13] offset:2560
    v_perm_b32 v26, v213, v209, s40
    s_waitcnt lgkmcnt(0)
    v_mfma_f32_16x16x32_bf16 v[32:35], v[16:19], a[176:179], v[32:35]
    v_perm_b32 v27, v221, v217, s40
    v_mfma_f32_16x16x32_bf16 a[36:39], v[20:23], a[188:191], a[36:39]
    v_perm_b32 v28, v197, v193, s41
    v_mfma_f32_16x16x32_bf16 a[4:7], v[20:23], a[180:183], a[4:7]
    v_perm_b32 v29, v205, v201, s41
    v_mfma_f32_16x16x32_bf16 v[68:71], v[20:23], a[184:187], v[68:71]
    v_perm_b32 v30, v213, v209, s41
    v_mfma_f32_16x16x32_bf16 v[36:39], v[20:23], a[176:179], v[36:39]
    v_perm_b32 v31, v221, v217, s41
    v_mfma_f32_16x16x32_bf16 a[40:43], v[24:27], a[188:191], a[40:43]
    global_load_dwordx4 v[152:155], v0, s[12:13] offset:3072
    v_perm_b32 v16, v198, v194, s40
    v_mfma_f32_16x16x32_bf16 a[8:11], v[24:27], a[180:183], a[8:11]
    v_perm_b32 v17, v206, v202, s40
    v_mfma_f32_16x16x32_bf16 v[72:75], v[24:27], a[184:187], v[72:75]
    v_perm_b32 v18, v214, v210, s40
    v_mfma_f32_16x16x32_bf16 v[40:43], v[24:27], a[176:179], v[40:43]
    v_perm_b32 v19, v222, v218, s40
    v_mfma_f32_16x16x32_bf16 a[44:47], v[28:31], a[188:191], a[44:47]
    ds_read_b128 a[140:143], v2 offset:3072
    ds_read_b128 a[132:135], v2 offset:1024
    v_perm_b32 v20, v198, v194, s41
    v_mfma_f32_16x16x32_bf16 a[12:15], v[28:31], a[180:183], a[12:15]
    global_load_dwordx4 v[156:159], v0, s[12:13] offset:3584
    v_perm_b32 v21, v206, v202, s41
    v_mfma_f32_16x16x32_bf16 v[76:79], v[28:31], a[184:187], v[76:79]
    v_perm_b32 v22, v214, v210, s41
    v_mfma_f32_16x16x32_bf16 v[44:47], v[28:31], a[176:179], v[44:47]
    ds_read_b128 a[136:139], v2 offset:2048
    ds_read_b128 a[128:131], v2 offset:0
    v_perm_b32 v23, v222, v218, s41
    v_mfma_f32_16x16x32_bf16 a[48:51], v[16:19], a[188:191], a[48:51]
    v_perm_b32 v24, v199, v195, s40
    v_mfma_f32_16x16x32_bf16 a[16:19], v[16:19], a[180:183], a[16:19]
    v_perm_b32 v25, v207, v203, s40
    v_mfma_f32_16x16x32_bf16 v[80:83], v[16:19], a[184:187], v[80:83]
    v_add_u32 v0, 4096, v0
    global_load_dwordx4 v[160:163], v0, s[12:13] offset:0
    v_perm_b32 v26, v215, v211, s40
    v_mfma_f32_16x16x32_bf16 v[48:51], v[16:19], a[176:179], v[48:51]
    v_perm_b32 v27, v223, v219, s40
    v_mfma_f32_16x16x32_bf16 a[52:55], v[20:23], a[188:191], a[52:55]
    v_perm_b32 v28, v199, v195, s41
    v_mfma_f32_16x16x32_bf16 a[20:23], v[20:23], a[180:183], a[20:23]
    v_perm_b32 v29, v207, v203, s41
    v_mfma_f32_16x16x32_bf16 v[84:87], v[20:23], a[184:187], v[84:87]
    v_perm_b32 v30, v215, v211, s41
    v_mfma_f32_16x16x32_bf16 v[52:55], v[20:23], a[176:179], v[52:55]
    v_perm_b32 v31, v223, v219, s41
    v_mfma_f32_16x16x32_bf16 a[56:59], v[24:27], a[188:191], a[56:59]
    global_load_dwordx4 v[164:167], v0, s[12:13] offset:512
    s_waitcnt vmcnt(18)
    v_perm_b32 v16, v228, v224, s40
    v_mfma_f32_16x16x32_bf16 a[24:27], v[24:27], a[180:183], a[24:27]
    v_perm_b32 v17, v236, v232, s40
    v_mfma_f32_16x16x32_bf16 v[88:91], v[24:27], a[184:187], v[88:91]
    v_perm_b32 v18, v244, v240, s40
    v_mfma_f32_16x16x32_bf16 v[56:59], v[24:27], a[176:179], v[56:59]
    v_perm_b32 v19, v252, v248, s40
    v_mfma_f32_16x16x32_bf16 a[60:63], v[28:31], a[188:191], a[60:63]
    v_perm_b32 v20, v228, v224, s41
    v_mfma_f32_16x16x32_bf16 a[28:31], v[28:31], a[180:183], a[28:31]
    global_load_dwordx4 v[168:171], v0, s[12:13] offset:1024
    v_perm_b32 v21, v236, v232, s41
    v_mfma_f32_16x16x32_bf16 v[92:95], v[28:31], a[184:187], v[92:95]
    v_perm_b32 v22, v244, v240, s41
    v_mfma_f32_16x16x32_bf16 v[60:63], v[28:31], a[176:179], v[60:63]
    v_perm_b32 v23, v252, v248, s41
    s_waitcnt lgkmcnt(3)
    v_mfma_f32_16x16x32_bf16 a[32:35], v[16:19], a[140:143], a[32:35]
    v_perm_b32 v24, v229, v225, s40
    s_waitcnt lgkmcnt(2)
    v_mfma_f32_16x16x32_bf16 a[0:3], v[16:19], a[132:135], a[0:3]
    v_perm_b32 v25, v237, v233, s40
    s_waitcnt lgkmcnt(1)
    v_mfma_f32_16x16x32_bf16 v[64:67], v[16:19], a[136:139], v[64:67]
    v_perm_b32 v26, v245, v241, s40
    s_waitcnt lgkmcnt(0)
    v_mfma_f32_16x16x32_bf16 v[32:35], v[16:19], a[128:131], v[32:35]
    global_load_dwordx4 v[172:175], v0, s[12:13] offset:1536
    v_perm_b32 v27, v253, v249, s40
    v_mfma_f32_16x16x32_bf16 a[36:39], v[20:23], a[140:143], a[36:39]
    v_perm_b32 v28, v229, v225, s41
    v_mfma_f32_16x16x32_bf16 a[4:7], v[20:23], a[132:135], a[4:7]
    v_perm_b32 v29, v237, v233, s41
    v_mfma_f32_16x16x32_bf16 v[68:71], v[20:23], a[136:139], v[68:71]
    v_perm_b32 v30, v245, v241, s41
    v_mfma_f32_16x16x32_bf16 v[36:39], v[20:23], a[128:131], v[36:39]
    v_perm_b32 v31, v253, v249, s41
    v_mfma_f32_16x16x32_bf16 a[40:43], v[24:27], a[140:143], a[40:43]
    v_perm_b32 v16, v230, v226, s40
    v_mfma_f32_16x16x32_bf16 a[8:11], v[24:27], a[132:135], a[8:11]
    global_load_dwordx4 v[176:179], v0, s[12:13] offset:2048
    v_perm_b32 v17, v238, v234, s40
    v_mfma_f32_16x16x32_bf16 v[72:75], v[24:27], a[136:139], v[72:75]
    v_perm_b32 v18, v246, v242, s40
    v_mfma_f32_16x16x32_bf16 v[40:43], v[24:27], a[128:131], v[40:43]
    v_perm_b32 v19, v254, v250, s40
    v_mfma_f32_16x16x32_bf16 a[44:47], v[28:31], a[140:143], a[44:47]
    ds_read_b128 a[156:159], v2 offset:7168
    ds_read_b128 a[148:151], v2 offset:5120
    v_perm_b32 v20, v230, v226, s41
    v_mfma_f32_16x16x32_bf16 a[12:15], v[28:31], a[132:135], a[12:15]
    v_perm_b32 v21, v238, v234, s41
    v_mfma_f32_16x16x32_bf16 v[76:79], v[28:31], a[136:139], v[76:79]
    global_load_dwordx4 v[180:183], v0, s[12:13] offset:2560
    v_perm_b32 v22, v246, v242, s41
    v_mfma_f32_16x16x32_bf16 v[44:47], v[28:31], a[128:131], v[44:47]
    ds_read_b128 a[152:155], v2 offset:6144
    ds_read_b128 a[144:147], v2 offset:4096
    v_perm_b32 v23, v254, v250, s41
    v_mfma_f32_16x16x32_bf16 a[48:51], v[16:19], a[140:143], a[48:51]
    v_perm_b32 v24, v231, v227, s40
    v_mfma_f32_16x16x32_bf16 a[16:19], v[16:19], a[132:135], a[16:19]
    v_perm_b32 v25, v239, v235, s40
    v_mfma_f32_16x16x32_bf16 v[80:83], v[16:19], a[136:139], v[80:83]
    v_perm_b32 v26, v247, v243, s40
    v_mfma_f32_16x16x32_bf16 v[48:51], v[16:19], a[128:131], v[48:51]
    global_load_dwordx4 v[184:187], v0, s[12:13] offset:3072
    v_perm_b32 v27, v255, v251, s40
    v_mfma_f32_16x16x32_bf16 a[52:55], v[20:23], a[140:143], a[52:55]
    v_perm_b32 v28, v231, v227, s41
    v_mfma_f32_16x16x32_bf16 a[20:23], v[20:23], a[132:135], a[20:23]
    v_perm_b32 v29, v239, v235, s41
    v_mfma_f32_16x16x32_bf16 v[84:87], v[20:23], a[136:139], v[84:87]
    v_perm_b32 v30, v247, v243, s41
    v_mfma_f32_16x16x32_bf16 v[52:55], v[20:23], a[128:131], v[52:55]
    v_perm_b32 v31, v255, v251, s41
    v_mfma_f32_16x16x32_bf16 a[56:59], v[24:27], a[140:143], a[56:59]
    global_load_dwordx4 v[188:191], v0, s[12:13] offset:3584
    s_waitcnt vmcnt(16)
    v_perm_b32 v16, v100, v96, s40
    v_mfma_f32_16x16x32_bf16 a[24:27], v[24:27], a[132:135], a[24:27]
    v_perm_b32 v17, v108, v104, s40
    v_mfma_f32_16x16x32_bf16 v[88:91], v[24:27], a[136:139], v[88:91]
    v_perm_b32 v18, v116, v112, s40
    v_mfma_f32_16x16x32_bf16 v[56:59], v[24:27], a[128:131], v[56:59]
    v_perm_b32 v19, v124, v120, s40
    v_mfma_f32_16x16x32_bf16 a[60:63], v[28:31], a[140:143], a[60:63]
    v_accvgpr_read_b32 v0, a193
    global_load_dwordx4 v[192:195], v0, s[14:15] offset:-3072
    v_perm_b32 v20, v100, v96, s41
    v_mfma_f32_16x16x32_bf16 a[28:31], v[28:31], a[132:135], a[28:31]
    v_perm_b32 v21, v108, v104, s41
    v_mfma_f32_16x16x32_bf16 v[92:95], v[28:31], a[136:139], v[92:95]
    v_perm_b32 v22, v116, v112, s41
    v_mfma_f32_16x16x32_bf16 v[60:63], v[28:31], a[128:131], v[60:63]
    v_perm_b32 v23, v124, v120, s41
    s_waitcnt lgkmcnt(3)
    v_mfma_f32_16x16x32_bf16 a[32:35], v[16:19], a[156:159], a[32:35]
    global_load_dwordx4 v[196:199], v0, s[14:15] offset:-1536
    v_perm_b32 v24, v101, v97, s40
    s_waitcnt lgkmcnt(2)
    v_mfma_f32_16x16x32_bf16 a[0:3], v[16:19], a[148:151], a[0:3]
    v_perm_b32 v25, v109, v105, s40
    s_waitcnt lgkmcnt(1)
    v_mfma_f32_16x16x32_bf16 v[64:67], v[16:19], a[152:155], v[64:67]
    v_perm_b32 v26, v117, v113, s40
    s_waitcnt lgkmcnt(0)
    v_mfma_f32_16x16x32_bf16 v[32:35], v[16:19], a[144:147], v[32:35]
    v_perm_b32 v27, v125, v121, s40
    v_mfma_f32_16x16x32_bf16 a[36:39], v[20:23], a[156:159], a[36:39]
    global_load_dwordx4 v[200:203], v0, s[14:15] offset:0
    v_perm_b32 v28, v101, v97, s41
    v_mfma_f32_16x16x32_bf16 a[4:7], v[20:23], a[148:151], a[4:7]
    v_perm_b32 v29, v109, v105, s41
    v_mfma_f32_16x16x32_bf16 v[68:71], v[20:23], a[152:155], v[68:71]
    v_perm_b32 v30, v117, v113, s41
    v_mfma_f32_16x16x32_bf16 v[36:39], v[20:23], a[144:147], v[36:39]
    v_perm_b32 v31, v125, v121, s41
    v_mfma_f32_16x16x32_bf16 a[40:43], v[24:27], a[156:159], a[40:43]
    global_load_dwordx4 v[204:207], v0, s[14:15] offset:1536
    v_perm_b32 v16, v102, v98, s40
    v_mfma_f32_16x16x32_bf16 a[8:11], v[24:27], a[148:151], a[8:11]
    v_perm_b32 v17, v110, v106, s40
    v_mfma_f32_16x16x32_bf16 v[72:75], v[24:27], a[152:155], v[72:75]
    v_perm_b32 v18, v118, v114, s40
    v_mfma_f32_16x16x32_bf16 v[40:43], v[24:27], a[144:147], v[40:43]
    v_perm_b32 v19, v126, v122, s40
    v_mfma_f32_16x16x32_bf16 a[44:47], v[28:31], a[156:159], a[44:47]
    global_load_dwordx4 v[208:211], v0, s[14:15] offset:3072
    ds_read_b128 a[172:175], v2 offset:11264
    ds_read_b128 a[164:167], v2 offset:9216
    v_perm_b32 v20, v102, v98, s41
    v_mfma_f32_16x16x32_bf16 a[12:15], v[28:31], a[148:151], a[12:15]
    v_perm_b32 v21, v110, v106, s41
    v_mfma_f32_16x16x32_bf16 v[76:79], v[28:31], a[152:155], v[76:79]
    v_perm_b32 v22, v118, v114, s41
    v_mfma_f32_16x16x32_bf16 v[44:47], v[28:31], a[144:147], v[44:47]
    ds_read_b128 a[168:171], v2 offset:10240
    ds_read_b128 a[160:163], v2 offset:8192
    v_perm_b32 v23, v126, v122, s41
    v_mfma_f32_16x16x32_bf16 a[48:51], v[16:19], a[156:159], a[48:51]
    global_load_dwordx4 v[212:215], v0, s[24:25] offset:-1536
    v_perm_b32 v24, v103, v99, s40
    v_mfma_f32_16x16x32_bf16 a[16:19], v[16:19], a[148:151], a[16:19]
    v_perm_b32 v25, v111, v107, s40
    v_mfma_f32_16x16x32_bf16 v[80:83], v[16:19], a[152:155], v[80:83]
    v_perm_b32 v26, v119, v115, s40
    v_mfma_f32_16x16x32_bf16 v[48:51], v[16:19], a[144:147], v[48:51]
    v_perm_b32 v27, v127, v123, s40
    v_mfma_f32_16x16x32_bf16 a[52:55], v[20:23], a[156:159], a[52:55]
    global_load_dwordx4 v[216:219], v0, s[24:25] offset:0
    v_perm_b32 v28, v103, v99, s41
    v_mfma_f32_16x16x32_bf16 a[20:23], v[20:23], a[148:151], a[20:23]
    v_perm_b32 v29, v111, v107, s41
    v_mfma_f32_16x16x32_bf16 v[84:87], v[20:23], a[152:155], v[84:87]
    v_perm_b32 v30, v119, v115, s41
    v_mfma_f32_16x16x32_bf16 v[52:55], v[20:23], a[144:147], v[52:55]
    v_perm_b32 v31, v127, v123, s41
    v_mfma_f32_16x16x32_bf16 a[56:59], v[24:27], a[156:159], a[56:59]
    global_load_dwordx4 v[220:223], v0, s[24:25] offset:1536
    s_waitcnt vmcnt(16)
    v_perm_b32 v16, v132, v128, s40
    v_mfma_f32_16x16x32_bf16 a[24:27], v[24:27], a[148:151], a[24:27]
    v_perm_b32 v17, v140, v136, s40
    v_mfma_f32_16x16x32_bf16 v[88:91], v[24:27], a[152:155], v[88:91]
    v_perm_b32 v18, v148, v144, s40
    v_accvgpr_read_b32 v4, a203
    v_mfma_f32_16x16x32_bf16 v[56:59], v[24:27], a[144:147], v[56:59]
    v_perm_b32 v19, v156, v152, s40
    v_mfma_f32_16x16x32_bf16 a[60:63], v[28:31], a[156:159], a[60:63]
    v_add_u32 v0, 49152, v0
    global_load_dwordx4 v[224:227], v0, s[14:15] offset:-3072
    v_perm_b32 v20, v132, v128, s41
    v_accvgpr_read_b32 v5, a204
    v_mfma_f32_16x16x32_bf16 a[28:31], v[28:31], a[148:151], a[28:31]
    v_perm_b32 v21, v140, v136, s41
    v_mfma_f32_16x16x32_bf16 v[92:95], v[28:31], a[152:155], v[92:95]
    v_perm_b32 v22, v148, v144, s41
    v_accvgpr_read_b32 v6, a205
    v_mfma_f32_16x16x32_bf16 v[60:63], v[28:31], a[144:147], v[60:63]
    v_perm_b32 v23, v156, v152, s41
    s_waitcnt lgkmcnt(3)
    v_mfma_f32_16x16x32_bf16 a[32:35], v[16:19], a[172:175], a[32:35]
    global_load_dwordx4 v[228:231], v0, s[14:15] offset:-1536
    v_perm_b32 v24, v133, v129, s40
    v_accvgpr_read_b32 v7, a206
    s_waitcnt lgkmcnt(2)
    v_mfma_f32_16x16x32_bf16 a[0:3], v[16:19], a[164:167], a[0:3]
    v_perm_b32 v25, v141, v137, s40
    s_waitcnt lgkmcnt(1)
    v_mfma_f32_16x16x32_bf16 v[64:67], v[16:19], a[168:171], v[64:67]
    v_perm_b32 v26, v149, v145, s40
    v_accvgpr_read_b32 v8, a207
    s_waitcnt lgkmcnt(0)
    v_mfma_f32_16x16x32_bf16 v[32:35], v[16:19], a[160:163], v[32:35]
    v_perm_b32 v27, v157, v153, s40
    v_mfma_f32_16x16x32_bf16 a[36:39], v[20:23], a[172:175], a[36:39]
    global_load_dwordx4 v[232:235], v0, s[14:15] offset:0
    v_perm_b32 v28, v133, v129, s41
    v_accvgpr_read_b32 v9, a208
    v_mfma_f32_16x16x32_bf16 a[4:7], v[20:23], a[164:167], a[4:7]
    v_perm_b32 v29, v141, v137, s41
    v_mfma_f32_16x16x32_bf16 v[68:71], v[20:23], a[168:171], v[68:71]
    v_perm_b32 v30, v149, v145, s41
    v_accvgpr_read_b32 v10, a209
    v_mfma_f32_16x16x32_bf16 v[36:39], v[20:23], a[160:163], v[36:39]
    v_perm_b32 v31, v157, v153, s41
    v_mfma_f32_16x16x32_bf16 a[40:43], v[24:27], a[172:175], a[40:43]
    global_load_dwordx4 v[236:239], v0, s[14:15] offset:1536
    v_perm_b32 v16, v134, v130, s40
    v_accvgpr_read_b32 v11, a210
    v_mfma_f32_16x16x32_bf16 a[8:11], v[24:27], a[164:167], a[8:11]
    v_perm_b32 v17, v142, v138, s40
    v_mfma_f32_16x16x32_bf16 v[72:75], v[24:27], a[168:171], v[72:75]
    v_perm_b32 v18, v150, v146, s40
    v_accvgpr_read_b32 v12, a211
    v_mfma_f32_16x16x32_bf16 v[40:43], v[24:27], a[160:163], v[40:43]
    v_perm_b32 v19, v158, v154, s40
    v_accvgpr_read_b32 v13, a212
    v_mfma_f32_16x16x32_bf16 a[44:47], v[28:31], a[172:175], a[44:47]
    global_load_dwordx4 v[240:243], v0, s[14:15] offset:3072
    ds_read_b128 a[188:191], v2 offset:15360
    ds_read_b128 a[180:183], v2 offset:13312
    v_perm_b32 v20, v134, v130, s41
    v_mfma_f32_16x16x32_bf16 a[12:15], v[28:31], a[164:167], a[12:15]
    v_perm_b32 v21, v142, v138, s41
    v_mfma_f32_16x16x32_bf16 v[76:79], v[28:31], a[168:171], v[76:79]
    v_perm_b32 v22, v150, v146, s41
    v_mfma_f32_16x16x32_bf16 v[44:47], v[28:31], a[160:163], v[44:47]
    ds_read_b128 a[184:187], v2 offset:14336
    ds_read_b128 a[176:179], v2 offset:12288
    v_perm_b32 v23, v158, v154, s41
    v_mfma_f32_16x16x32_bf16 a[48:51], v[16:19], a[172:175], a[48:51]
    global_load_dwordx4 v[244:247], v0, s[24:25] offset:-1536
    v_perm_b32 v24, v135, v131, s40
    v_mfma_f32_16x16x32_bf16 a[16:19], v[16:19], a[164:167], a[16:19]
    v_perm_b32 v25, v143, v139, s40
    v_mfma_f32_16x16x32_bf16 v[80:83], v[16:19], a[168:171], v[80:83]
    v_perm_b32 v26, v151, v147, s40
    v_mfma_f32_16x16x32_bf16 v[48:51], v[16:19], a[160:163], v[48:51]
    v_perm_b32 v27, v159, v155, s40
    v_mfma_f32_16x16x32_bf16 a[52:55], v[20:23], a[172:175], a[52:55]
    global_load_dwordx4 v[248:251], v0, s[24:25] offset:0
    v_perm_b32 v28, v135, v131, s41
    v_mfma_f32_16x16x32_bf16 a[20:23], v[20:23], a[164:167], a[20:23]
    v_perm_b32 v29, v143, v139, s41
    v_mfma_f32_16x16x32_bf16 v[84:87], v[20:23], a[168:171], v[84:87]
    v_perm_b32 v30, v151, v147, s41
    v_mfma_f32_16x16x32_bf16 v[52:55], v[20:23], a[160:163], v[52:55]
    v_perm_b32 v31, v159, v155, s41
    v_mfma_f32_16x16x32_bf16 a[56:59], v[24:27], a[172:175], a[56:59]
    global_load_dwordx4 v[252:255], v0, s[24:25] offset:1536
    s_waitcnt vmcnt(16)
    v_perm_b32 v16, v164, v160, s40
    v_mfma_f32_16x16x32_bf16 a[24:27], v[24:27], a[164:167], a[24:27]
    v_perm_b32 v17, v172, v168, s40
    v_mfma_f32_16x16x32_bf16 v[88:91], v[24:27], a[168:171], v[88:91]
    v_perm_b32 v18, v180, v176, s40
    v_mfma_f32_16x16x32_bf16 v[56:59], v[24:27], a[160:163], v[56:59]
    v_perm_b32 v19, v188, v184, s40
    v_mfma_f32_16x16x32_bf16 a[60:63], v[28:31], a[172:175], a[60:63]
    v_add_u32 v0, 49152, v0
    global_load_dwordx4 v[128:131], v0, s[14:15] offset:-3072
    v_perm_b32 v20, v164, v160, s41
    v_mfma_f32_16x16x32_bf16 a[28:31], v[28:31], a[164:167], a[28:31]
    v_perm_b32 v21, v172, v168, s41
    v_mfma_f32_16x16x32_bf16 v[92:95], v[28:31], a[168:171], v[92:95]
    v_perm_b32 v22, v180, v176, s41
    v_mfma_f32_16x16x32_bf16 v[60:63], v[28:31], a[160:163], v[60:63]
    v_perm_b32 v23, v188, v184, s41
    s_waitcnt lgkmcnt(3)
    v_mfma_f32_16x16x32_bf16 a[32:35], v[16:19], a[188:191], a[32:35]
    global_load_dwordx4 v[132:135], v0, s[14:15] offset:-1536
    v_perm_b32 v24, v165, v161, s40
    s_waitcnt lgkmcnt(2)
    v_mfma_f32_16x16x32_bf16 a[0:3], v[16:19], a[180:183], a[0:3]
    v_perm_b32 v25, v173, v169, s40
    s_waitcnt lgkmcnt(1)
    v_mfma_f32_16x16x32_bf16 v[64:67], v[16:19], a[184:187], v[64:67]
    v_perm_b32 v26, v181, v177, s40
    s_waitcnt lgkmcnt(0)
    v_mfma_f32_16x16x32_bf16 v[32:35], v[16:19], a[176:179], v[32:35]
    v_perm_b32 v27, v189, v185, s40
    v_mfma_f32_16x16x32_bf16 a[36:39], v[20:23], a[188:191], a[36:39]
    global_load_dwordx4 v[136:139], v0, s[14:15] offset:0
    v_perm_b32 v28, v165, v161, s41
    v_mfma_f32_16x16x32_bf16 a[4:7], v[20:23], a[180:183], a[4:7]
    v_perm_b32 v29, v173, v169, s41
    v_mfma_f32_16x16x32_bf16 v[68:71], v[20:23], a[184:187], v[68:71]
    v_perm_b32 v30, v181, v177, s41
    v_mfma_f32_16x16x32_bf16 v[36:39], v[20:23], a[176:179], v[36:39]
    v_perm_b32 v31, v189, v185, s41
    v_mfma_f32_16x16x32_bf16 a[40:43], v[24:27], a[188:191], a[40:43]
    global_load_dwordx4 v[140:143], v0, s[14:15] offset:1536
    v_perm_b32 v16, v166, v162, s40
    v_mfma_f32_16x16x32_bf16 a[8:11], v[24:27], a[180:183], a[8:11]
    v_perm_b32 v17, v174, v170, s40
    v_mfma_f32_16x16x32_bf16 v[72:75], v[24:27], a[184:187], v[72:75]
    v_perm_b32 v18, v182, v178, s40
    v_mfma_f32_16x16x32_bf16 v[40:43], v[24:27], a[176:179], v[40:43]
    v_perm_b32 v19, v190, v186, s40
    v_mfma_f32_16x16x32_bf16 a[44:47], v[28:31], a[188:191], a[44:47]
    global_load_dwordx4 v[144:147], v0, s[14:15] offset:3072
    v_perm_b32 v20, v166, v162, s41
    v_mfma_f32_16x16x32_bf16 a[12:15], v[28:31], a[180:183], a[12:15]
    v_perm_b32 v21, v174, v170, s41
    v_mfma_f32_16x16x32_bf16 v[76:79], v[28:31], a[184:187], v[76:79]
    v_perm_b32 v22, v182, v178, s41
    v_mfma_f32_16x16x32_bf16 v[44:47], v[28:31], a[176:179], v[44:47]
    v_perm_b32 v23, v190, v186, s41
    v_mfma_f32_16x16x32_bf16 a[48:51], v[16:19], a[188:191], a[48:51]
    global_load_dwordx4 v[148:151], v0, s[24:25] offset:-1536
    v_perm_b32 v24, v167, v163, s40
    v_mfma_f32_16x16x32_bf16 a[16:19], v[16:19], a[180:183], a[16:19]
    v_perm_b32 v25, v175, v171, s40
    v_mfma_f32_16x16x32_bf16 v[80:83], v[16:19], a[184:187], v[80:83]
    v_perm_b32 v26, v183, v179, s40
    v_mfma_f32_16x16x32_bf16 v[48:51], v[16:19], a[176:179], v[48:51]
    v_perm_b32 v27, v191, v187, s40
    v_mfma_f32_16x16x32_bf16 a[52:55], v[20:23], a[188:191], a[52:55]
    global_load_dwordx4 v[152:155], v0, s[24:25] offset:0
    v_perm_b32 v28, v167, v163, s41
    v_mfma_f32_16x16x32_bf16 a[20:23], v[20:23], a[180:183], a[20:23]
    v_perm_b32 v29, v175, v171, s41
    v_mfma_f32_16x16x32_bf16 v[84:87], v[20:23], a[184:187], v[84:87]
    v_perm_b32 v30, v183, v179, s41
    v_mfma_f32_16x16x32_bf16 v[52:55], v[20:23], a[176:179], v[52:55]
    v_perm_b32 v31, v191, v187, s41
    v_mfma_f32_16x16x32_bf16 a[56:59], v[24:27], a[188:191], a[56:59]
    global_load_dwordx4 v[156:159], v0, s[24:25] offset:1536
    v_mfma_f32_16x16x32_bf16 a[60:63], v[28:31], a[188:191], a[60:63]
    ds_write_b128 v11, a[32:35] offset:0
    v_mfma_f32_16x16x32_bf16 a[24:27], v[24:27], a[180:183], a[24:27]
    ds_write_b128 v11, a[36:39] offset:1024
    v_mfma_f32_16x16x32_bf16 a[28:31], v[28:31], a[180:183], a[28:31]
    ds_write_b128 v11, a[40:43] offset:2048
    v_mfma_f32_16x16x32_bf16 v[88:91], v[24:27], a[184:187], v[88:91]
    ds_write_b128 v11, a[44:47] offset:3072
    v_mfma_f32_16x16x32_bf16 v[92:95], v[28:31], a[184:187], v[92:95]
    ds_write_b128 v11, a[48:51] offset:4096
    v_mfma_f32_16x16x32_bf16 v[56:59], v[24:27], a[176:179], v[56:59]
    ds_write_b128 v11, a[52:55] offset:5120
    v_mfma_f32_16x16x32_bf16 v[60:63], v[28:31], a[176:179], v[60:63]
    ds_write_b128 v11, a[56:59] offset:6144
    ds_write_b128 v11, a[60:63] offset:7168
    s_cmp_lg_u64 s[34:35], 0
    s_cbranch_scc1 K1_ZS
K1_ZC:
    s_waitcnt lgkmcnt(0)
    s_barrier
    ds_read_b128 v[96:99], v12 offset:0
    ds_read_b128 v[100:103], v12 offset:1024
    ds_read_b128 v[104:107], v12 offset:2048
    ds_read_b128 v[108:111], v12 offset:3072
    ds_read_b128 v[112:115], v12 offset:4096
    ds_read_b128 v[116:119], v12 offset:5120
    ds_read_b128 v[120:123], v12 offset:6144
    ds_read_b128 v[124:127], v12 offset:7168
    ds_write_b128 v4, a[0:3] offset:0
    ds_write_b128 v4, a[4:7] offset:1024
    ds_write_b128 v4, a[8:11] offset:2048
    ds_write_b128 v4, a[12:15] offset:3072
    s_waitcnt lgkmcnt(11)
    v_pk_add_f32 v[64:65], v[64:65], v[96:97]
    v_pk_add_f32 v[66:67], v[66:67], v[98:99]
    global_store_dwordx4 v13, v[64:67], s[16:17] offset:0
    ds_write_b128 v4, a[16:19] offset:4096
    v_add_u32 v0, 49152, v0
    global_load_dwordx4 v[160:163], v0, s[14:15] offset:-3072
    s_waitcnt lgkmcnt(11)
    v_pk_add_f32 v[68:69], v[68:69], v[100:101]
    v_pk_add_f32 v[70:71], v[70:71], v[102:103]
    global_store_dwordx4 v13, v[68:71], s[16:17] offset:1024
    ds_write_b128 v4, a[20:23] offset:5120
    s_waitcnt lgkmcnt(11)
    v_pk_add_f32 v[72:73], v[72:73], v[104:105]
    v_pk_add_f32 v[74:75], v[74:75], v[106:107]
    global_store_dwordx4 v13, v[72:75], s[16:17] offset:2048
    ds_write_b128 v4, a[24:27] offset:6144
    s_waitcnt lgkmcnt(11)
    v_pk_add_f32 v[76:77], v[76:77], v[108:109]
    v_pk_add_f32 v[78:79], v[78:79], v[110:111]
    global_store_dwordx4 v13, v[76:79], s[16:17] offset:3072
    ds_write_b128 v4, a[28:31] offset:7168
    global_load_dwordx4 v[164:167], v0, s[14:15] offset:-1536
    s_waitcnt lgkmcnt(11)
    v_pk_add_f32 v[80:81], v[80:81], v[112:113]
    v_pk_add_f32 v[82:83], v[82:83], v[114:115]
    v_add_u32 v13, 4096, v13
    global_store_dwordx4 v13, v[80:83], s[16:17] offset:0
    s_waitcnt lgkmcnt(10)
    v_pk_add_f32 v[84:85], v[84:85], v[116:117]
    v_pk_add_f32 v[86:87], v[86:87], v[118:119]
    global_store_dwordx4 v13, v[84:87], s[16:17] offset:1024
    s_waitcnt lgkmcnt(9)
    v_pk_add_f32 v[88:89], v[88:89], v[120:121]
    v_pk_add_f32 v[90:91], v[90:91], v[122:123]
    global_store_dwordx4 v13, v[88:91], s[16:17] offset:2048
    s_waitcnt lgkmcnt(8)
    v_pk_add_f32 v[92:93], v[92:93], v[124:125]
    v_pk_add_f32 v[94:95], v[94:95], v[126:127]
    global_store_dwordx4 v13, v[92:95], s[16:17] offset:3072
    s_waitcnt lgkmcnt(0)
    s_barrier
    global_load_dwordx4 v[168:171], v0, s[14:15] offset:0
    ds_read_b128 v[96:99], v5 offset:0
    ds_read_b128 v[100:103], v5 offset:1024
    ds_read_b128 v[104:107], v5 offset:2048
    ds_read_b128 v[108:111], v5 offset:3072
    ds_read_b128 v[112:115], v5 offset:4096
    ds_read_b128 v[116:119], v5 offset:5120
    ds_read_b128 v[120:123], v5 offset:6144
    ds_read_b128 v[124:127], v5 offset:7168
    v_accvgpr_read_b32 v11, a214
    v_accvgpr_read_b32 v12, a215
    v_accvgpr_read_b32 v13, a213
    v_mov_b32 v14, s64
    v_add_u32 v15, 4096, v13
    s_waitcnt lgkmcnt(7)
    v_pk_add_f32 v[32:33], v[32:33], v[96:97]
    global_load_dwordx4 v[172:175], v0, s[14:15] offset:1536
    v_pk_add_f32 v[34:35], v[34:35], v[98:99]
    s_waitcnt lgkmcnt(6)
    v_pk_add_f32 v[36:37], v[36:37], v[100:101]
    v_pk_add_f32 v[38:39], v[38:39], v[102:103]
    s_waitcnt lgkmcnt(5)
    v_pk_add_f32 v[40:41], v[40:41], v[104:105]
    v_pk_add_f32 v[42:43], v[42:43], v[106:107]
    s_waitcnt lgkmcnt(4)
    v_pk_add_f32 v[44:45], v[44:45], v[108:109]
    v_pk_add_f32 v[46:47], v[46:47], v[110:111]
    s_waitcnt lgkmcnt(3)
    v_pk_add_f32 v[48:49], v[48:49], v[112:113]
    v_pk_add_f32 v[50:51], v[50:51], v[114:115]
    s_waitcnt lgkmcnt(2)
    v_pk_add_f32 v[52:53], v[52:53], v[116:117]
    v_pk_add_f32 v[54:55], v[54:55], v[118:119]
    s_waitcnt lgkmcnt(1)
    v_pk_add_f32 v[56:57], v[56:57], v[120:121]
    v_pk_add_f32 v[58:59], v[58:59], v[122:123]
    s_waitcnt lgkmcnt(0)
    v_pk_add_f32 v[60:61], v[60:61], v[124:125]
    v_pk_add_f32 v[62:63], v[62:63], v[126:127]
    s_waitcnt vmcnt(28)
    v_perm_b32 v16, v196, v192, s40
    v_perm_b32 v17, v204, v200, s40
    global_load_dwordx4 v[176:179], v0, s[14:15] offset:3072
    v_perm_b32 v18, v212, v208, s40
    v_perm_b32 v19, v220, v216, s40
    v_perm_b32 v20, v196, v192, s41
    v_perm_b32 v21, v204, v200, s41
    v_perm_b32 v22, v212, v208, s41
    v_perm_b32 v23, v220, v216, s41
    v_perm_b32 v24, v197, v193, s40
    v_accvgpr_write_b32 a64, v16
    v_perm_b32 v25, v205, v201, s40
    v_accvgpr_write_b32 a65, v17
    v_perm_b32 v26, v213, v209, s40
    v_accvgpr_write_b32 a66, v18
    v_perm_b32 v27, v221, v217, s40
    v_accvgpr_write_b32 a67, v19
    v_perm_b32 v28, v197, v193, s41
    v_accvgpr_write_b32 a68, v20
    v_perm_b32 v29, v205, v201, s41
    v_accvgpr_write_b32 a69, v21
    global_load_dwordx4 v[180:183], v0, s[24:25] offset:-1536
    v_perm_b32 v30, v213, v209, s41
    v_accvgpr_write_b32 a70, v22
    v_perm_b32 v31, v221, v217, s41
    v_accvgpr_write_b32 a71, v23
    v_perm_b32 v16, v198, v194, s40
    v_accvgpr_write_b32 a72, v24
    v_perm_b32 v17, v206, v202, s40
    v_accvgpr_write_b32 a73, v25
    v_perm_b32 v18, v214, v210, s40
    v_accvgpr_write_b32 a74, v26
    v_perm_b32 v19, v222, v218, s40
    v_accvgpr_write_b32 a75, v27
    v_perm_b32 v20, v198, v194, s41
    v_accvgpr_write_b32 a76, v28
    v_perm_b32 v21, v206, v202, s41
    v_accvgpr_write_b32 a77, v29
    v_perm_b32 v22, v214, v210, s41
    v_accvgpr_write_b32 a78, v30
    global_load_dwordx4 v[184:187], v0, s[24:25] offset:0
    v_perm_b32 v23, v222, v218, s41
    v_accvgpr_write_b32 a79, v31
    v_perm_b32 v24, v199, v195, s40
    v_accvgpr_write_b32 a80, v16
    v_perm_b32 v25, v207, v203, s40
    v_accvgpr_write_b32 a81, v17
    v_perm_b32 v26, v215, v211, s40
    v_accvgpr_write_b32 a82, v18
    v_perm_b32 v27, v223, v219, s40
    v_accvgpr_write_b32 a83, v19
    v_perm_b32 v28, v199, v195, s41
    v_accvgpr_write_b32 a84, v20
    v_perm_b32 v29, v207, v203, s41
    v_accvgpr_write_b32 a85, v21
    v_perm_b32 v30, v215, v211, s41
    v_accvgpr_write_b32 a86, v22
    v_perm_b32 v31, v223, v219, s41
    v_accvgpr_write_b32 a87, v23
    global_load_dwordx4 v[188:191], v0, s[24:25] offset:1536
    v_accvgpr_write_b32 a88, v24
    v_accvgpr_write_b32 a89, v25
    v_accvgpr_write_b32 a90, v26
    v_accvgpr_write_b32 a91, v27
    v_accvgpr_write_b32 a92, v28
    v_accvgpr_write_b32 a93, v29
    v_accvgpr_write_b32 a94, v30
    v_accvgpr_write_b32 a95, v31
    s_waitcnt vmcnt(24)
    v_perm_b32 v16, v228, v224, s40
    v_perm_b32 v17, v236, v232, s40
    v_perm_b32 v18, v244, v240, s40
    v_perm_b32 v19, v252, v248, s40
    v_perm_b32 v20, v228, v224, s41
    v_perm_b32 v21, v236, v232, s41
    v_perm_b32 v22, v244, v240, s41
    v_perm_b32 v23, v252, v248, s41
    v_perm_b32 v24, v229, v225, s40
    v_accvgpr_read_b32 v0, a192
    global_load_dwordx4 v[96:99], v0, s[14:15] offset:-3072
    v_accvgpr_write_b32 a216, v16
    v_perm_b32 v25, v237, v233, s40
    v_accvgpr_write_b32 a217, v17
    v_perm_b32 v26, v245, v241, s40
    v_accvgpr_write_b32 a218, v18
    v_perm_b32 v27, v253, v249, s40
    v_accvgpr_write_b32 a219, v19
    v_perm_b32 v28, v229, v225, s41
    v_accvgpr_write_b32 a220, v20
    v_perm_b32 v29, v237, v233, s41
    v_accvgpr_write_b32 a221, v21
    v_perm_b32 v30, v245, v241, s41
    v_accvgpr_write_b32 a222, v22
    v_perm_b32 v31, v253, v249, s41
    v_accvgpr_write_b32 a223, v23
    v_perm_b32 v16, v230, v226, s40
    v_accvgpr_write_b32 a224, v24
    v_perm_b32 v17, v238, v234, s40
    global_load_dwordx4 v[100:103], v0, s[14:15] offset:-1536
    v_accvgpr_write_b32 a225, v25
    v_perm_b32 v18, v246, v242, s40
    v_accvgpr_write_b32 a226, v26
    v_perm_b32 v19, v254, v250, s40
    s_waitcnt vmcnt(8)
    global_load_dwordx4 v[104:107], v0, s[14:15] offset:0
    s_cmp_lg_u32 s62, 0
    s_cbranch_scc1 K1_XM
    s_mov_b64 exec, 1
    global_store_dword v11, v14, s[16:17]
    s_mov_b64 exec, -1
K1_XN:
    global_load_dword v14, v12, s[16:17] sc1
    v_accvgpr_write_b32 a227, v27
    v_perm_b32 v20, v230, v226, s41
    v_accvgpr_write_b32 a228, v28
    v_perm_b32 v21, v238, v234, s41
    v_accvgpr_write_b32 a229, v29
    v_perm_b32 v22, v246, v242, s41
    v_accvgpr_write_b32 a230, v30
    v_perm_b32 v23, v254, v250, s41
    v_accvgpr_write_b32 a231, v31
    v_perm_b32 v24, v231, v227, s40
    v_accvgpr_write_b32 a232, v16
    global_load_dwordx4 v[108:111], v0, s[14:15] offset:1536
    v_perm_b32 v25, v239, v235, s40
    v_accvgpr_write_b32 a233, v17
    v_perm_b32 v26, v247, v243, s40
    v_accvgpr_write_b32 a234, v18
    v_perm_b32 v27, v255, v251, s40
    v_accvgpr_write_b32 a235, v19
    v_perm_b32 v28, v231, v227, s41
    v_accvgpr_write_b32 a236, v20
    v_perm_b32 v29, v239, v235, s41
    v_accvgpr_write_b32 a237, v21
    v_perm_b32 v30, v247, v243, s41
    v_accvgpr_write_b32 a238, v22
    v_perm_b32 v31, v255, v251, s41
    v_accvgpr_write_b32 a239, v23
    v_accvgpr_write_b32 a240, v24
    v_accvgpr_write_b32 a241, v25
    v_accvgpr_write_b32 a242, v26
    v_accvgpr_write_b32 a243, v27
    global_load_dwordx4 v[112:115], v0, s[14:15] offset:3072
    v_accvgpr_write_b32 a244, v28
    v_accvgpr_write_b32 a245, v29
    v_accvgpr_write_b32 a246, v30
    v_accvgpr_write_b32 a247, v31
    global_load_dwordx4 v[116:119], v0, s[24:25] offset:-1536
    v_perm_b32 v16, v132, v128, s40
    global_load_dwordx4 v[120:123], v0, s[24:25] offset:0
    v_perm_b32 v17, v140, v136, s40
    global_load_dwordx4 v[124:127], v0, s[24:25] offset:1536
    v_perm_b32 v18, v148, v144, s40
    v_perm_b32 v19, v156, v152, s40
    v_perm_b32 v20, v132, v128, s41
    v_perm_b32 v21, v140, v136, s41
    v_perm_b32 v22, v148, v144, s41
    v_perm_b32 v23, v156, v152, s41
    v_perm_b32 v24, v133, v129, s40
    v_accvgpr_write_b32 a128, v16
    v_perm_b32 v25, v141, v137, s40
    v_accvgpr_write_b32 a129, v17
    v_perm_b32 v26, v149, v145, s40
    v_accvgpr_write_b32 a130, v18
    v_perm_b32 v27, v157, v153, s40
    v_accvgpr_write_b32 a131, v19
    v_perm_b32 v28, v133, v129, s41
    v_accvgpr_write_b32 a132, v20
    v_perm_b32 v29, v141, v137, s41
    v_accvgpr_write_b32 a133, v21
    v_perm_b32 v30, v149, v145, s41
    v_accvgpr_write_b32 a134, v22
    v_perm_b32 v31, v157, v153, s41
    v_accvgpr_write_b32 a135, v23
    v_perm_b32 v16, v134, v130, s40
    v_accvgpr_write_b32 a136, v24
    v_perm_b32 v17, v142, v138, s40
    v_accvgpr_write_b32 a137, v25
    v_perm_b32 v18, v150, v146, s40
    v_accvgpr_write_b32 a138, v26
    v_perm_b32 v19, v158, v154, s40
    v_accvgpr_write_b32 a139, v27
    v_perm_b32 v20, v134, v130, s41
    v_accvgpr_write_b32 a140, v28
    v_perm_b32 v21, v142, v138, s41
    v_accvgpr_write_b32 a141, v29
    v_perm_b32 v22, v150, v146, s41
    v_accvgpr_write_b32 a142, v30
    v_perm_b32 v23, v158, v154, s41
    v_accvgpr_write_b32 a143, v31
    v_perm_b32 v24, v135, v131, s40
    v_accvgpr_write_b32 a144, v16
    v_perm_b32 v25, v143, v139, s40
    v_accvgpr_write_b32 a145, v17
    v_perm_b32 v26, v151, v147, s40
    v_accvgpr_write_b32 a146, v18
    v_perm_b32 v27, v159, v155, s40
    v_accvgpr_write_b32 a147, v19
    v_perm_b32 v28, v135, v131, s41
    v_accvgpr_write_b32 a148, v20
    v_perm_b32 v29, v143, v139, s41
    v_accvgpr_write_b32 a149, v21
    v_perm_b32 v30, v151, v147, s41
    v_accvgpr_write_b32 a150, v22
    v_perm_b32 v31, v159, v155, s41
    v_accvgpr_write_b32 a151, v23
    v_accvgpr_write_b32 a152, v24
    v_accvgpr_write_b32 a153, v25
    v_accvgpr_write_b32 a154, v26
    v_accvgpr_write_b32 a155, v27
    v_accvgpr_write_b32 a156, v28
    v_accvgpr_write_b32 a157, v29
    v_accvgpr_write_b32 a158, v30
    v_accvgpr_write_b32 a159, v31
    v_add_u32 v0, 49152, v0
    global_load_dwordx4 v[192:195], v0, s[14:15] offset:-3072
    s_waitcnt vmcnt(6)
    v_readfirstlane_b32 s34, v14
    s_nop 1
    s_cmp_lg_u32 s34, s64
    s_cbranch_scc1 K1_XW
K1_XL:
    global_load_dwordx4 v[64:67], v13, s[16:17] offset:0 sc1
    global_load_dwordx4 v[68:71], v13, s[16:17] offset:1024 sc1
    global_load_dwordx4 v[72:75], v13, s[16:17] offset:2048 sc1
    global_load_dwordx4 v[76:79], v13, s[16:17] offset:3072 sc1
    global_load_dwordx4 v[80:83], v15, s[16:17] offset:0 sc1
    global_load_dwordx4 v[84:87], v15, s[16:17] offset:1024 sc1
    global_load_dwordx4 v[88:91], v15, s[16:17] offset:2048 sc1
    global_load_dwordx4 v[92:95], v15, s[16:17] offset:3072 sc1
    global_load_dwordx4 v[196:199], v0, s[14:15] offset:-1536
    v_perm_b32 v16, v164, v160, s40
    global_load_dwordx4 v[200:203], v0, s[14:15] offset:0
    v_perm_b32 v17, v172, v168, s40
    global_load_dwordx4 v[204:207], v0, s[14:15] offset:1536
    v_perm_b32 v18, v180, v176, s40
    global_load_dwordx4 v[208:211], v0, s[14:15] offset:3072
    v_perm_b32 v19, v188, v184, s40
    global_load_dwordx4 v[212:215], v0, s[24:25] offset:-1536
    v_perm_b32 v20, v164, v160, s41
    global_load_dwordx4 v[216:219], v0, s[24:25] offset:0
    v_perm_b32 v21, v172, v168, s41
    global_load_dwordx4 v[220:223], v0, s[24:25] offset:1536
    v_perm_b32 v22, v180, v176, s41
    v_perm_b32 v23, v188, v184, s41
    v_perm_b32 v24, v165, v161, s40
    v_accvgpr_write_b32 a160, v16
    v_perm_b32 v25, v173, v169, s40
    v_accvgpr_write_b32 a161, v17
    v_perm_b32 v26, v181, v177, s40
    v_accvgpr_write_b32 a162, v18
    v_perm_b32 v27, v189, v185, s40
    v_accvgpr_write_b32 a163, v19
    v_perm_b32 v28, v165, v161, s41
    v_accvgpr_write_b32 a164, v20
    v_perm_b32 v29, v173, v169, s41
    v_accvgpr_write_b32 a165, v21
    v_perm_b32 v30, v181, v177, s41
    v_accvgpr_write_b32 a166, v22
    v_perm_b32 v31, v189, v185, s41
    v_accvgpr_write_b32 a167, v23
    v_perm_b32 v16, v166, v162, s40
    v_accvgpr_write_b32 a168, v24
    v_perm_b32 v17, v174, v170, s40
    v_accvgpr_write_b32 a169, v25
    v_perm_b32 v18, v182, v178, s40
    v_accvgpr_write_b32 a170, v26
    v_perm_b32 v19, v190, v186, s40
    v_accvgpr_write_b32 a171, v27
    v_perm_b32 v20, v166, v162, s41
    v_accvgpr_write_b32 a172, v28
    v_perm_b32 v21, v174, v170, s41
    v_accvgpr_write_b32 a173, v29
    v_perm_b32 v22, v182, v178, s41
    v_accvgpr_write_b32 a174, v30
    v_perm_b32 v23, v190, v186, s41
    v_accvgpr_write_b32 a175, v31
    v_perm_b32 v24, v167, v163, s40
    v_accvgpr_write_b32 a176, v16
    v_perm_b32 v25, v175, v171, s40
    v_accvgpr_write_b32 a177, v17
    v_perm_b32 v26, v183, v179, s40
    v_accvgpr_write_b32 a178, v18
    v_perm_b32 v27, v191, v187, s40
    v_accvgpr_write_b32 a179, v19
    v_perm_b32 v28, v167, v163, s41
    v_accvgpr_write_b32 a180, v20
    v_perm_b32 v29, v175, v171, s41
    v_accvgpr_write_b32 a181, v21
    v_perm_b32 v30, v183, v179, s41
    v_accvgpr_write_b32 a182, v22
    v_perm_b32 v31, v191, v187, s41
    v_accvgpr_write_b32 a183, v23
    v_accvgpr_write_b32 a184, v24
    v_accvgpr_write_b32 a185, v25
    v_accvgpr_write_b32 a186, v26
    v_accvgpr_write_b32 a187, v27
    v_accvgpr_write_b32 a188, v28
    v_accvgpr_write_b32 a189, v29
    v_accvgpr_write_b32 a190, v30
    v_accvgpr_write_b32 a191, v31
    s_waitcnt vmcnt(14)
    v_pk_add_f32 v[32:33], v[32:33], v[64:65]
    v_pk_add_f32 v[34:35], v[34:35], v[66:67]
    v_pk_add_f32 v[14:15], v[32:33], v[34:35]
    v_pk_mul_f32 v[2:3], v[32:33], v[32:33]
    v_pk_mul_f32 v[12:13], v[34:35], v[34:35]
    s_waitcnt vmcnt(13)
    v_pk_add_f32 v[36:37], v[36:37], v[68:69]
    v_pk_add_f32 v[38:39], v[38:39], v[70:71]
    v_pk_add_f32 v[14:15], v[14:15], v[36:37]
    v_pk_fma_f32 v[2:3], v[36:37], v[36:37], v[2:3]
    v_pk_add_f32 v[14:15], v[14:15], v[38:39]
    v_pk_fma_f32 v[12:13], v[38:39], v[38:39], v[12:13]
    s_waitcnt vmcnt(12)
    v_pk_add_f32 v[40:41], v[40:41], v[72:73]
    v_pk_add_f32 v[42:43], v[42:43], v[74:75]
    v_pk_add_f32 v[14:15], v[14:15], v[40:41]
    v_pk_fma_f32 v[2:3], v[40:41], v[40:41], v[2:3]
    v_pk_add_f32 v[14:15], v[14:15], v[42:43]
    v_pk_fma_f32 v[12:13], v[42:43], v[42:43], v[12:13]
    s_waitcnt vmcnt(11)
    v_pk_add_f32 v[44:45], v[44:45], v[76:77]
    v_pk_add_f32 v[46:47], v[46:47], v[78:79]
    v_pk_add_f32 v[14:15], v[14:15], v[44:45]
    v_pk_fma_f32 v[2:3], v[44:45], v[44:45], v[2:3]
    v_pk_add_f32 v[14:15], v[14:15], v[46:47]
    v_pk_fma_f32 v[12:13], v[46:47], v[46:47], v[12:13]
    s_waitcnt vmcnt(10)
    v_pk_add_f32 v[48:49], v[48:49], v[80:81]
    v_pk_add_f32 v[50:51], v[50:51], v[82:83]
    v_pk_add_f32 v[14:15], v[14:15], v[48:49]
    v_pk_fma_f32 v[2:3], v[48:49], v[48:49], v[2:3]
    v_pk_add_f32 v[14:15], v[14:15], v[50:51]
    v_pk_fma_f32 v[12:13], v[50:51], v[50:51], v[12:13]
    s_waitcnt vmcnt(9)
    v_pk_add_f32 v[52:53], v[52:53], v[84:85]
    v_pk_add_f32 v[54:55], v[54:55], v[86:87]
    v_pk_add_f32 v[14:15], v[14:15], v[52:53]
    v_pk_fma_f32 v[2:3], v[52:53], v[52:53], v[2:3]
    v_pk_add_f32 v[14:15], v[14:15], v[54:55]
    v_pk_fma_f32 v[12:13], v[54:55], v[54:55], v[12:13]
    s_waitcnt vmcnt(8)
    v_pk_add_f32 v[56:57], v[56:57], v[88:89]
    v_pk_add_f32 v[58:59], v[58:59], v[90:91]
    v_pk_add_f32 v[14:15], v[14:15], v[56:57]
    v_pk_fma_f32 v[2:3], v[56:57], v[56:57], v[2:3]
    v_pk_add_f32 v[14:15], v[14:15], v[58:59]
    v_pk_fma_f32 v[12:13], v[58:59], v[58:59], v[12:13]
    s_waitcnt vmcnt(7)
    v_pk_add_f32 v[60:61], v[60:61], v[92:93]
    v_pk_add_f32 v[62:63], v[62:63], v[94:95]
    v_pk_add_f32 v[14:15], v[14:15], v[60:61]
    v_pk_fma_f32 v[2:3], v[60:61], v[60:61], v[2:3]
    v_pk_add_f32 v[14:15], v[14:15], v[62:63]
    v_pk_fma_f32 v[12:13], v[62:63], v[62:63], v[12:13]
    v_pk_add_f32 v[2:3], v[2:3], v[12:13]
    v_add_f32 v14, v14, v15
    v_add_f32 v2, v2, v3
    s_nop 1
    v_permlane32_swap_b32 v14, v2
    v_add_f32 v14, v14, v2
    ds_write_b32 v6, v14
    v_cvt_pk_bf16_f32 v64, v32, v36
    v_cvt_pk_bf16_f32 v65, v40, v44
    v_cvt_pk_bf16_f32 v66, v48, v52
    v_cvt_pk_bf16_f32 v67, v56, v60
    v_cvt_pk_bf16_f32 v68, v33, v37
    v_cvt_pk_bf16_f32 v69, v41, v45
    v_cvt_pk_bf16_f32 v70, v49, v53
    v_cvt_pk_bf16_f32 v71, v57, v61
    s_waitcnt lgkmcnt(0)
    s_barrier
    v_mov_b32 v12, 52736
    ds_read_b128 v[16:19], v7
    ds_read_b128 v[20:23], v7 offset:256
    ds_read_b32 v12, v12
    v_cvt_pk_bf16_f32 v72, v34, v38
    v_cvt_pk_bf16_f32 v73, v42, v46
    v_cvt_pk_bf16_f32 v74, v50, v54
    v_cvt_pk_bf16_f32 v75, v58, v62
    v_cvt_pk_bf16_f32 v76, v35, v39
    v_cvt_pk_bf16_f32 v77, v43, v47
    v_cvt_pk_bf16_f32 v78, v51, v55
    v_cvt_pk_bf16_f32 v79, v59, v63
    s_waitcnt lgkmcnt(0)
    v_cmp_ne_u32 vcc, 0, v12
    s_nop 4
    s_cbranch_vccnz K1_XR
    v_accvgpr_write_b32 a200, v64
    v_accvgpr_write_b32 a201, v65
    v_accvgpr_write_b32 a202, v66
    v_accvgpr_write_b32 a203, v67
    v_accvgpr_write_b32 a204, v68
    v_accvgpr_write_b32 a205, v69
    v_accvgpr_write_b32 a206, v70
    v_accvgpr_write_b32 a207, v71
    v_accvgpr_write_b32 a208, v72
    v_accvgpr_write_b32 a209, v73
    v_accvgpr_write_b32 a210, v74
    v_accvgpr_write_b32 a211, v75
    v_accvgpr_write_b32 a212, v76
    v_accvgpr_write_b32 a213, v77
    v_accvgpr_write_b32 a214, v78
    v_accvgpr_write_b32 a215, v79
    v_pk_add_f32 v[16:17], v[16:17], v[18:19]
    v_pk_add_f32 v[20:21], v[20:21], v[22:23]
    v_add_f32 v16, v16, v17
    v_add_f32 v20, v20, v21
    v_mul_f32 v16, s53, v16
    v_mul_f32 v17, v16, v16
    v_fma_f32 v20, v20, s53, -v17
    v_max_f32 v20, 0, v20
    v_add_f32 v20, 0x38ae990f, v20
    v_rsq_f32 v20, v20
    s_nop 0
    v_mul_f32 v15, v16, v20
    v_sub_f32 v14, 0, v20
    v_pk_fma_f32 v[32:33], v[32:33], v[14:15], v[14:15] op_sel:[0,0,1] op_sel_hi:[1,0,1]
    v_pk_fma_f32 v[36:37], v[36:37], v[14:15], v[14:15] op_sel:[0,0,1] op_sel_hi:[1,0,1]
    v_pk_fma_f32 v[40:41], v[40:41], v[14:15], v[14:15] op_sel:[0,0,1] op_sel_hi:[1,0,1]
    v_pk_fma_f32 v[44:45], v[44:45], v[14:15], v[14:15] op_sel:[0,0,1] op_sel_hi:[1,0,1]
    v_pk_fma_f32 v[48:49], v[48:49], v[14:15], v[14:15] op_sel:[0,0,1] op_sel_hi:[1,0,1]
    v_pk_fma_f32 v[52:53], v[52:53], v[14:15], v[14:15] op_sel:[0,0,1] op_sel_hi:[1,0,1]
    v_pk_fma_f32 v[56:57], v[56:57], v[14:15], v[14:15] op_sel:[0,0,1] op_sel_hi:[1,0,1]
    v_pk_fma_f32 v[60:61], v[60:61], v[14:15], v[14:15] op_sel:[0,0,1] op_sel_hi:[1,0,1]
    v_cvt_pk_bf16_f32 v16, v32, v36
    v_cvt_pk_bf16_f32 v17, v40, v44
    v_cvt_pk_bf16_f32 v18, v48, v52
    v_cvt_pk_bf16_f32 v19, v56, v60
    ds_write_b128 v9, v[16:19] offset:0
    v_cvt_pk_bf16_f32 v20, v33, v37
    v_cvt_pk_bf16_f32 v21, v41, v45
    v_cvt_pk_bf16_f32 v22, v49, v53
    v_cvt_pk_bf16_f32 v23, v57, v61
    ds_write_b128 v9, v[20:23] offset:528
    v_pk_fma_f32 v[34:35], v[34:35], v[14:15], v[14:15] op_sel:[0,0,1] op_sel_hi:[1,0,1]
    v_add_u32 v0, 49152, v0
    global_load_dwordx4 v[224:227], v0, s[14:15] offset:-3072
    v_pk_fma_f32 v[38:39], v[38:39], v[14:15], v[14:15] op_sel:[0,0,1] op_sel_hi:[1,0,1]
    v_pk_fma_f32 v[42:43], v[42:43], v[14:15], v[14:15] op_sel:[0,0,1] op_sel_hi:[1,0,1]
    v_pk_fma_f32 v[46:47], v[46:47], v[14:15], v[14:15] op_sel:[0,0,1] op_sel_hi:[1,0,1]
    v_pk_fma_f32 v[50:51], v[50:51], v[14:15], v[14:15] op_sel:[0,0,1] op_sel_hi:[1,0,1]
    v_pk_fma_f32 v[54:55], v[54:55], v[14:15], v[14:15] op_sel:[0,0,1] op_sel_hi:[1,0,1]
    v_pk_fma_f32 v[58:59], v[58:59], v[14:15], v[14:15] op_sel:[0,0,1] op_sel_hi:[1,0,1]
    v_pk_fma_f32 v[62:63], v[62:63], v[14:15], v[14:15] op_sel:[0,0,1] op_sel_hi:[1,0,1]
    v_cvt_pk_bf16_f32 v24, v34, v38
    v_cvt_pk_bf16_f32 v25, v42, v46
    v_cvt_pk_bf16_f32 v26, v50, v54
    v_cvt_pk_bf16_f32 v27, v58, v62
    ds_write_b128 v9, v[24:27] offset:1056
    v_cvt_pk_bf16_f32 v28, v35, v39
    v_cvt_pk_bf16_f32 v29, v43, v47
    v_cvt_pk_bf16_f32 v30, v51, v55
    v_cvt_pk_bf16_f32 v31, v59, v63
    global_load_dwordx4 v[228:231], v0, s[14:15] offset:-1536
    ds_write_b128 v9, v[28:31] offset:1584
    v_accvgpr_read_b32 v3, a194
    s_waitcnt lgkmcnt(0)
    s_barrier
    global_load_dwordx4 v[232:235], v0, s[14:15] offset:0
    s_cmp_ge_u32 s3, 2
    s_cbranch_scc1 K1_KP
    ds_read_b128 a[0:3], v10 offset:0
    ds_read_b128 a[4:7], v10 offset:256
    ds_read_b128 a[8:11], v10 offset:2112
    ds_read_b128 a[12:15], v10 offset:2368
    global_load_dwordx4 v[236:239], v0, s[14:15] offset:1536
    v_perm_b32 v16, v100, v96, s40
    v_perm_b32 v17, v108, v104, s40
    v_perm_b32 v18, v116, v112, s40
    v_perm_b32 v19, v124, v120, s40
    v_perm_b32 v20, v100, v96, s41
    v_perm_b32 v21, v108, v104, s41
    v_perm_b32 v22, v116, v112, s41
    v_perm_b32 v23, v124, v120, s41
    s_waitcnt lgkmcnt(3)
    v_mfma_f32_16x16x32_bf16 v[32:35], a[0:3], v[16:19], 0
    global_load_dwordx4 v[240:243], v0, s[14:15] offset:3072
    v_perm_b32 v24, v101, v97, s40
    v_perm_b32 v25, v109, v105, s40
    s_waitcnt lgkmcnt(2)
    v_mfma_f32_16x16x32_bf16 v[36:39], a[4:7], v[16:19], 0
    global_load_dwordx4 v[244:247], v0, s[24:25] offset:-1536
    ds_read_b128 a[16:19], v10 offset:4224
    ds_read_b128 a[20:23], v10 offset:4480
    v_perm_b32 v26, v117, v113, s40
    v_perm_b32 v27, v125, v121, s40
    v_mov_b32 v1, v4
    v_mfma_f32_16x16x32_bf16 v[40:43], a[0:3], v[20:23], 0
    global_load_dwordx4 v[248:251], v0, s[24:25] offset:0
    v_perm_b32 v28, v101, v97, s41
    v_perm_b32 v29, v109, v105, s41
    v_mfma_f32_16x16x32_bf16 v[44:47], a[4:7], v[20:23], 0
    global_load_dwordx4 v[252:255], v0, s[24:25] offset:1536
    v_perm_b32 v30, v117, v113, s41
    v_perm_b32 v31, v125, v121, s41
    v_mfma_f32_16x16x32_bf16 v[48:51], a[0:3], v[24:27], 0
    v_add_u32 v0, 49152, v0
    global_load_dwordx4 v[128:131], v0, s[14:15] offset:-3072
    v_perm_b32 v16, v102, v98, s40
    v_perm_b32 v17, v110, v106, s40
    v_mfma_f32_16x16x32_bf16 v[52:55], a[4:7], v[24:27], 0
    global_load_dwordx4 v[132:135], v0, s[14:15] offset:-1536
    v_perm_b32 v18, v118, v114, s40
    v_perm_b32 v19, v126, v122, s40
    v_mfma_f32_16x16x32_bf16 v[56:59], a[0:3], v[28:31], 0
    global_load_dwordx4 v[136:139], v0, s[14:15] offset:0
    v_perm_b32 v20, v102, v98, s41
    v_perm_b32 v21, v110, v106, s41
    v_mov_b32 v2, v5
    v_mfma_f32_16x16x32_bf16 v[60:63], a[4:7], v[28:31], 0
    global_load_dwordx4 v[140:143], v0, s[14:15] offset:1536
    v_perm_b32 v22, v118, v114, s41
    v_perm_b32 v23, v126, v122, s41
    v_mfma_f32_16x16x32_bf16 a[96:99], a[0:3], v[16:19], 0
    v_perm_b32 v24, v103, v99, s40
    v_perm_b32 v25, v111, v107, s40
    v_mfma_f32_16x16x32_bf16 a[100:103], a[4:7], v[16:19], 0
    global_load_dwordx4 v[144:147], v0, s[14:15] offset:3072
    v_perm_b32 v26, v119, v115, s40
    v_perm_b32 v27, v127, v123, s40
    v_mfma_f32_16x16x32_bf16 a[104:107], a[0:3], v[20:23], 0
    v_perm_b32 v28, v103, v99, s41
    v_perm_b32 v29, v111, v107, s41
    v_mfma_f32_16x16x32_bf16 a[108:111], a[4:7], v[20:23], 0
    global_load_dwordx4 v[148:151], v0, s[24:25] offset:-1536
    v_perm_b32 v30, v119, v115, s41
    v_perm_b32 v31, v127, v123, s41
    v_mov_b32 v12, v8
    v_mfma_f32_16x16x32_bf16 a[112:115], a[0:3], v[24:27], 0
    s_waitcnt vmcnt(14)
    v_perm_b32 v16, v196, v192, s40
    v_perm_b32 v17, v204, v200, s40
    v_mfma_f32_16x16x32_bf16 a[116:119], a[4:7], v[24:27], 0
    global_load_dwordx4 v[152:155], v0, s[24:25] offset:0
    v_perm_b32 v18, v212, v208, s40
    v_perm_b32 v19, v220, v216, s40
    v_mfma_f32_16x16x32_bf16 a[120:123], a[0:3], v[28:31], 0
    global_load_dwordx4 v[156:159], v0, s[24:25] offset:1536
    v_perm_b32 v20, v196, v192, s41
    v_perm_b32 v21, v204, v200, s41
    v_mfma_f32_16x16x32_bf16 a[124:127], a[4:7], v[28:31], 0
    v_accvgpr_read_b32 v0, a193
    v_add_u32 v0, 196608, v0
    global_load_dwordx4 v[160:163], v0, s[14:15] offset:-3072
    v_perm_b32 v22, v212, v208, s41
    v_perm_b32 v23, v220, v216, s41
    s_waitcnt lgkmcnt(3)
    v_mfma_f32_16x16x32_bf16 v[32:35], a[8:11], v[16:19], v[32:35]
    global_load_dwordx4 v[164:167], v0, s[14:15] offset:-1536
    v_perm_b32 v24, v197, v193, s40
    v_perm_b32 v25, v205, v201, s40
    s_waitcnt lgkmcnt(2)
    v_mfma_f32_16x16x32_bf16 v[36:39], a[12:15], v[16:19], v[36:39]
    ds_read_b128 a[24:27], v10 offset:6336
    ds_read_b128 a[28:31], v10 offset:6592
    v_perm_b32 v26, v213, v209, s40
    v_perm_b32 v27, v221, v217, s40
    v_mfma_f32_16x16x32_bf16 v[40:43], a[8:11], v[20:23], v[40:43]
    global_load_dwordx4 v[168:171], v0, s[14:15] offset:0
    v_perm_b32 v28, v197, v193, s41
    v_perm_b32 v29, v205, v201, s41
    v_mfma_f32_16x16x32_bf16 v[44:47], a[12:15], v[20:23], v[44:47]
    v_perm_b32 v30, v213, v209, s41
    v_perm_b32 v31, v221, v217, s41
    v_mfma_f32_16x16x32_bf16 v[48:51], a[8:11], v[24:27], v[48:51]
    global_load_dwordx4 v[172:175], v0, s[14:15] offset:1536
    v_perm_b32 v16, v198, v194, s40
    v_perm_b32 v17, v206, v202, s40
    v_mfma_f32_16x16x32_bf16 v[52:55], a[12:15], v[24:27], v[52:55]
    v_perm_b32 v18, v214, v210, s40
    v_perm_b32 v19, v222, v218, s40
    v_mfma_f32_16x16x32_bf16 v[56:59], a[8:11], v[28:31], v[56:59]
    global_load_dwordx4 v[176:179], v0, s[14:15] offset:3072
    v_perm_b32 v20, v198, v194, s41
    v_perm_b32 v21, v206, v202, s41
    v_mfma_f32_16x16x32_bf16 v[60:63], a[12:15], v[28:31], v[60:63]
    v_perm_b32 v22, v214, v210, s41
    v_perm_b32 v23, v222, v218, s41
    v_mfma_f32_16x16x32_bf16 a[96:99], a[8:11], v[16:19], a[96:99]
    global_load_dwordx4 v[180:183], v0, s[24:25] offset:-1536
    v_perm_b32 v24, v199, v195, s40
    v_perm_b32 v25, v207, v203, s40
    v_mfma_f32_16x16x32_bf16 a[100:103], a[12:15], v[16:19], a[100:103]
    v_perm_b32 v26, v215, v211, s40
    v_perm_b32 v27, v223, v219, s40
    v_mfma_f32_16x16x32_bf16 a[104:107], a[8:11], v[20:23], a[104:107]
    global_load_dwordx4 v[184:187], v0, s[24:25] offset:0
    v_perm_b32 v28, v199, v195, s41
    v_perm_b32 v29, v207, v203, s41
    v_mfma_f32_16x16x32_bf16 a[108:111], a[12:15], v[20:23], a[108:111]
    v_perm_b32 v30, v215, v211, s41
    v_perm_b32 v31, v223, v219, s41
    v_mfma_f32_16x16x32_bf16 a[112:115], a[8:11], v[24:27], a[112:115]
    global_load_dwordx4 v[188:191], v0, s[24:25] offset:1536
    s_waitcnt vmcnt(16)
    v_perm_b32 v16, v228, v224, s40
    v_perm_b32 v17, v236, v232, s40
    v_mfma_f32_16x16x32_bf16 a[116:119], a[12:15], v[24:27], a[116:119]
    v_perm_b32 v18, v244, v240, s40
    v_perm_b32 v19, v252, v248, s40
    v_mfma_f32_16x16x32_bf16 a[120:123], a[8:11], v[28:31], a[120:123]
    v_add_u32 v0, 49152, v0
    global_load_dwordx4 v[192:195], v0, s[14:15] offset:-3072
    v_perm_b32 v20, v228, v224, s41
    v_perm_b32 v21, v236, v232, s41
    v_mfma_f32_16x16x32_bf16 a[124:127], a[12:15], v[28:31], a[124:127]
    v_perm_b32 v22, v244, v240, s41
    v_perm_b32 v23, v252, v248, s41
    s_waitcnt lgkmcnt(3)
    v_mfma_f32_16x16x32_bf16 v[32:35], a[16:19], v[16:19], v[32:35]
    global_load_dwordx4 v[196:199], v0, s[14:15] offset:-1536
    v_perm_b32 v24, v229, v225, s40
    v_perm_b32 v25, v237, v233, s40
    s_waitcnt lgkmcnt(2)
    v_mfma_f32_16x16x32_bf16 v[36:39], a[20:23], v[16:19], v[36:39]
    ds_read_b128 a[32:35], v10 offset:8448
    ds_read_b128 a[36:39], v10 offset:8704
    v_perm_b32 v26, v245, v241, s40
    v_perm_b32 v27, v253, v249, s40
    v_mfma_f32_16x16x32_bf16 v[40:43], a[16:19], v[20:23], v[40:43]
    global_load_dwordx4 v[200:203], v0, s[14:15] offset:0
    v_perm_b32 v28, v229, v225, s41
    v_perm_b32 v29, v237, v233, s41
    v_mfma_f32_16x16x32_bf16 v[44:47], a[20:23], v[20:23], v[44:47]
    v_perm_b32 v30, v245, v241, s41
    v_perm_b32 v31, v253, v249, s41
    v_mfma_f32_16x16x32_bf16 v[48:51], a[16:19], v[24:27], v[48:51]
    global_load_dwordx4 v[204:207], v0, s[14:15] offset:1536
    v_perm_b32 v16, v230, v226, s40
    v_perm_b32 v17, v238, v234, s40
    v_mfma_f32_16x16x32_bf16 v[52:55], a[20:23], v[24:27], v[52:55]
    v_perm_b32 v18, v246, v242, s40
    v_perm_b32 v19, v254, v250, s40
    v_mfma_f32_16x16x32_bf16 v[56:59], a[16:19], v[28:31], v[56:59]
    global_load_dwordx4 v[208:211], v0, s[14:15] offset:3072
    v_perm_b32 v20, v230, v226, s41
    v_perm_b32 v21, v238, v234, s41
    v_mfma_f32_16x16x32_bf16 v[60:63], a[20:23], v[28:31], v[60:63]
    v_perm_b32 v22, v246, v242, s41
    v_perm_b32 v23, v254, v250, s41
    v_mfma_f32_16x16x32_bf16 a[96:99], a[16:19], v[16:19], a[96:99]
    global_load_dwordx4 v[212:215], v0, s[24:25] offset:-1536
    v_perm_b32 v24, v231, v227, s40
    v_perm_b32 v25, v239, v235, s40
    v_mfma_f32_16x16x32_bf16 a[100:103], a[20:23], v[16:19], a[100:103]
    v_perm_b32 v26, v247, v243, s40
    v_perm_b32 v27, v255, v251, s40
    v_mfma_f32_16x16x32_bf16 a[104:107], a[16:19], v[20:23], a[104:107]
    global_load_dwordx4 v[216:219], v0, s[24:25] offset:0
    v_perm_b32 v28, v231, v227, s41
    v_perm_b32 v29, v239, v235, s41
    v_mfma_f32_16x16x32_bf16 a[108:111], a[20:23], v[20:23], a[108:111]
    v_perm_b32 v30, v247, v243, s41
    v_perm_b32 v31, v255, v251, s41
    v_mfma_f32_16x16x32_bf16 a[112:115], a[16:19], v[24:27], a[112:115]
    global_load_dwordx4 v[220:223], v0, s[24:25] offset:1536
    s_waitcnt vmcnt(16)
    v_perm_b32 v16, v132, v128, s40
    v_perm_b32 v17, v140, v136, s40
    v_mfma_f32_16x16x32_bf16 a[116:119], a[20:23], v[24:27], a[116:119]
    v_perm_b32 v18, v148, v144, s40
    v_perm_b32 v19, v156, v152, s40
    v_mfma_f32_16x16x32_bf16 a[120:123], a[16:19], v[28:31], a[120:123]
    v_add_u32 v0, 49152, v0
    global_load_dwordx4 v[224:227], v0, s[14:15] offset:-3072
    v_perm_b32 v20, v132, v128, s41
    v_perm_b32 v21, v140, v136, s41
    v_mfma_f32_16x16x32_bf16 a[124:127], a[20:23], v[28:31], a[124:127]
    v_perm_b32 v22, v148, v144, s41
    v_perm_b32 v23, v156, v152, s41
    s_waitcnt lgkmcnt(3)
    v_mfma_f32_16x16x32_bf16 v[32:35], a[24:27], v[16:19], v[32:35]
    global_load_dwordx4 v[228:231], v0, s[14:15] offset:-1536
    v_perm_b32 v24, v133, v129, s40
    v_perm_b32 v25, v141, v137, s40
    s_waitcnt lgkmcnt(2)
    v_mfma_f32_16x16x32_bf16 v[36:39], a[28:31], v[16:19], v[36:39]
    ds_read_b128 a[40:43], v10 offset:10560
    ds_read_b128 a[44:47], v10 offset:10816
    v_perm_b32 v26, v149, v145, s40
    v_perm_b32 v27, v157, v153, s40
    v_mfma_f32_16x16x32_bf16 v[40:43], a[24:27], v[20:23], v[40:43]
    global_load_dwordx4 v[232:235], v0, s[14:15] offset:0
    v_perm_b32 v28, v133, v129, s41
    v_perm_b32 v29, v141, v137, s41
    v_mfma_f32_16x16x32_bf16 v[44:47], a[28:31], v[20:23], v[44:47]
    v_perm_b32 v30, v149, v145, s41
    v_perm_b32 v31, v157, v153, s41
    v_mfma_f32_16x16x32_bf16 v[48:51], a[24:27], v[24:27], v[48:51]
    global_load_dwordx4 v[236:239], v0, s[14:15] offset:1536
    v_perm_b32 v16, v134, v130, s40
    v_perm_b32 v17, v142, v138, s40
    v_mfma_f32_16x16x32_bf16 v[52:55], a[28:31], v[24:27], v[52:55]
    v_perm_b32 v18, v150, v146, s40
    v_perm_b32 v19, v158, v154, s40
    v_mfma_f32_16x16x32_bf16 v[56:59], a[24:27], v[28:31], v[56:59]
    global_load_dwordx4 v[240:243], v0, s[14:15] offset:3072
    v_perm_b32 v20, v134, v130, s41
    v_perm_b32 v21, v142, v138, s41
    v_mfma_f32_16x16x32_bf16 v[60:63], a[28:31], v[28:31], v[60:63]
    v_perm_b32 v22, v150, v146, s41
    v_perm_b32 v23, v158, v154, s41
    v_mfma_f32_16x16x32_bf16 a[96:99], a[24:27], v[16:19], a[96:99]
    global_load_dwordx4 v[244:247], v0, s[24:25] offset:-1536
    v_perm_b32 v24, v135, v131, s40
    v_perm_b32 v25, v143, v139, s40
    v_mfma_f32_16x16x32_bf16 a[100:103], a[28:31], v[16:19], a[100:103]
    v_perm_b32 v26, v151, v147, s40
    v_perm_b32 v27, v159, v155, s40
    v_mfma_f32_16x16x32_bf16 a[104:107], a[24:27], v[20:23], a[104:107]
    global_load_dwordx4 v[248:251], v0, s[24:25] offset:0
    v_perm_b32 v28, v135, v131, s41
    v_perm_b32 v29, v143, v139, s41
    v_mfma_f32_16x16x32_bf16 a[108:111], a[28:31], v[20:23], a[108:111]
    v_perm_b32 v30, v151, v147, s41
    v_perm_b32 v31, v159, v155, s41
    v_mfma_f32_16x16x32_bf16 a[112:115], a[24:27], v[24:27], a[112:115]
    global_load_dwordx4 v[252:255], v0, s[24:25] offset:1536
    v_mfma_f32_16x16x32_bf16 a[116:119], a[28:31], v[24:27], a[116:119]
    v_mfma_f32_16x16x32_bf16 a[120:123], a[24:27], v[28:31], a[120:123]
    v_mfma_f32_16x16x32_bf16 a[124:127], a[28:31], v[28:31], a[124:127]
    v_mfma_f32_16x16x32_bf16 v[64:67], a[64:67], a[0:3], 0
    v_mfma_f32_16x16x32_bf16 v[96:99], a[64:67], a[4:7], 0
    ds_read_b128 a[48:51], v10 offset:12672
    ds_read_b128 a[52:55], v10 offset:12928
    v_mfma_f32_16x16x32_bf16 v[68:71], a[68:71], a[0:3], 0
    v_mfma_f32_16x16x32_bf16 v[100:103], a[68:71], a[4:7], 0
    ds_write_b128 v1, a[96:99] offset:0
    v_mfma_f32_16x16x32_bf16 v[72:75], a[72:75], a[0:3], 0
    ds_write_b128 v1, a[100:103] offset:1024
    v_mfma_f32_16x16x32_bf16 v[104:107], a[72:75], a[4:7], 0
    ds_write_b128 v1, a[104:107] offset:2048
    v_mfma_f32_16x16x32_bf16 v[76:79], a[76:79], a[0:3], 0
    ds_write_b128 v1, a[108:111] offset:3072
    v_mfma_f32_16x16x32_bf16 v[108:111], a[76:79], a[4:7], 0
    ds_write_b128 v1, a[112:115] offset:4096
    v_mfma_f32_16x16x32_bf16 v[80:83], a[80:83], a[0:3], 0
    ds_write_b128 v1, a[116:119] offset:5120
    v_mfma_f32_16x16x32_bf16 v[112:115], a[80:83], a[4:7], 0
    ds_write_b128 v1, a[120:123] offset:6144
    v_mfma_f32_16x16x32_bf16 v[84:87], a[84:87], a[0:3], 0
    ds_write_b128 v1, a[124:127] offset:7168
    v_mfma_f32_16x16x32_bf16 v[116:119], a[84:87], a[4:7], 0
    v_mfma_f32_16x16x32_bf16 v[88:91], a[88:91], a[0:3], 0
    v_mfma_f32_16x16x32_bf16 v[120:123], a[88:91], a[4:7], 0
    v_mfma_f32_16x16x32_bf16 v[92:95], a[92:95], a[0:3], 0
    v_mfma_f32_16x16x32_bf16 v[124:127], a[92:95], a[4:7], 0
    v_mfma_f32_16x16x32_bf16 v[64:67], a[216:219], a[8:11], v[64:67]
    v_mfma_f32_16x16x32_bf16 v[96:99], a[216:219], a[12:15], v[96:99]
    v_add_u32 v0, 49152, v0
    global_load_dwordx4 v[128:131], v0, s[14:15] offset:-3072
    ds_read_b128 a[56:59], v10 offset:14784
    ds_read_b128 a[60:63], v10 offset:15040
    v_mfma_f32_16x16x32_bf16 v[68:71], a[220:223], a[8:11], v[68:71]
    v_mfma_f32_16x16x32_bf16 v[100:103], a[220:223], a[12:15], v[100:103]
    v_mfma_f32_16x16x32_bf16 v[72:75], a[224:227], a[8:11], v[72:75]
    v_mfma_f32_16x16x32_bf16 v[104:107], a[224:227], a[12:15], v[104:107]
    v_mfma_f32_16x16x32_bf16 v[76:79], a[228:231], a[8:11], v[76:79]
    global_load_dwordx4 v[132:135], v0, s[14:15] offset:-1536
    v_mfma_f32_16x16x32_bf16 v[108:111], a[228:231], a[12:15], v[108:111]
    v_mfma_f32_16x16x32_bf16 v[80:83], a[232:235], a[8:11], v[80:83]
    v_mfma_f32_16x16x32_bf16 v[112:115], a[232:235], a[12:15], v[112:115]
    v_mfma_f32_16x16x32_bf16 v[84:87], a[236:239], a[8:11], v[84:87]
    v_mfma_f32_16x16x32_bf16 v[116:119], a[236:239], a[12:15], v[116:119]
    v_mfma_f32_16x16x32_bf16 v[88:91], a[240:243], a[8:11], v[88:91]
    global_load_dwordx4 v[136:139], v0, s[14:15] offset:0
    v_mfma_f32_16x16x32_bf16 v[120:123], a[240:243], a[12:15], v[120:123]
    v_mfma_f32_16x16x32_bf16 v[92:95], a[244:247], a[8:11], v[92:95]
    v_mfma_f32_16x16x32_bf16 v[124:127], a[244:247], a[12:15], v[124:127]
    s_waitcnt lgkmcnt(0)
    s_barrier
    v_mfma_f32_16x16x32_bf16 v[64:67], a[128:131], a[16:19], v[64:67]
    global_load_dwordx4 v[140:143], v0, s[14:15] offset:1536
    v_mfma_f32_16x16x32_bf16 v[96:99], a[128:131], a[20:23], v[96:99]
    v_mfma_f32_16x16x32_bf16 v[68:71], a[132:135], a[16:19], v[68:71]
    v_mfma_f32_16x16x32_bf16 v[100:103], a[132:135], a[20:23], v[100:103]
    v_mfma_f32_16x16x32_bf16 v[72:75], a[136:139], a[16:19], v[72:75]
    v_mfma_f32_16x16x32_bf16 v[104:107], a[136:139], a[20:23], v[104:107]
    v_mfma_f32_16x16x32_bf16 v[76:79], a[140:143], a[16:19], v[76:79]
    global_load_dwordx4 v[144:147], v0, s[14:15] offset:3072
    v_mfma_f32_16x16x32_bf16 v[108:111], a[140:143], a[20:23], v[108:111]
    v_mfma_f32_16x16x32_bf16 v[80:83], a[144:147], a[16:19], v[80:83]
    v_mfma_f32_16x16x32_bf16 v[112:115], a[144:147], a[20:23], v[112:115]
    v_mfma_f32_16x16x32_bf16 v[84:87], a[148:151], a[16:19], v[84:87]
    ds_read_b128 v[4:7], v2 offset:0
    ds_read_b128 v[8:11], v2 offset:1024
    v_mfma_f32_16x16x32_bf16 v[116:119], a[148:151], a[20:23], v[116:119]
    v_mfma_f32_16x16x32_bf16 v[88:91], a[152:155], a[16:19], v[88:91]
    global_load_dwordx4 v[148:151], v0, s[24:25] offset:-1536
    v_mfma_f32_16x16x32_bf16 v[120:123], a[152:155], a[20:23], v[120:123]
    s_waitcnt lgkmcnt(1)
    v_add_f32 v32, v32, v4
    v_mfma_f32_16x16x32_bf16 v[92:95], a[156:159], a[16:19], v[92:95]
    v_add_f32 v33, v33, v5
    v_mfma_f32_16x16x32_bf16 v[124:127], a[156:159], a[20:23], v[124:127]
    v_add_f32 v34, v34, v6
    v_mfma_f32_16x16x32_bf16 v[64:67], a[160:163], a[24:27], v[64:67]
    v_add_f32 v35, v35, v7
    v_mfma_f32_16x16x32_bf16 v[96:99], a[160:163], a[28:31], v[96:99]
    s_waitcnt lgkmcnt(0)
    v_add_f32 v36, v36, v8
    v_mfma_f32_16x16x32_bf16 v[68:71], a[164:167], a[24:27], v[68:71]
    global_load_dwordx4 v[152:155], v0, s[24:25] offset:0
    v_add_f32 v37, v37, v9
    v_mfma_f32_16x16x32_bf16 v[100:103], a[164:167], a[28:31], v[100:103]
    v_add_f32 v38, v38, v10
    v_mfma_f32_16x16x32_bf16 v[72:75], a[168:171], a[24:27], v[72:75]
    v_add_f32 v39, v39, v11
    v_mfma_f32_16x16x32_bf16 v[104:107], a[168:171], a[28:31], v[104:107]
    v_cvt_pk_bf16_f32 v32, v32, v33
    v_mfma_f32_16x16x32_bf16 v[76:79], a[172:175], a[24:27], v[76:79]
    v_cvt_pk_bf16_f32 v33, v34, v35
    v_mfma_f32_16x16x32_bf16 v[108:111], a[172:175], a[28:31], v[108:111]
    v_cvt_pk_bf16_f32 v34, v36, v37
    v_mfma_f32_16x16x32_bf16 v[80:83], a[176:179], a[24:27], v[80:83]
    global_load_dwordx4 v[156:159], v0, s[24:25] offset:1536
    v_cvt_pk_bf16_f32 v35, v38, v39
    v_mfma_f32_16x16x32_bf16 v[112:115], a[176:179], a[28:31], v[112:115]
    v_mfma_f32_16x16x32_bf16 v[84:87], a[180:183], a[24:27], v[84:87]
    ds_read_b128 v[4:7], v2 offset:2048
    ds_read_b128 v[8:11], v2 offset:3072
    v_mfma_f32_16x16x32_bf16 v[116:119], a[180:183], a[28:31], v[116:119]
    v_mfma_f32_16x16x32_bf16 v[88:91], a[184:187], a[24:27], v[88:91]
    s_waitcnt vmcnt(24)
    v_perm_b32 v16, v164, v160, s40
    v_perm_b32 v17, v172, v168, s40
    v_mfma_f32_16x16x32_bf16 v[120:123], a[184:187], a[28:31], v[120:123]
    global_store_dwordx4 v12, a[200:203], s[16:17] offset:0 sc1
    s_waitcnt lgkmcnt(1)
    v_add_f32 v40, v40, v4
    v_perm_b32 v18, v180, v176, s40
    v_perm_b32 v19, v188, v184, s40
    v_mfma_f32_16x16x32_bf16 v[92:95], a[188:191], a[24:27], v[92:95]
    v_add_f32 v41, v41, v5
    v_perm_b32 v20, v164, v160, s41
    v_perm_b32 v21, v172, v168, s41
    v_mfma_f32_16x16x32_bf16 v[124:127], a[188:191], a[28:31], v[124:127]
    v_add_f32 v42, v42, v6
    v_perm_b32 v22, v180, v176, s41
    v_perm_b32 v23, v188, v184, s41
    v_mfma_f32_16x16x32_bf16 v[64:67], v[16:19], a[32:35], v[64:67]
    v_add_f32 v43, v43, v7
    v_perm_b32 v24, v165, v161, s40
    v_perm_b32 v25, v173, v169, s40
    v_mfma_f32_16x16x32_bf16 v[96:99], v[16:19], a[36:39], v[96:99]
    global_store_dwordx4 v12, a[204:207], s[16:17] offset:128 sc1
    s_waitcnt lgkmcnt(0)
    v_add_f32 v44, v44, v8
    v_perm_b32 v26, v181, v177, s40
    v_perm_b32 v27, v189, v185, s40
    v_mfma_f32_16x16x32_bf16 v[68:71], v[20:23], a[32:35], v[68:71]
    v_add_f32 v45, v45, v9
    v_perm_b32 v28, v165, v161, s41
    v_perm_b32 v29, v173, v169, s41
    v_mfma_f32_16x16x32_bf16 v[100:103], v[20:23], a[36:39], v[100:103]
    v_add_f32 v46, v46, v10
    v_perm_b32 v30, v181, v177, s41
    v_perm_b32 v31, v189, v185, s41
    v_mfma_f32_16x16x32_bf16 v[72:75], v[24:27], a[32:35], v[72:75]
    v_add_f32 v47, v47, v11
    v_perm_b32 v16, v166, v162, s40
    v_perm_b32 v17, v174, v170, s40
    v_mfma_f32_16x16x32_bf16 v[104:107], v[24:27], a[36:39], v[104:107]
    global_store_dwordx4 v12, a[208:211], s[16:17] offset:256 sc1
    v_cvt_pk_bf16_f32 v40, v40, v41
    v_perm_b32 v18, v182, v178, s40
    v_perm_b32 v19, v190, v186, s40
    v_mfma_f32_16x16x32_bf16 v[76:79], v[28:31], a[32:35], v[76:79]
    v_cvt_pk_bf16_f32 v41, v42, v43
    v_perm_b32 v20, v166, v162, s41
    v_perm_b32 v21, v174, v170, s41
    v_mfma_f32_16x16x32_bf16 v[108:111], v[28:31], a[36:39], v[108:111]
    v_cvt_pk_bf16_f32 v42, v44, v45
    v_perm_b32 v22, v182, v178, s41
    v_perm_b32 v23, v190, v186, s41
    v_mfma_f32_16x16x32_bf16 v[80:83], v[16:19], a[32:35], v[80:83]
    v_cvt_pk_bf16_f32 v43, v46, v47
    v_perm_b32 v24, v167, v163, s40
    v_perm_b32 v25, v175, v171, s40
    v_mfma_f32_16x16x32_bf16 v[112:115], v[16:19], a[36:39], v[112:115]
    global_store_dwordx4 v12, a[212:215], s[16:17] offset:384 sc1
    v_perm_b32 v26, v183, v179, s40
    v_perm_b32 v27, v191, v187, s40
    v_mfma_f32_16x16x32_bf16 v[84:87], v[20:23], a[32:35], v[84:87]
    ds_read_b128 v[4:7], v2 offset:4096
    ds_read_b128 v[8:11], v2 offset:5120
    v_perm_b32 v28, v167, v163, s41
    v_perm_b32 v29, v175, v171, s41
    v_mfma_f32_16x16x32_bf16 v[116:119], v[20:23], a[36:39], v[116:119]
    v_perm_b32 v30, v183, v179, s41
    v_perm_b32 v31, v191, v187, s41
    v_mfma_f32_16x16x32_bf16 v[88:91], v[24:27], a[32:35], v[88:91]
    s_waitcnt vmcnt(20)
    v_perm_b32 v16, v196, v192, s40
    v_perm_b32 v17, v204, v200, s40
    v_mfma_f32_16x16x32_bf16 v[120:123], v[24:27], a[36:39], v[120:123]
    s_waitcnt lgkmcnt(1)
    v_add_f32 v48, v48, v4
    v_perm_b32 v18, v212, v208, s40
    v_perm_b32 v19, v220, v216, s40
    v_mfma_f32_16x16x32_bf16 v[92:95], v[28:31], a[32:35], v[92:95]
    global_store_dwordx4 v3, v[32:35], s[48:49] offset:0 sc1
    v_add_f32 v49, v49, v5
    v_perm_b32 v20, v196, v192, s41
    v_perm_b32 v21, v204, v200, s41
    v_mfma_f32_16x16x32_bf16 v[124:127], v[28:31], a[36:39], v[124:127]
    v_add_f32 v50, v50, v6
    v_perm_b32 v22, v212, v208, s41
    v_perm_b32 v23, v220, v216, s41
    v_mfma_f32_16x16x32_bf16 v[64:67], v[16:19], a[40:43], v[64:67]
    v_add_f32 v51, v51, v7
    v_perm_b32 v24, v197, v193, s40
    v_perm_b32 v25, v205, v201, s40
    v_mfma_f32_16x16x32_bf16 v[96:99], v[16:19], a[44:47], v[96:99]
    s_waitcnt lgkmcnt(0)
    v_add_f32 v52, v52, v8
    v_perm_b32 v26, v213, v209, s40
    v_perm_b32 v27, v221, v217, s40
    v_mfma_f32_16x16x32_bf16 v[68:71], v[20:23], a[40:43], v[68:71]
    global_store_dwordx4 v3, v[40:43], s[48:49] offset:128 sc1
    v_add_f32 v53, v53, v9
    v_perm_b32 v28, v197, v193, s41
    v_perm_b32 v29, v205, v201, s41
    v_mfma_f32_16x16x32_bf16 v[100:103], v[20:23], a[44:47], v[100:103]
    v_add_f32 v54, v54, v10
    v_perm_b32 v30, v213, v209, s41
    v_perm_b32 v31, v221, v217, s41
    v_mfma_f32_16x16x32_bf16 v[72:75], v[24:27], a[40:43], v[72:75]
    v_add_f32 v55, v55, v11
    v_perm_b32 v16, v198, v194, s40
    v_perm_b32 v17, v206, v202, s40
    v_mfma_f32_16x16x32_bf16 v[104:107], v[24:27], a[44:47], v[104:107]
    v_cvt_pk_bf16_f32 v48, v48, v49
    v_perm_b32 v18, v214, v210, s40
    v_perm_b32 v19, v222, v218, s40
    v_mfma_f32_16x16x32_bf16 v[76:79], v[28:31], a[40:43], v[76:79]
    v_cvt_pk_bf16_f32 v49, v50, v51
    v_perm_b32 v20, v198, v194, s41
    v_perm_b32 v21, v206, v202, s41
    v_mfma_f32_16x16x32_bf16 v[108:111], v[28:31], a[44:47], v[108:111]
    v_cvt_pk_bf16_f32 v50, v52, v53
    v_perm_b32 v22, v214, v210, s41
    v_perm_b32 v23, v222, v218, s41
    v_mfma_f32_16x16x32_bf16 v[80:83], v[16:19], a[40:43], v[80:83]
    v_cvt_pk_bf16_f32 v51, v54, v55
    v_perm_b32 v24, v199, v195, s40
    v_perm_b32 v25, v207, v203, s40
    v_mfma_f32_16x16x32_bf16 v[112:115], v[16:19], a[44:47], v[112:115]
    v_perm_b32 v26, v215, v211, s40
    v_perm_b32 v27, v223, v219, s40
    v_mfma_f32_16x16x32_bf16 v[84:87], v[20:23], a[40:43], v[84:87]
    global_store_dwordx4 v3, v[48:51], s[48:49] offset:1024 sc1
    ds_read_b128 v[4:7], v2 offset:6144
    ds_read_b128 v[8:11], v2 offset:7168
    v_perm_b32 v28, v199, v195, s41
    v_perm_b32 v29, v207, v203, s41
    v_mfma_f32_16x16x32_bf16 v[116:119], v[20:23], a[44:47], v[116:119]
    v_perm_b32 v30, v215, v211, s41
    v_perm_b32 v31, v223, v219, s41
    v_mfma_f32_16x16x32_bf16 v[88:91], v[24:27], a[40:43], v[88:91]
    s_waitcnt vmcnt(15)
    v_perm_b32 v16, v228, v224, s40
    v_perm_b32 v17, v236, v232, s40
    v_mfma_f32_16x16x32_bf16 v[120:123], v[24:27], a[44:47], v[120:123]
    s_waitcnt lgkmcnt(1)
    v_add_f32 v56, v56, v4
    v_perm_b32 v18, v244, v240, s40
    v_perm_b32 v19, v252, v248, s40
    v_mfma_f32_16x16x32_bf16 v[92:95], v[28:31], a[40:43], v[92:95]
    v_add_f32 v57, v57, v5
    v_perm_b32 v20, v228, v224, s41
    v_perm_b32 v21, v236, v232, s41
    v_mfma_f32_16x16x32_bf16 v[124:127], v[28:31], a[44:47], v[124:127]
    v_add_f32 v58, v58, v6
    v_perm_b32 v22, v244, v240, s41
    v_perm_b32 v23, v252, v248, s41
    v_mfma_f32_16x16x32_bf16 v[64:67], v[16:19], a[48:51], v[64:67]
    v_add_f32 v59, v59, v7
    v_perm_b32 v24, v229, v225, s40
    v_perm_b32 v25, v237, v233, s40
    v_mfma_f32_16x16x32_bf16 v[96:99], v[16:19], a[52:55], v[96:99]
    s_waitcnt lgkmcnt(0)
    v_add_f32 v60, v60, v8
    v_perm_b32 v26, v245, v241, s40
    v_perm_b32 v27, v253, v249, s40
    v_mfma_f32_16x16x32_bf16 v[68:71], v[20:23], a[48:51], v[68:71]
    v_add_f32 v61, v61, v9
    v_perm_b32 v28, v229, v225, s41
    v_perm_b32 v29, v237, v233, s41
    v_mfma_f32_16x16x32_bf16 v[100:103], v[20:23], a[52:55], v[100:103]
    v_add_f32 v62, v62, v10
    v_perm_b32 v30, v245, v241, s41
    v_perm_b32 v31, v253, v249, s41
    v_mfma_f32_16x16x32_bf16 v[72:75], v[24:27], a[48:51], v[72:75]
    v_add_f32 v63, v63, v11
    v_perm_b32 v16, v230, v226, s40
    v_perm_b32 v17, v238, v234, s40
    v_mfma_f32_16x16x32_bf16 v[104:107], v[24:27], a[52:55], v[104:107]
    v_cvt_pk_bf16_f32 v56, v56, v57
    v_perm_b32 v18, v246, v242, s40
    v_perm_b32 v19, v254, v250, s40
    v_mfma_f32_16x16x32_bf16 v[76:79], v[28:31], a[48:51], v[76:79]
    v_cvt_pk_bf16_f32 v57, v58, v59
    v_perm_b32 v20, v230, v226, s41
    v_perm_b32 v21, v238, v234, s41
    v_mfma_f32_16x16x32_bf16 v[108:111], v[28:31], a[52:55], v[108:111]
    v_cvt_pk_bf16_f32 v58, v60, v61
    v_perm_b32 v22, v246, v242, s41
    v_perm_b32 v23, v254, v250, s41
    v_mfma_f32_16x16x32_bf16 v[80:83], v[16:19], a[48:51], v[80:83]
    v_cvt_pk_bf16_f32 v59, v62, v63
    v_perm_b32 v24, v231, v227, s40
    v_perm_b32 v25, v239, v235, s40
    v_mfma_f32_16x16x32_bf16 v[112:115], v[16:19], a[52:55], v[112:115]
    v_perm_b32 v26, v247, v243, s40
    v_perm_b32 v27, v255, v251, s40
    v_mfma_f32_16x16x32_bf16 v[84:87], v[20:23], a[48:51], v[84:87]
    global_store_dwordx4 v3, v[56:59], s[48:49] offset:1152 sc1
    v_perm_b32 v28, v231, v227, s41
    v_perm_b32 v29, v239, v235, s41
    v_mfma_f32_16x16x32_bf16 v[116:119], v[20:23], a[52:55], v[116:119]
    v_perm_b32 v30, v247, v243, s41
    v_perm_b32 v31, v255, v251, s41
    v_mfma_f32_16x16x32_bf16 v[88:91], v[24:27], a[48:51], v[88:91]
    s_waitcnt vmcnt(8)
    v_perm_b32 v16, v132, v128, s40
    v_perm_b32 v17, v140, v136, s40
    v_mfma_f32_16x16x32_bf16 v[120:123], v[24:27], a[52:55], v[120:123]
    v_perm_b32 v18, v148, v144, s40
    v_perm_b32 v19, v156, v152, s40
    v_mfma_f32_16x16x32_bf16 v[92:95], v[28:31], a[48:51], v[92:95]
    v_perm_b32 v20, v132, v128, s41
    v_perm_b32 v21, v140, v136, s41
    v_mfma_f32_16x16x32_bf16 v[124:127], v[28:31], a[52:55], v[124:127]
    v_perm_b32 v22, v148, v144, s41
    v_perm_b32 v23, v156, v152, s41
    v_mfma_f32_16x16x32_bf16 v[64:67], v[16:19], a[56:59], v[64:67]
    v_perm_b32 v24, v133, v129, s40
    v_perm_b32 v25, v141, v137, s40
    v_mfma_f32_16x16x32_bf16 v[96:99], v[16:19], a[60:63], v[96:99]
    v_perm_b32 v26, v149, v145, s40
    v_perm_b32 v27, v157, v153, s40
    v_mfma_f32_16x16x32_bf16 v[68:71], v[20:23], a[56:59], v[68:71]
    v_perm_b32 v28, v133, v129, s41
    v_perm_b32 v29, v141, v137, s41
    v_mfma_f32_16x16x32_bf16 v[100:103], v[20:23], a[60:63], v[100:103]
    v_perm_b32 v30, v149, v145, s41
    v_perm_b32 v31, v157, v153, s41
    v_mfma_f32_16x16x32_bf16 v[72:75], v[24:27], a[56:59], v[72:75]
    v_perm_b32 v16, v134, v130, s40
    v_perm_b32 v17, v142, v138, s40
    v_mfma_f32_16x16x32_bf16 v[104:107], v[24:27], a[60:63], v[104:107]
    v_perm_b32 v18, v150, v146, s40
    v_perm_b32 v19, v158, v154, s40
    v_mfma_f32_16x16x32_bf16 v[76:79], v[28:31], a[56:59], v[76:79]
    v_perm_b32 v20, v134, v130, s41
    v_perm_b32 v21, v142, v138, s41
    v_mfma_f32_16x16x32_bf16 v[108:111], v[28:31], a[60:63], v[108:111]
    v_perm_b32 v22, v150, v146, s41
    v_perm_b32 v23, v158, v154, s41
    v_mfma_f32_16x16x32_bf16 v[80:83], v[16:19], a[56:59], v[80:83]
    v_perm_b32 v24, v135, v131, s40
    v_perm_b32 v25, v143, v139, s40
    v_mfma_f32_16x16x32_bf16 v[112:115], v[16:19], a[60:63], v[112:115]
    v_perm_b32 v26, v151, v147, s40
    v_perm_b32 v27, v159, v155, s40
    v_mfma_f32_16x16x32_bf16 v[84:87], v[20:23], a[56:59], v[84:87]
    v_perm_b32 v28, v135, v131, s41
    v_perm_b32 v29, v143, v139, s41
    v_mfma_f32_16x16x32_bf16 v[116:119], v[20:23], a[60:63], v[116:119]
    v_perm_b32 v30, v151, v147, s41
    v_perm_b32 v31, v159, v155, s41
    v_accvgpr_read_b32 v1, a195
    v_mfma_f32_16x16x32_bf16 v[88:91], v[24:27], a[56:59], v[88:91]
    v_mfma_f32_16x16x32_bf16 v[120:123], v[24:27], a[60:63], v[120:123]
    v_mfma_f32_16x16x32_bf16 v[92:95], v[28:31], a[56:59], v[92:95]
    v_mfma_f32_16x16x32_bf16 v[124:127], v[28:31], a[60:63], v[124:127]
    v_pk_mul_f32 v[64:65], v[64:65], s[50:51]
    v_pk_mul_f32 v[68:69], v[68:69], s[50:51]
    v_pk_mul_f32 v[72:73], v[72:73], s[50:51]
    v_pk_mul_f32 v[76:77], v[76:77], s[50:51]
    v_pk_mul_f32 v[80:81], v[80:81], s[50:51]
    v_pk_mul_f32 v[84:85], v[84:85], s[50:51]
    v_pk_mul_f32 v[88:89], v[88:89], s[50:51]
    v_pk_mul_f32 v[92:93], v[92:93], s[50:51]
    v_cvt_pk_bf16_f32 v4, v64, v68
    v_cvt_pk_bf16_f32 v5, v72, v76
    v_cvt_pk_bf16_f32 v6, v80, v84
    v_cvt_pk_bf16_f32 v7, v88, v92
    global_store_dwordx4 v1, v[4:7], s[44:45] offset:0 sc1
    v_cvt_pk_bf16_f32 v8, v65, v69
    v_cvt_pk_bf16_f32 v9, v73, v77
    v_cvt_pk_bf16_f32 v10, v81, v85
    v_cvt_pk_bf16_f32 v11, v89, v93
    global_store_dwordx4 v1, v[8:11], s[44:45] offset:512 sc1
    v_pk_mul_f32 v[66:67], v[66:67], s[50:51]
    v_pk_mul_f32 v[70:71], v[70:71], s[50:51]
    v_pk_mul_f32 v[74:75], v[74:75], s[50:51]
    v_pk_mul_f32 v[78:79], v[78:79], s[50:51]
    v_pk_mul_f32 v[82:83], v[82:83], s[50:51]
    v_pk_mul_f32 v[86:87], v[86:87], s[50:51]
    v_pk_mul_f32 v[90:91], v[90:91], s[50:51]
    v_pk_mul_f32 v[94:95], v[94:95], s[50:51]
    v_cvt_pk_bf16_f32 v12, v66, v70
    v_cvt_pk_bf16_f32 v13, v74, v78
    v_cvt_pk_bf16_f32 v14, v82, v86
    v_cvt_pk_bf16_f32 v15, v90, v94
    global_store_dwordx4 v1, v[12:15], s[44:45] offset:1024 sc1
    v_cvt_pk_bf16_f32 v16, v67, v71
    v_cvt_pk_bf16_f32 v17, v75, v79
    v_cvt_pk_bf16_f32 v18, v83, v87
    v_cvt_pk_bf16_f32 v19, v91, v95
    global_store_dwordx4 v1, v[16:19], s[44:45] offset:1536 sc1
    v_pk_mul_f32 v[96:97], v[96:97], s[50:51]
    v_pk_mul_f32 v[100:101], v[100:101], s[50:51]
    v_pk_mul_f32 v[104:105], v[104:105], s[50:51]
    v_pk_mul_f32 v[108:109], v[108:109], s[50:51]
    v_pk_mul_f32 v[112:113], v[112:113], s[50:51]
    v_pk_mul_f32 v[116:117], v[116:117], s[50:51]
    v_pk_mul_f32 v[120:121], v[120:121], s[50:51]
    v_pk_mul_f32 v[124:125], v[124:125], s[50:51]
    v_cvt_pk_bf16_f32 v20, v96, v100
    v_cvt_pk_bf16_f32 v21, v104, v108
    v_cvt_pk_bf16_f32 v22, v112, v116
    v_cvt_pk_bf16_f32 v23, v120, v124
    global_store_dwordx4 v1, v[20:23], s[44:45] offset:2048 sc1
    v_cvt_pk_bf16_f32 v24, v97, v101
    v_cvt_pk_bf16_f32 v25, v105, v109
    v_cvt_pk_bf16_f32 v26, v113, v117
    v_cvt_pk_bf16_f32 v27, v121, v125
    global_store_dwordx4 v1, v[24:27], s[44:45] offset:2560 sc1
    v_pk_mul_f32 v[98:99], v[98:99], s[50:51]
    v_pk_mul_f32 v[102:103], v[102:103], s[50:51]
    v_pk_mul_f32 v[106:107], v[106:107], s[50:51]
    v_pk_mul_f32 v[110:111], v[110:111], s[50:51]
    v_pk_mul_f32 v[114:115], v[114:115], s[50:51]
    v_pk_mul_f32 v[118:119], v[118:119], s[50:51]
    v_pk_mul_f32 v[122:123], v[122:123], s[50:51]
    v_pk_mul_f32 v[126:127], v[126:127], s[50:51]
    v_cvt_pk_bf16_f32 v28, v98, v102
    v_cvt_pk_bf16_f32 v29, v106, v110
    v_cvt_pk_bf16_f32 v30, v114, v118
    v_cvt_pk_bf16_f32 v31, v122, v126
    global_store_dwordx4 v1, v[28:31], s[44:45] offset:3072 sc1
    v_cvt_pk_bf16_f32 v4, v99, v103
    v_cvt_pk_bf16_f32 v5, v107, v111
    v_cvt_pk_bf16_f32 v6, v115, v119
    v_cvt_pk_bf16_f32 v7, v123, v127
    global_store_dwordx4 v1, v[4:7], s[44:45] offset:3584 sc1
    s_branch K2_START
K1_KP:
    ds_read_b128 a[32:35], v10 offset:8448
    ds_read_b128 a[36:39], v10 offset:8704
    ds_read_b128 a[40:43], v10 offset:10560
    ds_read_b128 a[44:47], v10 offset:10816
    global_load_dwordx4 v[236:239], v0, s[14:15] offset:1536
    v_perm_b32 v16, v100, v96, s40
    v_perm_b32 v17, v108, v104, s40
    v_perm_b32 v18, v116, v112, s40
    v_perm_b32 v19, v124, v120, s40
    v_perm_b32 v20, v100, v96, s41
    v_perm_b32 v21, v108, v104, s41
    v_perm_b32 v22, v116, v112, s41
    v_perm_b32 v23, v124, v120, s41
    s_waitcnt lgkmcnt(3)
    v_mfma_f32_16x16x32_bf16 a[96:99], a[32:35], v[16:19], 0
    global_load_dwordx4 v[240:243], v0, s[14:15] offset:3072
    v_perm_b32 v24, v101, v97, s40
    v_perm_b32 v25, v109, v105, s40
    s_waitcnt lgkmcnt(2)
    v_mfma_f32_16x16x32_bf16 a[100:103], a[36:39], v[16:19], 0
    global_load_dwordx4 v[244:247], v0, s[24:25] offset:-1536
    ds_read_b128 a[48:51], v10 offset:12672
    ds_read_b128 a[52:55], v10 offset:12928
    v_perm_b32 v26, v117, v113, s40
    v_perm_b32 v27, v125, v121, s40
    v_mov_b32 v1, v4
    v_mfma_f32_16x16x32_bf16 a[104:107], a[32:35], v[20:23], 0
    global_load_dwordx4 v[248:251], v0, s[24:25] offset:0
    v_perm_b32 v28, v101, v97, s41
    v_perm_b32 v29, v109, v105, s41
    v_mfma_f32_16x16x32_bf16 a[108:111], a[36:39], v[20:23], 0
    global_load_dwordx4 v[252:255], v0, s[24:25] offset:1536
    v_perm_b32 v30, v117, v113, s41
    v_perm_b32 v31, v125, v121, s41
    v_mfma_f32_16x16x32_bf16 a[112:115], a[32:35], v[24:27], 0
    v_add_u32 v0, 49152, v0
    global_load_dwordx4 v[128:131], v0, s[14:15] offset:-3072
    v_perm_b32 v16, v102, v98, s40
    v_perm_b32 v17, v110, v106, s40
    v_mfma_f32_16x16x32_bf16 a[116:119], a[36:39], v[24:27], 0
    global_load_dwordx4 v[132:135], v0, s[14:15] offset:-1536
    v_perm_b32 v18, v118, v114, s40
    v_perm_b32 v19, v126, v122, s40
    v_mfma_f32_16x16x32_bf16 a[120:123], a[32:35], v[28:31], 0
    global_load_dwordx4 v[136:139], v0, s[14:15] offset:0
    v_perm_b32 v20, v102, v98, s41
    v_perm_b32 v21, v110, v106, s41
    v_mov_b32 v2, v5
    v_mfma_f32_16x16x32_bf16 a[124:127], a[36:39], v[28:31], 0
    global_load_dwordx4 v[140:143], v0, s[14:15] offset:1536
    v_perm_b32 v22, v118, v114, s41
    v_perm_b32 v23, v126, v122, s41
    v_mfma_f32_16x16x32_bf16 v[32:35], a[32:35], v[16:19], 0
    v_perm_b32 v24, v103, v99, s40
    v_perm_b32 v25, v111, v107, s40
    v_mfma_f32_16x16x32_bf16 v[36:39], a[36:39], v[16:19], 0
    global_load_dwordx4 v[144:147], v0, s[14:15] offset:3072
    v_perm_b32 v26, v119, v115, s40
    v_perm_b32 v27, v127, v123, s40
    v_mfma_f32_16x16x32_bf16 v[40:43], a[32:35], v[20:23], 0
    v_perm_b32 v28, v103, v99, s41
    v_perm_b32 v29, v111, v107, s41
    v_mfma_f32_16x16x32_bf16 v[44:47], a[36:39], v[20:23], 0
    global_load_dwordx4 v[148:151], v0, s[24:25] offset:-1536
    v_perm_b32 v30, v119, v115, s41
    v_perm_b32 v31, v127, v123, s41
    v_mov_b32 v12, v8
    v_mfma_f32_16x16x32_bf16 v[48:51], a[32:35], v[24:27], 0
    s_waitcnt vmcnt(14)
    v_perm_b32 v16, v196, v192, s40
    v_perm_b32 v17, v204, v200, s40
    v_mfma_f32_16x16x32_bf16 v[52:55], a[36:39], v[24:27], 0
    global_load_dwordx4 v[152:155], v0, s[24:25] offset:0
    v_perm_b32 v18, v212, v208, s40
    v_perm_b32 v19, v220, v216, s40
    v_mfma_f32_16x16x32_bf16 v[56:59], a[32:35], v[28:31], 0
    global_load_dwordx4 v[156:159], v0, s[24:25] offset:1536
    v_perm_b32 v20, v196, v192, s41
    v_perm_b32 v21, v204, v200, s41
    v_mfma_f32_16x16x32_bf16 v[60:63], a[36:39], v[28:31], 0
    v_accvgpr_read_b32 v0, a193
    v_add_u32 v0, 196608, v0
    global_load_dwordx4 v[160:163], v0, s[14:15] offset:-3072
    v_perm_b32 v22, v212, v208, s41
    v_perm_b32 v23, v220, v216, s41
    s_waitcnt lgkmcnt(3)
    v_mfma_f32_16x16x32_bf16 a[96:99], a[40:43], v[16:19], a[96:99]
    global_load_dwordx4 v[164:167], v0, s[14:15] offset:-1536
    v_perm_b32 v24, v197, v193, s40
    v_perm_b32 v25, v205, v201, s40
    s_waitcnt lgkmcnt(2)
    v_mfma_f32_16x16x32_bf16 a[100:103], a[44:47], v[16:19], a[100:103]
    ds_read_b128 a[56:59], v10 offset:14784
    ds_read_b128 a[60:63], v10 offset:15040
    v_perm_b32 v26, v213, v209, s40
    v_perm_b32 v27, v221, v217, s40
    v_mfma_f32_16x16x32_bf16 a[104:107], a[40:43], v[20:23], a[104:107]
    global_load_dwordx4 v[168:171], v0, s[14:15] offset:0
    v_perm_b32 v28, v197, v193, s41
    v_perm_b32 v29, v205, v201, s41
    v_mfma_f32_16x16x32_bf16 a[108:111], a[44:47], v[20:23], a[108:111]
    v_perm_b32 v30, v213, v209, s41
    v_perm_b32 v31, v221, v217, s41
    v_mfma_f32_16x16x32_bf16 a[112:115], a[40:43], v[24:27], a[112:115]
    global_load_dwordx4 v[172:175], v0, s[14:15] offset:1536
    v_perm_b32 v16, v198, v194, s40
    v_perm_b32 v17, v206, v202, s40
    v_mfma_f32_16x16x32_bf16 a[116:119], a[44:47], v[24:27], a[116:119]
    v_perm_b32 v18, v214, v210, s40
    v_perm_b32 v19, v222, v218, s40
    v_mfma_f32_16x16x32_bf16 a[120:123], a[40:43], v[28:31], a[120:123]
    global_load_dwordx4 v[176:179], v0, s[14:15] offset:3072
    v_perm_b32 v20, v198, v194, s41
    v_perm_b32 v21, v206, v202, s41
    v_mfma_f32_16x16x32_bf16 a[124:127], a[44:47], v[28:31], a[124:127]
    v_perm_b32 v22, v214, v210, s41
    v_perm_b32 v23, v222, v218, s41
    v_mfma_f32_16x16x32_bf16 v[32:35], a[40:43], v[16:19], v[32:35]
    global_load_dwordx4 v[180:183], v0, s[24:25] offset:-1536
    v_perm_b32 v24, v199, v195, s40
    v_perm_b32 v25, v207, v203, s40
    v_mfma_f32_16x16x32_bf16 v[36:39], a[44:47], v[16:19], v[36:39]
    v_perm_b32 v26, v215, v211, s40
    v_perm_b32 v27, v223, v219, s40
    v_mfma_f32_16x16x32_bf16 v[40:43], a[40:43], v[20:23], v[40:43]
    global_load_dwordx4 v[184:187], v0, s[24:25] offset:0
    v_perm_b32 v28, v199, v195, s41
    v_perm_b32 v29, v207, v203, s41
    v_mfma_f32_16x16x32_bf16 v[44:47], a[44:47], v[20:23], v[44:47]
    v_perm_b32 v30, v215, v211, s41
    v_perm_b32 v31, v223, v219, s41
    v_mfma_f32_16x16x32_bf16 v[48:51], a[40:43], v[24:27], v[48:51]
    global_load_dwordx4 v[188:191], v0, s[24:25] offset:1536
    s_waitcnt vmcnt(16)
    v_perm_b32 v16, v228, v224, s40
    v_perm_b32 v17, v236, v232, s40
    v_mfma_f32_16x16x32_bf16 v[52:55], a[44:47], v[24:27], v[52:55]
    v_perm_b32 v18, v244, v240, s40
    v_perm_b32 v19, v252, v248, s40
    v_mfma_f32_16x16x32_bf16 v[56:59], a[40:43], v[28:31], v[56:59]
    v_add_u32 v0, 49152, v0
    global_load_dwordx4 v[192:195], v0, s[14:15] offset:-3072
    v_perm_b32 v20, v228, v224, s41
    v_perm_b32 v21, v236, v232, s41
    v_mfma_f32_16x16x32_bf16 v[60:63], a[44:47], v[28:31], v[60:63]
    v_perm_b32 v22, v244, v240, s41
    v_perm_b32 v23, v252, v248, s41
    s_waitcnt lgkmcnt(3)
    v_mfma_f32_16x16x32_bf16 a[96:99], a[48:51], v[16:19], a[96:99]
    global_load_dwordx4 v[196:199], v0, s[14:15] offset:-1536
    v_perm_b32 v24, v229, v225, s40
    v_perm_b32 v25, v237, v233, s40
    s_waitcnt lgkmcnt(2)
    v_mfma_f32_16x16x32_bf16 a[100:103], a[52:55], v[16:19], a[100:103]
    ds_read_b128 a[0:3], v10 offset:0
    ds_read_b128 a[4:7], v10 offset:256
    v_perm_b32 v26, v245, v241, s40
    v_perm_b32 v27, v253, v249, s40
    v_mfma_f32_16x16x32_bf16 a[104:107], a[48:51], v[20:23], a[104:107]
    global_load_dwordx4 v[200:203], v0, s[14:15] offset:0
    v_perm_b32 v28, v229, v225, s41
    v_perm_b32 v29, v237, v233, s41
    v_mfma_f32_16x16x32_bf16 a[108:111], a[52:55], v[20:23], a[108:111]
    v_perm_b32 v30, v245, v241, s41
    v_perm_b32 v31, v253, v249, s41
    v_mfma_f32_16x16x32_bf16 a[112:115], a[48:51], v[24:27], a[112:115]
    global_load_dwordx4 v[204:207], v0, s[14:15] offset:1536
    v_perm_b32 v16, v230, v226, s40
    v_perm_b32 v17, v238, v234, s40
    v_mfma_f32_16x16x32_bf16 a[116:119], a[52:55], v[24:27], a[116:119]
    v_perm_b32 v18, v246, v242, s40
    v_perm_b32 v19, v254, v250, s40
    v_mfma_f32_16x16x32_bf16 a[120:123], a[48:51], v[28:31], a[120:123]
    global_load_dwordx4 v[208:211], v0, s[14:15] offset:3072
    v_perm_b32 v20, v230, v226, s41
    v_perm_b32 v21, v238, v234, s41
    v_mfma_f32_16x16x32_bf16 a[124:127], a[52:55], v[28:31], a[124:127]
    v_perm_b32 v22, v246, v242, s41
    v_perm_b32 v23, v254, v250, s41
    v_mfma_f32_16x16x32_bf16 v[32:35], a[48:51], v[16:19], v[32:35]
    global_load_dwordx4 v[212:215], v0, s[24:25] offset:-1536
    v_perm_b32 v24, v231, v227, s40
    v_perm_b32 v25, v239, v235, s40
    v_mfma_f32_16x16x32_bf16 v[36:39], a[52:55], v[16:19], v[36:39]
    v_perm_b32 v26, v247, v243, s40
    v_perm_b32 v27, v255, v251, s40
    v_mfma_f32_16x16x32_bf16 v[40:43], a[48:51], v[20:23], v[40:43]
    global_load_dwordx4 v[216:219], v0, s[24:25] offset:0
    v_perm_b32 v28, v231, v227, s41
    v_perm_b32 v29, v239, v235, s41
    v_mfma_f32_16x16x32_bf16 v[44:47], a[52:55], v[20:23], v[44:47]
    v_perm_b32 v30, v247, v243, s41
    v_perm_b32 v31, v255, v251, s41
    v_mfma_f32_16x16x32_bf16 v[48:51], a[48:51], v[24:27], v[48:51]
    global_load_dwordx4 v[220:223], v0, s[24:25] offset:1536
    s_waitcnt vmcnt(16)
    v_perm_b32 v16, v132, v128, s40
    v_perm_b32 v17, v140, v136, s40
    v_mfma_f32_16x16x32_bf16 v[52:55], a[52:55], v[24:27], v[52:55]
    v_perm_b32 v18, v148, v144, s40
    v_perm_b32 v19, v156, v152, s40
    v_mfma_f32_16x16x32_bf16 v[56:59], a[48:51], v[28:31], v[56:59]
    v_add_u32 v0, 49152, v0
    global_load_dwordx4 v[224:227], v0, s[14:15] offset:-3072
    v_perm_b32 v20, v132, v128, s41
    v_perm_b32 v21, v140, v136, s41
    v_mfma_f32_16x16x32_bf16 v[60:63], a[52:55], v[28:31], v[60:63]
    v_perm_b32 v22, v148, v144, s41
    v_perm_b32 v23, v156, v152, s41
    s_waitcnt lgkmcnt(3)
    v_mfma_f32_16x16x32_bf16 a[96:99], a[56:59], v[16:19], a[96:99]
    global_load_dwordx4 v[228:231], v0, s[14:15] offset:-1536
    v_perm_b32 v24, v133, v129, s40
    v_perm_b32 v25, v141, v137, s40
    s_waitcnt lgkmcnt(2)
    v_mfma_f32_16x16x32_bf16 a[100:103], a[60:63], v[16:19], a[100:103]
    ds_read_b128 a[8:11], v10 offset:2112
    ds_read_b128 a[12:15], v10 offset:2368
    v_perm_b32 v26, v149, v145, s40
    v_perm_b32 v27, v157, v153, s40
    v_mfma_f32_16x16x32_bf16 a[104:107], a[56:59], v[20:23], a[104:107]
    global_load_dwordx4 v[232:235], v0, s[14:15] offset:0
    v_perm_b32 v28, v133, v129, s41
    v_perm_b32 v29, v141, v137, s41
    v_mfma_f32_16x16x32_bf16 a[108:111], a[60:63], v[20:23], a[108:111]
    v_perm_b32 v30, v149, v145, s41
    v_perm_b32 v31, v157, v153, s41
    v_mfma_f32_16x16x32_bf16 a[112:115], a[56:59], v[24:27], a[112:115]
    global_load_dwordx4 v[236:239], v0, s[14:15] offset:1536
    v_perm_b32 v16, v134, v130, s40
    v_perm_b32 v17, v142, v138, s40
    v_mfma_f32_16x16x32_bf16 a[116:119], a[60:63], v[24:27], a[116:119]
    v_perm_b32 v18, v150, v146, s40
    v_perm_b32 v19, v158, v154, s40
    v_mfma_f32_16x16x32_bf16 a[120:123], a[56:59], v[28:31], a[120:123]
    global_load_dwordx4 v[240:243], v0, s[14:15] offset:3072
    v_perm_b32 v20, v134, v130, s41
    v_perm_b32 v21, v142, v138, s41
    v_mfma_f32_16x16x32_bf16 a[124:127], a[60:63], v[28:31], a[124:127]
    v_perm_b32 v22, v150, v146, s41
    v_perm_b32 v23, v158, v154, s41
    v_mfma_f32_16x16x32_bf16 v[32:35], a[56:59], v[16:19], v[32:35]
    global_load_dwordx4 v[244:247], v0, s[24:25] offset:-1536
    v_perm_b32 v24, v135, v131, s40
    v_perm_b32 v25, v143, v139, s40
    v_mfma_f32_16x16x32_bf16 v[36:39], a[60:63], v[16:19], v[36:39]
    v_perm_b32 v26, v151, v147, s40
    v_perm_b32 v27, v159, v155, s40
    v_mfma_f32_16x16x32_bf16 v[40:43], a[56:59], v[20:23], v[40:43]
    global_load_dwordx4 v[248:251], v0, s[24:25] offset:0
    v_perm_b32 v28, v135, v131, s41
    v_perm_b32 v29, v143, v139, s41
    v_mfma_f32_16x16x32_bf16 v[44:47], a[60:63], v[20:23], v[44:47]
    v_perm_b32 v30, v151, v147, s41
    v_perm_b32 v31, v159, v155, s41
    v_mfma_f32_16x16x32_bf16 v[48:51], a[56:59], v[24:27], v[48:51]
    global_load_dwordx4 v[252:255], v0, s[24:25] offset:1536
    v_mfma_f32_16x16x32_bf16 v[52:55], a[60:63], v[24:27], v[52:55]
    v_mfma_f32_16x16x32_bf16 v[56:59], a[56:59], v[28:31], v[56:59]
    v_mfma_f32_16x16x32_bf16 v[60:63], a[60:63], v[28:31], v[60:63]
    s_waitcnt lgkmcnt(3)
    v_mfma_f32_16x16x32_bf16 v[64:67], a[64:67], a[0:3], 0
    s_waitcnt lgkmcnt(2)
    v_mfma_f32_16x16x32_bf16 v[96:99], a[64:67], a[4:7], 0
    ds_read_b128 a[16:19], v10 offset:4224
    ds_read_b128 a[20:23], v10 offset:4480
    v_mfma_f32_16x16x32_bf16 v[68:71], a[68:71], a[0:3], 0
    v_mfma_f32_16x16x32_bf16 v[100:103], a[68:71], a[4:7], 0
    ds_write_b128 v1, a[96:99] offset:0
    v_mfma_f32_16x16x32_bf16 v[72:75], a[72:75], a[0:3], 0
    ds_write_b128 v1, a[100:103] offset:1024
    v_mfma_f32_16x16x32_bf16 v[104:107], a[72:75], a[4:7], 0
    ds_write_b128 v1, a[104:107] offset:2048
    v_mfma_f32_16x16x32_bf16 v[76:79], a[76:79], a[0:3], 0
    ds_write_b128 v1, a[108:111] offset:3072
    v_mfma_f32_16x16x32_bf16 v[108:111], a[76:79], a[4:7], 0
    ds_write_b128 v1, a[112:115] offset:4096
    v_mfma_f32_16x16x32_bf16 v[80:83], a[80:83], a[0:3], 0
    ds_write_b128 v1, a[116:119] offset:5120
    v_mfma_f32_16x16x32_bf16 v[112:115], a[80:83], a[4:7], 0
    ds_write_b128 v1, a[120:123] offset:6144
    v_mfma_f32_16x16x32_bf16 v[84:87], a[84:87], a[0:3], 0
    ds_write_b128 v1, a[124:127] offset:7168
    v_mfma_f32_16x16x32_bf16 v[116:119], a[84:87], a[4:7], 0
    v_mfma_f32_16x16x32_bf16 v[88:91], a[88:91], a[0:3], 0
    v_mfma_f32_16x16x32_bf16 v[120:123], a[88:91], a[4:7], 0
    v_mfma_f32_16x16x32_bf16 v[92:95], a[92:95], a[0:3], 0
    v_mfma_f32_16x16x32_bf16 v[124:127], a[92:95], a[4:7], 0
    s_waitcnt lgkmcnt(11)
    v_mfma_f32_16x16x32_bf16 v[64:67], a[216:219], a[8:11], v[64:67]
    s_waitcnt lgkmcnt(10)
    v_mfma_f32_16x16x32_bf16 v[96:99], a[216:219], a[12:15], v[96:99]
    v_add_u32 v0, 49152, v0
    global_load_dwordx4 v[128:131], v0, s[14:15] offset:-3072
    ds_read_b128 a[24:27], v10 offset:6336
    ds_read_b128 a[28:31], v10 offset:6592
    v_mfma_f32_16x16x32_bf16 v[68:71], a[220:223], a[8:11], v[68:71]
    v_mfma_f32_16x16x32_bf16 v[100:103], a[220:223], a[12:15], v[100:103]
    v_mfma_f32_16x16x32_bf16 v[72:75], a[224:227], a[8:11], v[72:75]
    v_mfma_f32_16x16x32_bf16 v[104:107], a[224:227], a[12:15], v[104:107]
    v_mfma_f32_16x16x32_bf16 v[76:79], a[228:231], a[8:11], v[76:79]
    global_load_dwordx4 v[132:135], v0, s[14:15] offset:-1536
    v_mfma_f32_16x16x32_bf16 v[108:111], a[228:231], a[12:15], v[108:111]
    v_mfma_f32_16x16x32_bf16 v[80:83], a[232:235], a[8:11], v[80:83]
    v_mfma_f32_16x16x32_bf16 v[112:115], a[232:235], a[12:15], v[112:115]
    v_mfma_f32_16x16x32_bf16 v[84:87], a[236:239], a[8:11], v[84:87]
    v_mfma_f32_16x16x32_bf16 v[116:119], a[236:239], a[12:15], v[116:119]
    v_mfma_f32_16x16x32_bf16 v[88:91], a[240:243], a[8:11], v[88:91]
    global_load_dwordx4 v[136:139], v0, s[14:15] offset:0
    v_mfma_f32_16x16x32_bf16 v[120:123], a[240:243], a[12:15], v[120:123]
    v_mfma_f32_16x16x32_bf16 v[92:95], a[244:247], a[8:11], v[92:95]
    v_mfma_f32_16x16x32_bf16 v[124:127], a[244:247], a[12:15], v[124:127]
    s_waitcnt lgkmcnt(0)
    s_barrier
    v_mfma_f32_16x16x32_bf16 v[64:67], a[128:131], a[16:19], v[64:67]
    global_load_dwordx4 v[140:143], v0, s[14:15] offset:1536
    v_mfma_f32_16x16x32_bf16 v[96:99], a[128:131], a[20:23], v[96:99]
    v_mfma_f32_16x16x32_bf16 v[68:71], a[132:135], a[16:19], v[68:71]
    v_mfma_f32_16x16x32_bf16 v[100:103], a[132:135], a[20:23], v[100:103]
    v_mfma_f32_16x16x32_bf16 v[72:75], a[136:139], a[16:19], v[72:75]
    v_mfma_f32_16x16x32_bf16 v[104:107], a[136:139], a[20:23], v[104:107]
    v_mfma_f32_16x16x32_bf16 v[76:79], a[140:143], a[16:19], v[76:79]
    global_load_dwordx4 v[144:147], v0, s[14:15] offset:3072
    v_mfma_f32_16x16x32_bf16 v[108:111], a[140:143], a[20:23], v[108:111]
    v_mfma_f32_16x16x32_bf16 v[80:83], a[144:147], a[16:19], v[80:83]
    v_mfma_f32_16x16x32_bf16 v[112:115], a[144:147], a[20:23], v[112:115]
    v_mfma_f32_16x16x32_bf16 v[84:87], a[148:151], a[16:19], v[84:87]
    ds_read_b128 v[4:7], v2 offset:0
    ds_read_b128 v[8:11], v2 offset:1024
    v_mfma_f32_16x16x32_bf16 v[116:119], a[148:151], a[20:23], v[116:119]
    v_mfma_f32_16x16x32_bf16 v[88:91], a[152:155], a[16:19], v[88:91]
    global_load_dwordx4 v[148:151], v0, s[24:25] offset:-1536
    v_mfma_f32_16x16x32_bf16 v[120:123], a[152:155], a[20:23], v[120:123]
    s_waitcnt lgkmcnt(1)
    v_add_f32 v32, v32, v4
    v_mfma_f32_16x16x32_bf16 v[92:95], a[156:159], a[16:19], v[92:95]
    v_add_f32 v33, v33, v5
    v_mfma_f32_16x16x32_bf16 v[124:127], a[156:159], a[20:23], v[124:127]
    v_add_f32 v34, v34, v6
    v_mfma_f32_16x16x32_bf16 v[64:67], a[160:163], a[24:27], v[64:67]
    v_add_f32 v35, v35, v7
    v_mfma_f32_16x16x32_bf16 v[96:99], a[160:163], a[28:31], v[96:99]
    s_waitcnt lgkmcnt(0)
    v_add_f32 v36, v36, v8
    v_mfma_f32_16x16x32_bf16 v[68:71], a[164:167], a[24:27], v[68:71]
    global_load_dwordx4 v[152:155], v0, s[24:25] offset:0
    v_add_f32 v37, v37, v9
    v_mfma_f32_16x16x32_bf16 v[100:103], a[164:167], a[28:31], v[100:103]
    v_add_f32 v38, v38, v10
    v_mfma_f32_16x16x32_bf16 v[72:75], a[168:171], a[24:27], v[72:75]
    v_add_f32 v39, v39, v11
    v_mfma_f32_16x16x32_bf16 v[104:107], a[168:171], a[28:31], v[104:107]
    v_cvt_pk_bf16_f32 v32, v32, v33
    v_mfma_f32_16x16x32_bf16 v[76:79], a[172:175], a[24:27], v[76:79]
    v_cvt_pk_bf16_f32 v33, v34, v35
    v_mfma_f32_16x16x32_bf16 v[108:111], a[172:175], a[28:31], v[108:111]
    v_cvt_pk_bf16_f32 v34, v36, v37
    v_mfma_f32_16x16x32_bf16 v[80:83], a[176:179], a[24:27], v[80:83]
    global_load_dwordx4 v[156:159], v0, s[24:25] offset:1536
    v_cvt_pk_bf16_f32 v35, v38, v39
    v_mfma_f32_16x16x32_bf16 v[112:115], a[176:179], a[28:31], v[112:115]
    v_mfma_f32_16x16x32_bf16 v[84:87], a[180:183], a[24:27], v[84:87]
    ds_read_b128 v[4:7], v2 offset:2048
    ds_read_b128 v[8:11], v2 offset:3072
    v_mfma_f32_16x16x32_bf16 v[116:119], a[180:183], a[28:31], v[116:119]
    v_mfma_f32_16x16x32_bf16 v[88:91], a[184:187], a[24:27], v[88:91]
    s_waitcnt vmcnt(24)
    v_perm_b32 v16, v164, v160, s40
    v_perm_b32 v17, v172, v168, s40
    v_mfma_f32_16x16x32_bf16 v[120:123], a[184:187], a[28:31], v[120:123]
    global_store_dwordx4 v12, a[200:203], s[16:17] offset:0 sc1
    s_waitcnt lgkmcnt(1)
    v_add_f32 v40, v40, v4
    v_perm_b32 v18, v180, v176, s40
    v_perm_b32 v19, v188, v184, s40
    v_mfma_f32_16x16x32_bf16 v[92:95], a[188:191], a[24:27], v[92:95]
    v_add_f32 v41, v41, v5
    v_perm_b32 v20, v164, v160, s41
    v_perm_b32 v21, v172, v168, s41
    v_mfma_f32_16x16x32_bf16 v[124:127], a[188:191], a[28:31], v[124:127]
    v_add_f32 v42, v42, v6
    v_perm_b32 v22, v180, v176, s41
    v_perm_b32 v23, v188, v184, s41
    v_mfma_f32_16x16x32_bf16 v[64:67], v[16:19], a[32:35], v[64:67]
    v_add_f32 v43, v43, v7
    v_perm_b32 v24, v165, v161, s40
    v_perm_b32 v25, v173, v169, s40
    v_mfma_f32_16x16x32_bf16 v[96:99], v[16:19], a[36:39], v[96:99]
    global_store_dwordx4 v12, a[204:207], s[16:17] offset:128 sc1
    s_waitcnt lgkmcnt(0)
    v_add_f32 v44, v44, v8
    v_perm_b32 v26, v181, v177, s40
    v_perm_b32 v27, v189, v185, s40
    v_mfma_f32_16x16x32_bf16 v[68:71], v[20:23], a[32:35], v[68:71]
    v_add_f32 v45, v45, v9
    v_perm_b32 v28, v165, v161, s41
    v_perm_b32 v29, v173, v169, s41
    v_mfma_f32_16x16x32_bf16 v[100:103], v[20:23], a[36:39], v[100:103]
    v_add_f32 v46, v46, v10
    v_perm_b32 v30, v181, v177, s41
    v_perm_b32 v31, v189, v185, s41
    v_mfma_f32_16x16x32_bf16 v[72:75], v[24:27], a[32:35], v[72:75]
    v_add_f32 v47, v47, v11
    v_perm_b32 v16, v166, v162, s40
    v_perm_b32 v17, v174, v170, s40
    v_mfma_f32_16x16x32_bf16 v[104:107], v[24:27], a[36:39], v[104:107]
    global_store_dwordx4 v12, a[208:211], s[16:17] offset:256 sc1
    v_cvt_pk_bf16_f32 v40, v40, v41
    v_perm_b32 v18, v182, v178, s40
    v_perm_b32 v19, v190, v186, s40
    v_mfma_f32_16x16x32_bf16 v[76:79], v[28:31], a[32:35], v[76:79]
    v_cvt_pk_bf16_f32 v41, v42, v43
    v_perm_b32 v20, v166, v162, s41
    v_perm_b32 v21, v174, v170, s41
    v_mfma_f32_16x16x32_bf16 v[108:111], v[28:31], a[36:39], v[108:111]
    v_cvt_pk_bf16_f32 v42, v44, v45
    v_perm_b32 v22, v182, v178, s41
    v_perm_b32 v23, v190, v186, s41
    v_mfma_f32_16x16x32_bf16 v[80:83], v[16:19], a[32:35], v[80:83]
    v_cvt_pk_bf16_f32 v43, v46, v47
    v_perm_b32 v24, v167, v163, s40
    v_perm_b32 v25, v175, v171, s40
    v_mfma_f32_16x16x32_bf16 v[112:115], v[16:19], a[36:39], v[112:115]
    global_store_dwordx4 v12, a[212:215], s[16:17] offset:384 sc1
    v_perm_b32 v26, v183, v179, s40
    v_perm_b32 v27, v191, v187, s40
    v_mfma_f32_16x16x32_bf16 v[84:87], v[20:23], a[32:35], v[84:87]
    ds_read_b128 v[4:7], v2 offset:4096
    ds_read_b128 v[8:11], v2 offset:5120
    v_perm_b32 v28, v167, v163, s41
    v_perm_b32 v29, v175, v171, s41
    v_mfma_f32_16x16x32_bf16 v[116:119], v[20:23], a[36:39], v[116:119]
    v_perm_b32 v30, v183, v179, s41
    v_perm_b32 v31, v191, v187, s41
    v_mfma_f32_16x16x32_bf16 v[88:91], v[24:27], a[32:35], v[88:91]
    s_waitcnt vmcnt(20)
    v_perm_b32 v16, v196, v192, s40
    v_perm_b32 v17, v204, v200, s40
    v_mfma_f32_16x16x32_bf16 v[120:123], v[24:27], a[36:39], v[120:123]
    s_waitcnt lgkmcnt(1)
    v_add_f32 v48, v48, v4
    v_perm_b32 v18, v212, v208, s40
    v_perm_b32 v19, v220, v216, s40
    v_mfma_f32_16x16x32_bf16 v[92:95], v[28:31], a[32:35], v[92:95]
    global_store_dwordx4 v3, v[32:35], s[48:49] offset:2048 sc1
    v_add_f32 v49, v49, v5
    v_perm_b32 v20, v196, v192, s41
    v_perm_b32 v21, v204, v200, s41
    v_mfma_f32_16x16x32_bf16 v[124:127], v[28:31], a[36:39], v[124:127]
    v_add_f32 v50, v50, v6
    v_perm_b32 v22, v212, v208, s41
    v_perm_b32 v23, v220, v216, s41
    v_mfma_f32_16x16x32_bf16 v[64:67], v[16:19], a[40:43], v[64:67]
    v_add_f32 v51, v51, v7
    v_perm_b32 v24, v197, v193, s40
    v_perm_b32 v25, v205, v201, s40
    v_mfma_f32_16x16x32_bf16 v[96:99], v[16:19], a[44:47], v[96:99]
    s_waitcnt lgkmcnt(0)
    v_add_f32 v52, v52, v8
    v_perm_b32 v26, v213, v209, s40
    v_perm_b32 v27, v221, v217, s40
    v_mfma_f32_16x16x32_bf16 v[68:71], v[20:23], a[40:43], v[68:71]
    global_store_dwordx4 v3, v[40:43], s[48:49] offset:2176 sc1
    v_add_f32 v53, v53, v9
    v_perm_b32 v28, v197, v193, s41
    v_perm_b32 v29, v205, v201, s41
    v_mfma_f32_16x16x32_bf16 v[100:103], v[20:23], a[44:47], v[100:103]
    v_add_f32 v54, v54, v10
    v_perm_b32 v30, v213, v209, s41
    v_perm_b32 v31, v221, v217, s41
    v_mfma_f32_16x16x32_bf16 v[72:75], v[24:27], a[40:43], v[72:75]
    v_add_f32 v55, v55, v11
    v_perm_b32 v16, v198, v194, s40
    v_perm_b32 v17, v206, v202, s40
    v_mfma_f32_16x16x32_bf16 v[104:107], v[24:27], a[44:47], v[104:107]
    v_cvt_pk_bf16_f32 v48, v48, v49
    v_perm_b32 v18, v214, v210, s40
    v_perm_b32 v19, v222, v218, s40
    v_mfma_f32_16x16x32_bf16 v[76:79], v[28:31], a[40:43], v[76:79]
    v_cvt_pk_bf16_f32 v49, v50, v51
    v_perm_b32 v20, v198, v194, s41
    v_perm_b32 v21, v206, v202, s41
    v_mfma_f32_16x16x32_bf16 v[108:111], v[28:31], a[44:47], v[108:111]
    v_cvt_pk_bf16_f32 v50, v52, v53
    v_perm_b32 v22, v214, v210, s41
    v_perm_b32 v23, v222, v218, s41
    v_mfma_f32_16x16x32_bf16 v[80:83], v[16:19], a[40:43], v[80:83]
    v_cvt_pk_bf16_f32 v51, v54, v55
    v_perm_b32 v24, v199, v195, s40
    v_perm_b32 v25, v207, v203, s40
    v_mfma_f32_16x16x32_bf16 v[112:115], v[16:19], a[44:47], v[112:115]
    v_perm_b32 v26, v215, v211, s40
    v_perm_b32 v27, v223, v219, s40
    v_mfma_f32_16x16x32_bf16 v[84:87], v[20:23], a[40:43], v[84:87]
    global_store_dwordx4 v3, v[48:51], s[48:49] offset:3072 sc1
    ds_read_b128 v[4:7], v2 offset:6144
    ds_read_b128 v[8:11], v2 offset:7168
    v_perm_b32 v28, v199, v195, s41
    v_perm_b32 v29, v207, v203, s41
    v_mfma_f32_16x16x32_bf16 v[116:119], v[20:23], a[44:47], v[116:119]
    v_perm_b32 v30, v215, v211, s41
    v_perm_b32 v31, v223, v219, s41
    v_mfma_f32_16x16x32_bf16 v[88:91], v[24:27], a[40:43], v[88:91]
    s_waitcnt vmcnt(15)
    v_perm_b32 v16, v228, v224, s40
    v_perm_b32 v17, v236, v232, s40
    v_mfma_f32_16x16x32_bf16 v[120:123], v[24:27], a[44:47], v[120:123]
    s_waitcnt lgkmcnt(1)
    v_add_f32 v56, v56, v4
    v_perm_b32 v18, v244, v240, s40
    v_perm_b32 v19, v252, v248, s40
    v_mfma_f32_16x16x32_bf16 v[92:95], v[28:31], a[40:43], v[92:95]
    v_add_f32 v57, v57, v5
    v_perm_b32 v20, v228, v224, s41
    v_perm_b32 v21, v236, v232, s41
    v_mfma_f32_16x16x32_bf16 v[124:127], v[28:31], a[44:47], v[124:127]
    v_add_f32 v58, v58, v6
    v_perm_b32 v22, v244, v240, s41
    v_perm_b32 v23, v252, v248, s41
    v_mfma_f32_16x16x32_bf16 v[64:67], v[16:19], a[48:51], v[64:67]
    v_add_f32 v59, v59, v7
    v_perm_b32 v24, v229, v225, s40
    v_perm_b32 v25, v237, v233, s40
    v_mfma_f32_16x16x32_bf16 v[96:99], v[16:19], a[52:55], v[96:99]
    s_waitcnt lgkmcnt(0)
    v_add_f32 v60, v60, v8
    v_perm_b32 v26, v245, v241, s40
    v_perm_b32 v27, v253, v249, s40
    v_mfma_f32_16x16x32_bf16 v[68:71], v[20:23], a[48:51], v[68:71]
    v_add_f32 v61, v61, v9
    v_perm_b32 v28, v229, v225, s41
    v_perm_b32 v29, v237, v233, s41
    v_mfma_f32_16x16x32_bf16 v[100:103], v[20:23], a[52:55], v[100:103]
    v_add_f32 v62, v62, v10
    v_perm_b32 v30, v245, v241, s41
    v_perm_b32 v31, v253, v249, s41
    v_mfma_f32_16x16x32_bf16 v[72:75], v[24:27], a[48:51], v[72:75]
    v_add_f32 v63, v63, v11
    v_perm_b32 v16, v230, v226, s40
    v_perm_b32 v17, v238, v234, s40
    v_mfma_f32_16x16x32_bf16 v[104:107], v[24:27], a[52:55], v[104:107]
    v_cvt_pk_bf16_f32 v56, v56, v57
    v_perm_b32 v18, v246, v242, s40
    v_perm_b32 v19, v254, v250, s40
    v_mfma_f32_16x16x32_bf16 v[76:79], v[28:31], a[48:51], v[76:79]
    v_cvt_pk_bf16_f32 v57, v58, v59
    v_perm_b32 v20, v230, v226, s41
    v_perm_b32 v21, v238, v234, s41
    v_mfma_f32_16x16x32_bf16 v[108:111], v[28:31], a[52:55], v[108:111]
    v_cvt_pk_bf16_f32 v58, v60, v61
    v_perm_b32 v22, v246, v242, s41
    v_perm_b32 v23, v254, v250, s41
    v_mfma_f32_16x16x32_bf16 v[80:83], v[16:19], a[48:51], v[80:83]
    v_cvt_pk_bf16_f32 v59, v62, v63
    v_perm_b32 v24, v231, v227, s40
    v_perm_b32 v25, v239, v235, s40
    v_mfma_f32_16x16x32_bf16 v[112:115], v[16:19], a[52:55], v[112:115]
    v_perm_b32 v26, v247, v243, s40
    v_perm_b32 v27, v255, v251, s40
    v_mfma_f32_16x16x32_bf16 v[84:87], v[20:23], a[48:51], v[84:87]
    global_store_dwordx4 v3, v[56:59], s[48:49] offset:3200 sc1
    v_perm_b32 v28, v231, v227, s41
    v_perm_b32 v29, v239, v235, s41
    v_mfma_f32_16x16x32_bf16 v[116:119], v[20:23], a[52:55], v[116:119]
    v_perm_b32 v30, v247, v243, s41
    v_perm_b32 v31, v255, v251, s41
    v_mfma_f32_16x16x32_bf16 v[88:91], v[24:27], a[48:51], v[88:91]
    s_waitcnt vmcnt(8)
    v_perm_b32 v16, v132, v128, s40
    v_perm_b32 v17, v140, v136, s40
    v_mfma_f32_16x16x32_bf16 v[120:123], v[24:27], a[52:55], v[120:123]
    v_perm_b32 v18, v148, v144, s40
    v_perm_b32 v19, v156, v152, s40
    v_mfma_f32_16x16x32_bf16 v[92:95], v[28:31], a[48:51], v[92:95]
    v_perm_b32 v20, v132, v128, s41
    v_perm_b32 v21, v140, v136, s41
    v_mfma_f32_16x16x32_bf16 v[124:127], v[28:31], a[52:55], v[124:127]
    v_perm_b32 v22, v148, v144, s41
    v_perm_b32 v23, v156, v152, s41
    v_mfma_f32_16x16x32_bf16 v[64:67], v[16:19], a[56:59], v[64:67]
    v_perm_b32 v24, v133, v129, s40
    v_perm_b32 v25, v141, v137, s40
    v_mfma_f32_16x16x32_bf16 v[96:99], v[16:19], a[60:63], v[96:99]
    v_perm_b32 v26, v149, v145, s40
    v_perm_b32 v27, v157, v153, s40
    v_mfma_f32_16x16x32_bf16 v[68:71], v[20:23], a[56:59], v[68:71]
    v_perm_b32 v28, v133, v129, s41
    v_perm_b32 v29, v141, v137, s41
    v_mfma_f32_16x16x32_bf16 v[100:103], v[20:23], a[60:63], v[100:103]
    v_perm_b32 v30, v149, v145, s41
    v_perm_b32 v31, v157, v153, s41
    v_mfma_f32_16x16x32_bf16 v[72:75], v[24:27], a[56:59], v[72:75]
    v_perm_b32 v16, v134, v130, s40
    v_perm_b32 v17, v142, v138, s40
    v_mfma_f32_16x16x32_bf16 v[104:107], v[24:27], a[60:63], v[104:107]
    v_perm_b32 v18, v150, v146, s40
    v_perm_b32 v19, v158, v154, s40
    v_mfma_f32_16x16x32_bf16 v[76:79], v[28:31], a[56:59], v[76:79]
    v_perm_b32 v20, v134, v130, s41
    v_perm_b32 v21, v142, v138, s41
    v_mfma_f32_16x16x32_bf16 v[108:111], v[28:31], a[60:63], v[108:111]
    v_perm_b32 v22, v150, v146, s41
    v_perm_b32 v23, v158, v154, s41
    v_mfma_f32_16x16x32_bf16 v[80:83], v[16:19], a[56:59], v[80:83]
    v_perm_b32 v24, v135, v131, s40
    v_perm_b32 v25, v143, v139, s40
    v_mfma_f32_16x16x32_bf16 v[112:115], v[16:19], a[60:63], v[112:115]
    v_perm_b32 v26, v151, v147, s40
    v_perm_b32 v27, v159, v155, s40
    v_mfma_f32_16x16x32_bf16 v[84:87], v[20:23], a[56:59], v[84:87]
    v_perm_b32 v28, v135, v131, s41
    v_perm_b32 v29, v143, v139, s41
    v_mfma_f32_16x16x32_bf16 v[116:119], v[20:23], a[60:63], v[116:119]
    v_perm_b32 v30, v151, v147, s41
    v_perm_b32 v31, v159, v155, s41
    v_accvgpr_read_b32 v1, a195
    v_mfma_f32_16x16x32_bf16 v[88:91], v[24:27], a[56:59], v[88:91]
    v_mfma_f32_16x16x32_bf16 v[120:123], v[24:27], a[60:63], v[120:123]
    v_mfma_f32_16x16x32_bf16 v[92:95], v[28:31], a[56:59], v[92:95]
    v_mfma_f32_16x16x32_bf16 v[124:127], v[28:31], a[60:63], v[124:127]
    v_cvt_pk_bf16_f32 v4, v64, v68
    v_cvt_pk_bf16_f32 v5, v72, v76
    v_cvt_pk_bf16_f32 v6, v80, v84
    s_nop 3
    v_cvt_pk_bf16_f32 v7, v88, v92
    global_store_dwordx4 v1, v[4:7], s[44:45] offset:0 sc1
    v_cvt_pk_bf16_f32 v8, v65, v69
    v_cvt_pk_bf16_f32 v9, v73, v77
    v_cvt_pk_bf16_f32 v10, v81, v85
    v_cvt_pk_bf16_f32 v11, v89, v93
    global_store_dwordx4 v1, v[8:11], s[44:45] offset:512 sc1
    v_cvt_pk_bf16_f32 v12, v66, v70
    v_cvt_pk_bf16_f32 v13, v74, v78
    v_cvt_pk_bf16_f32 v14, v82, v86
    v_cvt_pk_bf16_f32 v15, v90, v94
    global_store_dwordx4 v1, v[12:15], s[44:45] offset:1024 sc1
    v_cvt_pk_bf16_f32 v16, v67, v71
    v_cvt_pk_bf16_f32 v17, v75, v79
    v_cvt_pk_bf16_f32 v18, v83, v87
    v_cvt_pk_bf16_f32 v19, v91, v95
    global_store_dwordx4 v1, v[16:19], s[44:45] offset:1536 sc1
    v_cvt_pk_bf16_f32 v20, v96, v100
    v_cvt_pk_bf16_f32 v21, v104, v108
    v_cvt_pk_bf16_f32 v22, v112, v116
    v_cvt_pk_bf16_f32 v23, v120, v124
    global_store_dwordx4 v1, v[20:23], s[44:45] offset:2048 sc1
    v_cvt_pk_bf16_f32 v24, v97, v101
    v_cvt_pk_bf16_f32 v25, v105, v109
    v_cvt_pk_bf16_f32 v26, v113, v117
    v_cvt_pk_bf16_f32 v27, v121, v125
    global_store_dwordx4 v1, v[24:27], s[44:45] offset:2560 sc1
    v_cvt_pk_bf16_f32 v28, v98, v102
    v_cvt_pk_bf16_f32 v29, v106, v110
    v_cvt_pk_bf16_f32 v30, v114, v118
    v_cvt_pk_bf16_f32 v31, v122, v126
    global_store_dwordx4 v1, v[28:31], s[44:45] offset:3072 sc1
    v_cvt_pk_bf16_f32 v4, v99, v103
    v_cvt_pk_bf16_f32 v5, v107, v111
    v_cvt_pk_bf16_f32 v6, v115, v119
    v_cvt_pk_bf16_f32 v7, v123, v127
    global_store_dwordx4 v1, v[4:7], s[44:45] offset:3584 sc1
K2_START:
    s_load_dwordx2 s[58:59], s[0:1], 48
    v_mbcnt_lo_u32_b32 v2, -1, 0
    v_mbcnt_hi_u32_b32 v2, -1, v2
    s_mov_b64 s[4:5], s[16:17]
    s_and_b32 s6, s2, 7
    s_lshr_b32 s7, s2, 3
    s_lshr_b32 s30, s6, 2
    s_mul_i32 s30, s30, 125
    s_lshl_b32 s47, s30, 7
    s_add_u32 s47, s47, 25293824
    s_lshl_b32 s56, s3, 7
    s_add_u32 s56, s56, 128
    v_lshl_add_u32 v201, v2, 9, s56
    v_cmp_gt_u32 vcc, 31, v2
    s_nop 1
    v_cndmask_b32 v201, 0, v201, vcc
    v_cmp_gt_u32 vcc, 7, v2
    s_nop 1
    v_cndmask_b32 v200, 0, v201, vcc
    v_add_u32 v201, s47, v201
    v_add_u32 v200, s47, v200
    s_lshl_b32 s56, s7, 2
    s_add_u32 s30, s30, s56
    s_cmp_eq_u32 s7, 31
    s_cselect_b32 s56, 0, 3
    v_and_b32 v202, s56, v2
    v_add_u32 v202, s30, v202
    v_and_b32 v203, 7, v202
    v_cmp_lt_u32 vcc, 124, v202
    v_lshrrev_b32 v202, 3, v202
    v_lshl_add_u32 v202, v203, 4, v202
    v_subrev_u32 v204, 2, v203
    v_med3_i32 v204, v204, 0, 3
    v_subrev_u32 v203, 5, v203
    v_ashrrev_i32 v211, 31, v203
    v_sub_u32 v204, v204, v211
    v_subrev_u32 v204, 110, v204
    v_max_i32 v203, 0, v203
    v_cndmask_b32 v203, v203, v204, vcc
    v_sub_u32 v202, v202, v203
    v_lshlrev_b32 v202, 7, v202
    v_add_u32 v202, 25293824, v202
    v_cmp_gt_u32 vcc, 8, v2
    s_nop 1
    v_cndmask_b32 v200, v202, v200, vcc
    v_mov_b32 v203, 0
    v_accvgpr_read_b32 v208, a196
    v_mov_b32 v209, 1
    v_mov_b32 v1, s3
    v_lshl_add_u32 v0, v1, 6, v2
    v_lshlrev_b32 v7, 4, v2
    v_and_b32 v3, 15, v2
    v_lshrrev_b32 v4, 4, v2
    s_and_b32 s6, s2, 7
    s_lshr_b32 s7, s2, 3
    s_mul_i32 s28, s6, 512000
    v_lshl_add_u32 v8, v1, 12, v7
    v_add_u32 v8, 4096, v8
    v_lshlrev_b32 v9, 8, v4
    s_lshl_b32 s29, s7, 14
    s_add_u32 s32, s3, 1
    s_and_b32 s32, s32, 3
    s_lshl_b32 s32, s32, 12
    s_add_u32 s32, s32, s29
    s_add_u32 s33, s3, 2
    s_and_b32 s33, s33, 3
    s_lshl_b32 s33, s33, 12
    s_add_u32 s33, s33, s29
    s_add_u32 s34, s3, 3
    s_and_b32 s34, s34, 3
    s_lshl_b32 s34, s34, 12
    s_add_u32 s34, s34, s29
    s_add_u32 s35, s3, 4
    s_and_b32 s35, s35, 3
    s_lshl_b32 s35, s35, 12
    s_add_u32 s35, s35, s29
    s_add_u32 s30, s28, 12582912
    s_add_u32 s12, s4, s30
    s_addc_u32 s13, s5, 0
    s_mov_b32 s14, 512000
    s_mov_b32 s15, 0x00020000
    s_add_u32 s30, s28, 8388608
    s_add_u32 s8, s4, s30
    s_addc_u32 s9, s5, 0
    s_mov_b32 s10, 512000
    s_mov_b32 s11, 0x00020000
    s_add_u32 s30, s28, 16777216
    s_add_u32 s42, s4, s30
    s_addc_u32 s43, s5, 0
    s_add_u32 s40, s12, 16384
    s_addc_u32 s41, s13, 0
    s_mov_b32 s36, 0
    v_mov_b32 v96, 0
    v_mov_b32 v97, 0
    v_mov_b32 v98, 0
    v_mov_b32 v99, 0
    v_mov_b32 v100, 0
    v_mov_b32 v101, 0
    v_mov_b32 v102, 0
    v_mov_b32 v103, 0
    v_mov_b32 v104, 0
    v_mov_b32 v105, 0
    v_mov_b32 v106, 0
    v_mov_b32 v107, 0
    v_mov_b32 v108, 0
    v_mov_b32 v109, 0
    v_mov_b32 v110, 0
    v_mov_b32 v111, 0
    v_mov_b32 v112, 0
    v_mov_b32 v113, 0
    v_mov_b32 v114, 0
    v_mov_b32 v115, 0
    v_mov_b32 v116, 0
    v_mov_b32 v117, 0
    v_mov_b32 v118, 0
    v_mov_b32 v119, 0
    v_mov_b32 v120, 0
    v_mov_b32 v121, 0
    v_mov_b32 v122, 0
    v_mov_b32 v123, 0
    v_mov_b32 v124, 0
    v_mov_b32 v125, 0
    v_mov_b32 v126, 0
    v_mov_b32 v127, 0
    v_mov_b32 v72, 0
    v_mov_b32 v73, 0
    v_mov_b32 v74, 0
    v_mov_b32 v75, 0
    v_mov_b32 v76, 0
    v_mov_b32 v77, 0
    v_mov_b32 v78, 0
    v_mov_b32 v79, 0
    v_lshrrev_b32 v14, 2, v3
    v_lshrrev_b32 v15, 1, v4
    v_xor_b32 v14, v14, v15
    v_and_b32 v14, 1, v14
    v_and_b32 v15, 10, v3
    v_or_b32 v14, v14, v15
    v_mov_b32 v15, 0x3f803f80
    v_cmp_eq_u32 vcc, 0, v14
    s_nop 1
    v_cndmask_b32 v80, 0, v15, vcc
    v_cmp_eq_u32 vcc, 8, v14
    s_nop 1
    v_cndmask_b32 v84, 0, v15, vcc
    v_and_b32 v14, 1, v3
    v_mul_u32_u24 v14, 0xaaaa, v14
    v_add_u32 v88, 0x4444, v14
    v_mov_b32 v81, v80
    v_mov_b32 v82, v80
    v_mov_b32 v83, v80
    v_mov_b32 v85, v84
    v_mov_b32 v86, v84
    v_mov_b32 v87, v84
    v_lshrrev_b32 v6, 5, v2
    v_and_b32 v5, 31, v2
    v_add_u32 v13, s3, v6
    v_add_u32 v14, 3, v13
    v_add_u32 v13, 1, v13
    v_and_b32 v13, 3, v13
    v_and_b32 v14, 3, v14
    v_lshlrev_b32 v15, 4, v5
    v_lshl_add_u32 v15, v1, 2, v15
    v_lshl_add_u32 v13, v13, 9, v15
    v_lshl_add_u32 v14, v14, 9, v15
    v_lshrrev_b32 v15, 3, v3
    v_lshlrev_b32 v15, 12, v15
    v_and_b32 v5, 7, v3
    v_lshl_add_u32 v15, v5, 4, v15
    v_lshl_add_u32 v15, v4, 7, v15
    s_add_u32 s30, s3, 1
    s_and_b32 s30, s30, 3
    s_mul_i32 s30, s30, 24576
    s_add_u32 s30, s30, 2048
    v_add_u32 v192, s30, v7
    s_add_u32 s30, s3, 2
    s_and_b32 s30, s30, 3
    s_mul_i32 s30, s30, 24576
    s_add_u32 s30, s30, 10240
    v_add_u32 v193, s30, v7
    s_add_u32 s30, s3, 3
    s_and_b32 s30, s30, 3
    s_mul_i32 s30, s30, 24576
    s_add_u32 s30, s30, 18432
    v_add_u32 v194, s30, v7
    s_mul_i32 s30, s3, 24576
    s_add_u32 s30, s30, 2048
    v_add_u32 v195, s30, v7
    v_lshlrev_b32 v196, 4, v3
    v_lshl_add_u32 v196, v1, 9, v196
    s_lshr_b32 s30, s6, 2
    s_mul_i32 s30, s30, 2048000
    s_lshl_b32 s31, s7, 2
    s_add_u32 s31, s31, s3
    s_lshl_b32 s37, s31, 14
    s_add_u32 s37, s37, s30
    s_and_b32 s30, s6, 3
    s_lshl_b32 s30, s30, 10
    s_add_u32 s37, s37, s30
    s_add_u32 s38, s37, 8192
    s_add_u32 s20, s4, 4194304
    s_addc_u32 s21, s5, 0
    s_mov_b32 s22, 21099520
    s_mov_b32 s23, 0x00020000
    s_cmp_ge_u32 s31, 125
    s_cselect_b32 s22, 0, s22
    s_mov_b32 s39, 0x80008000
    s_lshr_b32 s30, s6, 2
    s_mul_i32 s30, s30, 125
    s_add_u32 s30, s30, s31
    s_lshl_b32 s30, s30, 2
    s_and_b32 s46, s6, 3
    s_add_u32 s46, s46, s30
    s_lshl_b32 s46, s46, 7
    s_add_u32 s46, s46, 20971520
    s_add_u32 s60, s4, 20971520
    s_addc_u32 s61, s5, 0
    s_mul_i32 s62, s3, 393216
    s_add_u32 s62, s62, 4096
    s_mul_i32 s47, s7, 12288
    s_add_u32 s47, s47, s62
    s_add_u32 s47, s47, 20967424
    v_min_u32 v12, 10, v2
    v_lshl_add_u32 v10, v12, 7, s47
    s_min_u32 s47, s6, 2
    s_mul_i32 s56, s6, 31
    s_add_u32 s47, s47, s56
    s_add_u32 s47, s47, s7
    s_min_u32 s56, s47, 249
    s_lshl_b32 s47, s56, 2
    s_add_u32 s47, s47, s3
    s_lshl_b32 s47, s47, 12
    s_sub_u32 s47, s47, 1024
    v_lshl_add_u32 v11, v12, 7, s47
    v_cmp_gt_u32 vcc, 8, v2
    s_nop 1
    v_cndmask_b32 v205, v11, v10, vcc
    v_mov_b32 v11, 384
    v_mov_b32 v12, 1024
    v_cndmask_b32 v206, v11, v12, vcc
    v_lshrrev_b32 v10, 2, v2
    v_add_u32 v10, s56, v10
    v_subrev_u32 v10, 1, v10
    v_max_i32 v10, 0, v10
    v_min_i32 v10, 249, v10
    v_and_b32 v11, 7, v10
    v_cmp_lt_u32 vcc, 124, v10
    v_lshrrev_b32 v10, 3, v10
    v_lshl_add_u32 v10, v11, 4, v10
    v_subrev_u32 v12, 2, v11
    v_med3_i32 v12, v12, 0, 3
    v_subrev_u32 v11, 5, v11
    v_ashrrev_i32 v211, 31, v11
    v_sub_u32 v12, v12, v211
    v_subrev_u32 v12, 110, v12
    v_max_i32 v11, 0, v11
    v_cndmask_b32 v11, v11, v12, vcc
    v_sub_u32 v10, v10, v11
    v_lshlrev_b32 v10, 7, v10
    v_add_u32 v10, 25293824, v10
    s_lshl_b32 s47, s7, 2
    s_add_u32 s47, s47, s3
    s_lshl_b32 s56, s47, 5
    s_add_u32 s56, s56, 25357776
    v_min_u32 v11, 17, v2
    v_lshl_add_u32 v11, v11, 2, s56
    v_cmp_gt_u32 vcc, 12, v2
    s_nop 1
    v_cndmask_b32 v204, v11, v10, vcc
    s_lshl_b32 s47, s47, 7
    s_min_u32 s47, s47, 7552
    v_mov_b32 v10, s47
    v_mov_b32 v11, 0
    s_mov_b32 s63, 2
    s_mov_b32 s29, 0
    s_waitcnt vmcnt(0)
    s_waitcnt lgkmcnt(0)
    s_barrier
    s_cmp_eq_u32 s3, 0
    s_cselect_b64 exec, 1, 0
    global_store_dword v208, v209, s[4:5] sc1
    s_mov_b64 exec, -1
    v_cmp_eq_u32 vcc, 0, v203
    s_nop 4
    s_cbranch_vccz K2_GO
    s_mov_b32 s56, 0
K2_PA:
    global_load_dword v203, v200, s[4:5] sc1
    s_add_u32 s56, s56, 1
    s_waitcnt vmcnt(0)
    v_cmp_eq_u32 vcc, 0, v203
    s_cmp_lt_u32 s56, 0x20000
    s_nop 0
    s_cselect_b64 s[30:31], vcc, 0
    s_cmp_lg_u64 s[30:31], 0
    s_cbranch_scc1 K2_PA
K2_GO:
    global_load_dwordx4 v[128:131], v9, s[12:13] offset:0 sc1
    global_load_dwordx4 v[132:135], v9, s[12:13] offset:1024 sc1
    buffer_load_dwordx4 a[176:179], v7, s[8:11], s35 offen offset:0 sc1
    buffer_load_dwordx4 a[180:183], v7, s[8:11], s35 offen offset:1024 sc1
    buffer_load_dwordx4 a[184:187], v7, s[8:11], s35 offen offset:2048 sc1
    buffer_load_dwordx4 a[188:191], v7, s[8:11], s35 offen offset:3072 sc1
    global_load_dwordx4 a[208:211], v7, s[12:13] offset:0 sc1
    global_load_dwordx4 a[212:215], v7, s[12:13] offset:1024 sc1
    global_load_dwordx4 a[216:219], v7, s[12:13] offset:2048 sc1
    global_load_dwordx4 a[220:223], v7, s[12:13] offset:3072 sc1
    buffer_load_dwordx4 a[128:131], v7, s[8:11], s32 offen offset:0 sc1
    buffer_load_dwordx4 a[132:135], v7, s[8:11], s32 offen offset:1024 sc1
    buffer_load_dwordx4 a[136:139], v7, s[8:11], s32 offen offset:2048 sc1
    buffer_load_dwordx4 a[140:143], v7, s[8:11], s32 offen offset:3072 sc1
    global_load_dwordx4 a[192:195], v8, s[12:13] offset:0 sc1
    global_load_dwordx4 a[196:199], v8, s[12:13] offset:1024 sc1
    global_load_dwordx4 a[200:203], v8, s[12:13] offset:2048 sc1
    global_load_dwordx4 a[204:207], v8, s[12:13] offset:3072 sc1
    s_waitcnt vmcnt(17)
    v_xor_b32 v128, s39, v128
    v_xor_b32 v129, s39, v129
    v_xor_b32 v130, s39, v130
    v_xor_b32 v131, s39, v131
    s_waitcnt vmcnt(16)
    v_xor_b32 v132, s39, v132
    v_xor_b32 v133, s39, v133
    v_xor_b32 v134, s39, v134
    v_xor_b32 v135, s39, v135
K2_MAIN:
    s_mov_b32 s28, 16384
    s_waitcnt vmcnt(15)
    v_mfma_f32_16x16x32_bf16 v[120:123], v[128:131], a[176:179], v[120:123]
    buffer_load_dwordx4 a[144:147], v7, s[8:11], s33 offen offset:0 sc1
    buffer_load_dwordx4 a[148:151], v7, s[8:11], s33 offen offset:1024 sc1
    s_waitcnt vmcnt(15)
    v_mfma_f32_16x16x32_bf16 v[124:127], v[128:131], a[184:187], v[124:127]
    buffer_load_dwordx4 a[152:155], v7, s[8:11], s33 offen offset:2048 sc1
    buffer_load_dwordx4 a[156:159], v7, s[8:11], s33 offen offset:3072 sc1
    v_mfma_f32_16x16x32_bf16 v[120:123], v[132:135], a[180:183], v[120:123]
    s_waitcnt vmcnt(16)
    v_mfma_f32_16x16x32_bf16 v[124:127], v[132:135], a[188:191], v[124:127]
    s_waitcnt vmcnt(11)
    v_mfma_f32_16x16x32_bf16 v[32:35], a[208:211], a[176:179], v[120:123]
    s_waitcnt vmcnt(9)
    v_mfma_f32_16x16x32_bf16 v[36:39], a[216:219], a[176:179], v[120:123]
    global_load_dwordx4 a[240:243], v7, s[42:43] offset:0 sc1
    global_load_dwordx4 a[244:247], v7, s[42:43] offset:1024 sc1
    v_mfma_f32_16x16x32_bf16 v[40:43], a[208:211], a[184:187], v[124:127]
    v_mfma_f32_16x16x32_bf16 v[44:47], a[216:219], a[184:187], v[124:127]
    global_load_dwordx4 a[248:251], v7, s[42:43] offset:2048 sc1
    global_load_dwordx4 a[252:255], v7, s[42:43] offset:3072 sc1
    v_mfma_f32_16x16x32_bf16 v[32:35], a[212:215], a[180:183], v[32:35]
    s_waitcnt vmcnt(12)
    v_mfma_f32_16x16x32_bf16 v[36:39], a[220:223], a[180:183], v[36:39]
    v_mfma_f32_16x16x32_bf16 v[40:43], a[212:215], a[188:191], v[40:43]
    v_mfma_f32_16x16x32_bf16 v[44:47], a[220:223], a[188:191], v[44:47]
    s_waitcnt vmcnt(15)
    v_mfma_f32_16x16x32_bf16 v[96:99], v[128:131], a[128:131], v[96:99]
    s_waitcnt vmcnt(13)
    v_mfma_f32_16x16x32_bf16 v[100:103], v[128:131], a[136:139], v[100:103]
    v_mfma_f32_16x16x32_bf16 v[96:99], v[132:135], a[132:135], v[96:99]
    s_waitcnt vmcnt(12)
    v_mfma_f32_16x16x32_bf16 v[100:103], v[132:135], a[140:143], v[100:103]
    s_waitcnt vmcnt(11)
    v_mfma_f32_16x16x32_bf16 v[16:19], a[192:195], a[128:131], v[96:99]
    buffer_load_dwordx4 a[160:163], v7, s[8:11], s34 offen offset:0 sc1
    v_exp_f32 v64, v32
    s_waitcnt vmcnt(10)
    v_mfma_f32_16x16x32_bf16 v[20:23], a[200:203], a[128:131], v[96:99]
    buffer_load_dwordx4 a[164:167], v7, s[8:11], s34 offen offset:1024 sc1
    v_exp_f32 v65, v33
    v_mfma_f32_16x16x32_bf16 v[24:27], a[192:195], a[136:139], v[100:103]
    buffer_load_dwordx4 a[168:171], v7, s[8:11], s34 offen offset:2048 sc1
    v_exp_f32 v66, v34
    v_mfma_f32_16x16x32_bf16 v[28:31], a[200:203], a[136:139], v[100:103]
    buffer_load_dwordx4 a[172:175], v7, s[8:11], s34 offen offset:3072 sc1
    v_exp_f32 v67, v35
    v_cvt_pk_bf16_f32 v56, v64, v65
    v_mfma_f32_16x16x32_bf16 v[16:19], a[196:199], a[132:135], v[16:19]
    global_load_dwordx4 a[224:227], v8, s[42:43] offset:0 sc1
    v_exp_f32 v68, v36
    s_waitcnt vmcnt(13)
    v_mfma_f32_16x16x32_bf16 v[20:23], a[204:207], a[132:135], v[20:23]
    global_load_dwordx4 a[228:231], v8, s[42:43] offset:1024 sc1
    v_exp_f32 v69, v37
    v_mfma_f32_16x16x32_bf16 v[24:27], a[196:199], a[140:143], v[24:27]
    global_load_dwordx4 a[232:235], v8, s[42:43] offset:2048 sc1
    v_exp_f32 v70, v38
    v_cvt_pk_bf16_f32 v57, v66, v67
    v_mfma_f32_16x16x32_bf16 v[28:31], a[204:207], a[140:143], v[28:31]
    global_load_dwordx4 a[236:239], v8, s[42:43] offset:3072 sc1
    v_exp_f32 v71, v39
    v_cvt_pk_bf16_f32 v58, v68, v69
    v_cvt_pk_bf16_f32 v59, v70, v71
    v_exp_f32 v64, v40
    v_exp_f32 v65, v41
    v_exp_f32 v66, v42
    global_load_dwordx4 a[208:211], v8, s[40:41] offset:0 sc1
    global_load_dwordx4 a[212:215], v8, s[40:41] offset:1024 sc1
    global_load_dwordx4 a[216:219], v8, s[40:41] offset:2048 sc1
    global_load_dwordx4 a[220:223], v8, s[40:41] offset:3072 sc1
    s_waitcnt vmcnt(19)
    v_mfma_f32_16x16x32_bf16 v[104:107], v[128:131], a[144:147], v[104:107]
    s_waitcnt vmcnt(17)
    v_mfma_f32_16x16x32_bf16 v[108:111], v[128:131], a[152:155], v[108:111]
    v_mfma_f32_16x16x32_bf16 v[104:107], v[132:135], a[148:151], v[104:107]
    s_waitcnt vmcnt(16)
    v_mfma_f32_16x16x32_bf16 v[108:111], v[132:135], a[156:159], v[108:111]
    v_exp_f32 v67, v43
    v_cvt_pk_bf16_f32 v60, v64, v65
    v_exp_f32 v68, v44
    v_exp_f32 v69, v45
    v_cvt_pk_bf16_f32 v61, v66, v67
    v_exp_f32 v70, v46
    v_exp_f32 v71, v47
    v_cvt_pk_bf16_f32 v62, v68, v69
    v_mfma_f32_16x16x32_bf16 v[32:35], a[192:195], a[144:147], v[104:107]
    v_cvt_pk_bf16_f32 v63, v70, v71
    v_exp_f32 v64, v16
    v_mfma_f32_16x16x32_bf16 v[36:39], a[200:203], a[144:147], v[104:107]
    v_exp_f32 v65, v17
    v_mfma_f32_16x16x32_bf16 v[40:43], a[192:195], a[152:155], v[108:111]
    v_exp_f32 v66, v18
    v_mfma_f32_16x16x32_bf16 v[44:47], a[200:203], a[152:155], v[108:111]
    v_exp_f32 v67, v19
    v_cvt_pk_bf16_f32 v48, v64, v65
    v_mfma_f32_16x16x32_bf16 v[32:35], a[196:199], a[148:151], v[32:35]
    v_exp_f32 v68, v20
    v_mfma_f32_16x16x32_bf16 v[36:39], a[204:207], a[148:151], v[36:39]
    v_exp_f32 v69, v21
    v_mfma_f32_16x16x32_bf16 v[40:43], a[196:199], a[156:159], v[40:43]
    v_exp_f32 v70, v22
    v_cvt_pk_bf16_f32 v49, v66, v67
    v_mfma_f32_16x16x32_bf16 v[44:47], a[204:207], a[156:159], v[44:47]
    v_exp_f32 v71, v23
    v_smfmac_f32_16x16x64_bf16 v[76:79], v[84:87], v[56:63], v88
    v_add_u32 v8, s28, v8
    v_cvt_pk_bf16_f32 v50, v68, v69
    v_cvt_pk_bf16_f32 v51, v70, v71
    s_waitcnt vmcnt(15)
    v_mfma_f32_16x16x32_bf16 v[160:163], a[240:243], v[56:59], 0
    v_exp_f32 v64, v24
    s_waitcnt vmcnt(14)
    v_mfma_f32_16x16x32_bf16 v[164:167], a[244:247], v[56:59], 0
    v_exp_f32 v65, v25
    s_waitcnt vmcnt(13)
    v_mfma_f32_16x16x32_bf16 v[168:171], a[248:251], v[56:59], 0
    v_exp_f32 v66, v26
    s_waitcnt vmcnt(12)
    v_mfma_f32_16x16x32_bf16 v[172:175], a[252:255], v[56:59], 0
    v_exp_f32 v67, v27
    v_cvt_pk_bf16_f32 v52, v64, v65
    v_mfma_f32_16x16x32_bf16 v[176:179], a[240:243], v[60:63], 0
    v_exp_f32 v68, v28
    v_mfma_f32_16x16x32_bf16 v[180:183], a[244:247], v[60:63], 0
    v_exp_f32 v69, v29
    v_cvt_pk_bf16_f32 v53, v66, v67
    v_mfma_f32_16x16x32_bf16 v[184:187], a[248:251], v[60:63], 0
    v_exp_f32 v70, v30
    v_mfma_f32_16x16x32_bf16 v[188:191], a[252:255], v[60:63], 0
    s_waitcnt vmcnt(11)
    v_mfma_f32_16x16x32_bf16 v[112:115], v[128:131], a[160:163], v[112:115]
    s_waitcnt vmcnt(9)
    v_mfma_f32_16x16x32_bf16 v[116:119], v[128:131], a[168:171], v[116:119]
    v_mfma_f32_16x16x32_bf16 v[112:115], v[132:135], a[164:167], v[112:115]
    s_waitcnt vmcnt(8)
    v_mfma_f32_16x16x32_bf16 v[116:119], v[132:135], a[172:175], v[116:119]
    v_exp_f32 v71, v31
    v_cvt_pk_bf16_f32 v54, v68, v69
    v_mfma_f32_16x16x32_bf16 v[16:19], a[192:195], a[160:163], v[112:115]
    v_cvt_pk_bf16_f32 v55, v70, v71
    v_exp_f32 v64, v32
    v_mfma_f32_16x16x32_bf16 v[20:23], a[200:203], a[160:163], v[112:115]
    v_exp_f32 v65, v33
    v_mfma_f32_16x16x32_bf16 v[24:27], a[192:195], a[168:171], v[116:119]
    v_exp_f32 v66, v34
    v_mfma_f32_16x16x32_bf16 v[28:31], a[200:203], a[168:171], v[116:119]
    v_exp_f32 v67, v35
    v_cvt_pk_bf16_f32 v56, v64, v65
    v_mfma_f32_16x16x32_bf16 v[16:19], a[196:199], a[164:167], v[16:19]
    v_exp_f32 v68, v36
    v_mfma_f32_16x16x32_bf16 v[20:23], a[204:207], a[164:167], v[20:23]
    v_exp_f32 v69, v37
    v_mfma_f32_16x16x32_bf16 v[24:27], a[196:199], a[172:175], v[24:27]
    v_exp_f32 v70, v38
    v_cvt_pk_bf16_f32 v57, v66, v67
    v_mfma_f32_16x16x32_bf16 v[28:31], a[204:207], a[172:175], v[28:31]
    v_exp_f32 v71, v39
    v_smfmac_f32_16x16x64_bf16 v[72:75], v[80:83], v[48:55], v88
    global_load_dwordx4 a[240:243], v8, s[42:43] offset:0 sc1
    global_load_dwordx4 a[244:247], v8, s[42:43] offset:1024 sc1
    global_load_dwordx4 a[248:251], v8, s[42:43] offset:2048 sc1
    global_load_dwordx4 a[252:255], v8, s[42:43] offset:3072 sc1
    v_cvt_pk_bf16_f32 v58, v68, v69
    v_cvt_pk_bf16_f32 v59, v70, v71
    s_waitcnt vmcnt(11)
    v_mfma_f32_16x16x32_bf16 a[0:3], a[224:227], v[48:51], 0
    v_exp_f32 v64, v40
    s_waitcnt vmcnt(10)
    v_mfma_f32_16x16x32_bf16 a[4:7], a[228:231], v[48:51], 0
    v_exp_f32 v65, v41
    s_waitcnt vmcnt(9)
    v_mfma_f32_16x16x32_bf16 a[8:11], a[232:235], v[48:51], 0
    v_exp_f32 v66, v42
    s_waitcnt vmcnt(8)
    v_mfma_f32_16x16x32_bf16 a[12:15], a[236:239], v[48:51], 0
    v_exp_f32 v67, v43
    v_cvt_pk_bf16_f32 v60, v64, v65
    v_mfma_f32_16x16x32_bf16 a[16:19], a[224:227], v[52:55], 0
    v_exp_f32 v68, v44
    v_mfma_f32_16x16x32_bf16 a[20:23], a[228:231], v[52:55], 0
    v_exp_f32 v69, v45
    v_cvt_pk_bf16_f32 v61, v66, v67
    v_mfma_f32_16x16x32_bf16 a[24:27], a[232:235], v[52:55], 0
    v_exp_f32 v70, v46
    v_mfma_f32_16x16x32_bf16 a[28:31], a[236:239], v[52:55], 0
    v_exp_f32 v71, v47
    v_cvt_pk_bf16_f32 v62, v68, v69
    v_mfma_f32_16x16x32_bf16 v[32:35], a[192:195], a[176:179], v[120:123]
    v_cvt_pk_bf16_f32 v63, v70, v71
    v_exp_f32 v64, v16
    v_mfma_f32_16x16x32_bf16 v[36:39], a[200:203], a[176:179], v[120:123]
    v_exp_f32 v65, v17
    v_mfma_f32_16x16x32_bf16 v[40:43], a[192:195], a[184:187], v[124:127]
    v_exp_f32 v66, v18
    v_mfma_f32_16x16x32_bf16 v[44:47], a[200:203], a[184:187], v[124:127]
    v_exp_f32 v67, v19
    v_cvt_pk_bf16_f32 v48, v64, v65
    v_mfma_f32_16x16x32_bf16 v[32:35], a[196:199], a[180:183], v[32:35]
    v_exp_f32 v68, v20
    v_mfma_f32_16x16x32_bf16 v[36:39], a[204:207], a[180:183], v[36:39]
    v_exp_f32 v69, v21
    v_mfma_f32_16x16x32_bf16 v[40:43], a[196:199], a[188:191], v[40:43]
    v_exp_f32 v70, v22
    v_cvt_pk_bf16_f32 v49, v66, v67
    v_mfma_f32_16x16x32_bf16 v[44:47], a[204:207], a[188:191], v[44:47]
    v_exp_f32 v71, v23
    v_smfmac_f32_16x16x64_bf16 v[72:75], v[84:87], v[56:63], v88
    global_load_dwordx4 a[192:195], v8, s[40:41] offset:0 sc1
    global_load_dwordx4 a[196:199], v8, s[40:41] offset:1024 sc1
    global_load_dwordx4 a[200:203], v8, s[40:41] offset:2048 sc1
    global_load_dwordx4 a[204:207], v8, s[40:41] offset:3072 sc1
    v_cvt_pk_bf16_f32 v50, v68, v69
    v_cvt_pk_bf16_f32 v51, v70, v71
    v_mfma_f32_16x16x32_bf16 a[32:35], a[224:227], v[56:59], 0
    v_exp_f32 v64, v24
    v_mfma_f32_16x16x32_bf16 a[36:39], a[228:231], v[56:59], 0
    v_exp_f32 v65, v25
    v_mfma_f32_16x16x32_bf16 a[40:43], a[232:235], v[56:59], 0
    v_exp_f32 v66, v26
    v_mfma_f32_16x16x32_bf16 a[44:47], a[236:239], v[56:59], 0
    v_exp_f32 v67, v27
    v_cvt_pk_bf16_f32 v52, v64, v65
    v_mfma_f32_16x16x32_bf16 a[48:51], a[224:227], v[60:63], 0
    v_exp_f32 v68, v28
    v_mfma_f32_16x16x32_bf16 a[52:55], a[228:231], v[60:63], 0
    v_exp_f32 v69, v29
    v_cvt_pk_bf16_f32 v53, v66, v67
    v_mfma_f32_16x16x32_bf16 a[56:59], a[232:235], v[60:63], 0
    v_exp_f32 v70, v30
    s_waitcnt vmcnt(8)
    v_mfma_f32_16x16x32_bf16 a[60:63], a[236:239], v[60:63], 0
    v_exp_f32 v71, v31
    v_cvt_pk_bf16_f32 v54, v68, v69
    v_mfma_f32_16x16x32_bf16 v[16:19], a[208:211], a[128:131], v[96:99]
    v_cvt_pk_bf16_f32 v55, v70, v71
    v_exp_f32 v64, v32
    v_mfma_f32_16x16x32_bf16 v[20:23], a[216:219], a[128:131], v[96:99]
    v_exp_f32 v65, v33
    v_mfma_f32_16x16x32_bf16 v[24:27], a[208:211], a[136:139], v[100:103]
    v_exp_f32 v66, v34
    v_mfma_f32_16x16x32_bf16 v[28:31], a[216:219], a[136:139], v[100:103]
    v_exp_f32 v67, v35
    v_cvt_pk_bf16_f32 v56, v64, v65
    v_mfma_f32_16x16x32_bf16 v[16:19], a[212:215], a[132:135], v[16:19]
    v_exp_f32 v68, v36
    v_mfma_f32_16x16x32_bf16 v[20:23], a[220:223], a[132:135], v[20:23]
    v_exp_f32 v69, v37
    v_mfma_f32_16x16x32_bf16 v[24:27], a[212:215], a[140:143], v[24:27]
    v_exp_f32 v70, v38
    v_cvt_pk_bf16_f32 v57, v66, v67
    v_mfma_f32_16x16x32_bf16 v[28:31], a[220:223], a[140:143], v[28:31]
    v_exp_f32 v71, v39
    v_smfmac_f32_16x16x64_bf16 v[76:79], v[80:83], v[48:55], v88
    v_cvt_pk_bf16_f32 v58, v68, v69
    v_cvt_pk_bf16_f32 v59, v70, v71
    v_mfma_f32_16x16x32_bf16 a[64:67], a[224:227], v[48:51], 0
    v_exp_f32 v64, v40
    v_mfma_f32_16x16x32_bf16 a[68:71], a[228:231], v[48:51], 0
    v_exp_f32 v65, v41
    v_mfma_f32_16x16x32_bf16 a[72:75], a[232:235], v[48:51], 0
    v_exp_f32 v66, v42
    v_mfma_f32_16x16x32_bf16 a[76:79], a[236:239], v[48:51], 0
    v_exp_f32 v67, v43
    v_cvt_pk_bf16_f32 v60, v64, v65
    v_mfma_f32_16x16x32_bf16 a[80:83], a[224:227], v[52:55], 0
    v_exp_f32 v68, v44
    v_mfma_f32_16x16x32_bf16 a[84:87], a[228:231], v[52:55], 0
    v_exp_f32 v69, v45
    v_cvt_pk_bf16_f32 v61, v66, v67
    v_mfma_f32_16x16x32_bf16 a[88:91], a[232:235], v[52:55], 0
    v_exp_f32 v70, v46
    v_mfma_f32_16x16x32_bf16 a[92:95], a[236:239], v[52:55], 0
    v_exp_f32 v71, v47
    v_cvt_pk_bf16_f32 v62, v68, v69
K2_LOOP:
    v_mfma_f32_16x16x32_bf16 v[32:35], a[208:211], a[144:147], v[104:107]
    v_cvt_pk_bf16_f32 v63, v70, v71
    v_exp_f32 v64, v16
    v_mfma_f32_16x16x32_bf16 v[36:39], a[216:219], a[144:147], v[104:107]
    v_exp_f32 v65, v17
    v_mfma_f32_16x16x32_bf16 v[40:43], a[208:211], a[152:155], v[108:111]
    v_exp_f32 v66, v18
    v_mfma_f32_16x16x32_bf16 v[44:47], a[216:219], a[152:155], v[108:111]
    v_exp_f32 v67, v19
    v_cvt_pk_bf16_f32 v48, v64, v65
    v_mfma_f32_16x16x32_bf16 v[32:35], a[212:215], a[148:151], v[32:35]
    v_exp_f32 v68, v20
    v_mfma_f32_16x16x32_bf16 v[36:39], a[220:223], a[148:151], v[36:39]
    v_exp_f32 v69, v21
    v_mfma_f32_16x16x32_bf16 v[40:43], a[212:215], a[156:159], v[40:43]
    v_exp_f32 v70, v22
    v_cvt_pk_bf16_f32 v49, v66, v67
    v_mfma_f32_16x16x32_bf16 v[44:47], a[220:223], a[156:159], v[44:47]
    v_exp_f32 v71, v23
    v_smfmac_f32_16x16x64_bf16 v[76:79], v[84:87], v[56:63], v88
    v_add_u32 v8, s28, v8
    v_cvt_pk_bf16_f32 v50, v68, v69
    v_cvt_pk_bf16_f32 v51, v70, v71
    v_mfma_f32_16x16x32_bf16 v[160:163], a[224:227], v[56:59], v[160:163]
    v_exp_f32 v64, v24
    v_mfma_f32_16x16x32_bf16 v[164:167], a[228:231], v[56:59], v[164:167]
    v_exp_f32 v65, v25
    v_mfma_f32_16x16x32_bf16 v[168:171], a[232:235], v[56:59], v[168:171]
    v_exp_f32 v66, v26
    v_mfma_f32_16x16x32_bf16 v[172:175], a[236:239], v[56:59], v[172:175]
    v_exp_f32 v67, v27
    v_cvt_pk_bf16_f32 v52, v64, v65
    v_mfma_f32_16x16x32_bf16 v[176:179], a[224:227], v[60:63], v[176:179]
    v_exp_f32 v68, v28
    v_mfma_f32_16x16x32_bf16 v[180:183], a[228:231], v[60:63], v[180:183]
    v_exp_f32 v69, v29
    v_cvt_pk_bf16_f32 v53, v66, v67
    v_mfma_f32_16x16x32_bf16 v[184:187], a[232:235], v[60:63], v[184:187]
    v_exp_f32 v70, v30
    v_mfma_f32_16x16x32_bf16 v[188:191], a[236:239], v[60:63], v[188:191]
    v_exp_f32 v71, v31
    v_cvt_pk_bf16_f32 v54, v68, v69
    v_mfma_f32_16x16x32_bf16 v[16:19], a[208:211], a[160:163], v[112:115]
    v_cvt_pk_bf16_f32 v55, v70, v71
    v_exp_f32 v64, v32
    v_mfma_f32_16x16x32_bf16 v[20:23], a[216:219], a[160:163], v[112:115]
    v_exp_f32 v65, v33
    v_mfma_f32_16x16x32_bf16 v[24:27], a[208:211], a[168:171], v[116:119]
    v_exp_f32 v66, v34
    v_mfma_f32_16x16x32_bf16 v[28:31], a[216:219], a[168:171], v[116:119]
    v_exp_f32 v67, v35
    v_cvt_pk_bf16_f32 v56, v64, v65
    v_mfma_f32_16x16x32_bf16 v[16:19], a[212:215], a[164:167], v[16:19]
    v_exp_f32 v68, v36
    v_mfma_f32_16x16x32_bf16 v[20:23], a[220:223], a[164:167], v[20:23]
    v_exp_f32 v69, v37
    v_mfma_f32_16x16x32_bf16 v[24:27], a[212:215], a[172:175], v[24:27]
    v_exp_f32 v70, v38
    v_cvt_pk_bf16_f32 v57, v66, v67
    v_mfma_f32_16x16x32_bf16 v[28:31], a[220:223], a[172:175], v[28:31]
    v_exp_f32 v71, v39
    v_smfmac_f32_16x16x64_bf16 v[72:75], v[80:83], v[48:55], v88
    global_load_dwordx4 a[224:227], v8, s[42:43] offset:0 sc1
    global_load_dwordx4 a[228:231], v8, s[42:43] offset:1024 sc1
    global_load_dwordx4 a[232:235], v8, s[42:43] offset:2048 sc1
    global_load_dwordx4 a[236:239], v8, s[42:43] offset:3072 sc1
    v_cvt_pk_bf16_f32 v58, v68, v69
    v_cvt_pk_bf16_f32 v59, v70, v71
    s_waitcnt vmcnt(8)
    v_mfma_f32_16x16x32_bf16 a[0:3], a[240:243], v[48:51], a[0:3]
    v_exp_f32 v64, v40
    v_mfma_f32_16x16x32_bf16 a[4:7], a[244:247], v[48:51], a[4:7]
    v_exp_f32 v65, v41
    v_mfma_f32_16x16x32_bf16 a[8:11], a[248:251], v[48:51], a[8:11]
    v_exp_f32 v66, v42
    v_mfma_f32_16x16x32_bf16 a[12:15], a[252:255], v[48:51], a[12:15]
    v_exp_f32 v67, v43
    v_cvt_pk_bf16_f32 v60, v64, v65
    v_mfma_f32_16x16x32_bf16 a[16:19], a[240:243], v[52:55], a[16:19]
    v_exp_f32 v68, v44
    v_mfma_f32_16x16x32_bf16 a[20:23], a[244:247], v[52:55], a[20:23]
    v_exp_f32 v69, v45
    v_cvt_pk_bf16_f32 v61, v66, v67
    v_mfma_f32_16x16x32_bf16 a[24:27], a[248:251], v[52:55], a[24:27]
    v_exp_f32 v70, v46
    v_mfma_f32_16x16x32_bf16 a[28:31], a[252:255], v[52:55], a[28:31]
    v_exp_f32 v71, v47
    v_cvt_pk_bf16_f32 v62, v68, v69
    v_mfma_f32_16x16x32_bf16 v[32:35], a[208:211], a[176:179], v[120:123]
    v_cvt_pk_bf16_f32 v63, v70, v71
    v_exp_f32 v64, v16
    v_mfma_f32_16x16x32_bf16 v[36:39], a[216:219], a[176:179], v[120:123]
    v_exp_f32 v65, v17
    v_mfma_f32_16x16x32_bf16 v[40:43], a[208:211], a[184:187], v[124:127]
    v_exp_f32 v66, v18
    v_mfma_f32_16x16x32_bf16 v[44:47], a[216:219], a[184:187], v[124:127]
    v_exp_f32 v67, v19
    v_cvt_pk_bf16_f32 v48, v64, v65
    v_mfma_f32_16x16x32_bf16 v[32:35], a[212:215], a[180:183], v[32:35]
    v_exp_f32 v68, v20
    v_mfma_f32_16x16x32_bf16 v[36:39], a[220:223], a[180:183], v[36:39]
    v_exp_f32 v69, v21
    v_mfma_f32_16x16x32_bf16 v[40:43], a[212:215], a[188:191], v[40:43]
    v_exp_f32 v70, v22
    v_cvt_pk_bf16_f32 v49, v66, v67
    v_mfma_f32_16x16x32_bf16 v[44:47], a[220:223], a[188:191], v[44:47]
    v_exp_f32 v71, v23
    v_smfmac_f32_16x16x64_bf16 v[72:75], v[84:87], v[56:63], v88
    global_load_dwordx4 a[208:211], v8, s[40:41] offset:0 sc1
    global_load_dwordx4 a[212:215], v8, s[40:41] offset:1024 sc1
    global_load_dwordx4 a[216:219], v8, s[40:41] offset:2048 sc1
    global_load_dwordx4 a[220:223], v8, s[40:41] offset:3072 sc1
    v_cvt_pk_bf16_f32 v50, v68, v69
    v_cvt_pk_bf16_f32 v51, v70, v71
    v_mfma_f32_16x16x32_bf16 a[32:35], a[240:243], v[56:59], a[32:35]
    v_exp_f32 v64, v24
    v_mfma_f32_16x16x32_bf16 a[36:39], a[244:247], v[56:59], a[36:39]
    v_exp_f32 v65, v25
    v_mfma_f32_16x16x32_bf16 a[40:43], a[248:251], v[56:59], a[40:43]
    v_exp_f32 v66, v26
    v_mfma_f32_16x16x32_bf16 a[44:47], a[252:255], v[56:59], a[44:47]
    v_exp_f32 v67, v27
    v_cvt_pk_bf16_f32 v52, v64, v65
    v_mfma_f32_16x16x32_bf16 a[48:51], a[240:243], v[60:63], a[48:51]
    v_exp_f32 v68, v28
    v_mfma_f32_16x16x32_bf16 a[52:55], a[244:247], v[60:63], a[52:55]
    v_exp_f32 v69, v29
    v_cvt_pk_bf16_f32 v53, v66, v67
    v_mfma_f32_16x16x32_bf16 a[56:59], a[248:251], v[60:63], a[56:59]
    v_exp_f32 v70, v30
    s_waitcnt vmcnt(8)
    v_mfma_f32_16x16x32_bf16 a[60:63], a[252:255], v[60:63], a[60:63]
    v_exp_f32 v71, v31
    v_cvt_pk_bf16_f32 v54, v68, v69
    v_mfma_f32_16x16x32_bf16 v[16:19], a[192:195], a[128:131], v[96:99]
    v_cvt_pk_bf16_f32 v55, v70, v71
    v_exp_f32 v64, v32
    v_mfma_f32_16x16x32_bf16 v[20:23], a[200:203], a[128:131], v[96:99]
    v_exp_f32 v65, v33
    v_mfma_f32_16x16x32_bf16 v[24:27], a[192:195], a[136:139], v[100:103]
    v_exp_f32 v66, v34
    v_mfma_f32_16x16x32_bf16 v[28:31], a[200:203], a[136:139], v[100:103]
    v_exp_f32 v67, v35
    v_cvt_pk_bf16_f32 v56, v64, v65
    v_mfma_f32_16x16x32_bf16 v[16:19], a[196:199], a[132:135], v[16:19]
    v_exp_f32 v68, v36
    v_mfma_f32_16x16x32_bf16 v[20:23], a[204:207], a[132:135], v[20:23]
    v_exp_f32 v69, v37
    v_mfma_f32_16x16x32_bf16 v[24:27], a[196:199], a[140:143], v[24:27]
    v_exp_f32 v70, v38
    v_cvt_pk_bf16_f32 v57, v66, v67
    v_mfma_f32_16x16x32_bf16 v[28:31], a[204:207], a[140:143], v[28:31]
    v_exp_f32 v71, v39
    v_smfmac_f32_16x16x64_bf16 v[76:79], v[80:83], v[48:55], v88
    v_cvt_pk_bf16_f32 v58, v68, v69
    v_cvt_pk_bf16_f32 v59, v70, v71
    v_mfma_f32_16x16x32_bf16 a[64:67], a[240:243], v[48:51], a[64:67]
    v_exp_f32 v64, v40
    v_mfma_f32_16x16x32_bf16 a[68:71], a[244:247], v[48:51], a[68:71]
    v_exp_f32 v65, v41
    v_mfma_f32_16x16x32_bf16 a[72:75], a[248:251], v[48:51], a[72:75]
    v_exp_f32 v66, v42
    v_mfma_f32_16x16x32_bf16 a[76:79], a[252:255], v[48:51], a[76:79]
    v_exp_f32 v67, v43
    v_cvt_pk_bf16_f32 v60, v64, v65
    v_mfma_f32_16x16x32_bf16 a[80:83], a[240:243], v[52:55], a[80:83]
    v_exp_f32 v68, v44
    v_mfma_f32_16x16x32_bf16 a[84:87], a[244:247], v[52:55], a[84:87]
    v_exp_f32 v69, v45
    v_cvt_pk_bf16_f32 v61, v66, v67
    v_mfma_f32_16x16x32_bf16 a[88:91], a[248:251], v[52:55], a[88:91]
    v_exp_f32 v70, v46
    v_mfma_f32_16x16x32_bf16 a[92:95], a[252:255], v[52:55], a[92:95]
    v_exp_f32 v71, v47
    v_cvt_pk_bf16_f32 v62, v68, v69
    v_mfma_f32_16x16x32_bf16 v[32:35], a[192:195], a[144:147], v[104:107]
    v_cvt_pk_bf16_f32 v63, v70, v71
    v_exp_f32 v64, v16
    v_mfma_f32_16x16x32_bf16 v[36:39], a[200:203], a[144:147], v[104:107]
    v_exp_f32 v65, v17
    v_mfma_f32_16x16x32_bf16 v[40:43], a[192:195], a[152:155], v[108:111]
    v_exp_f32 v66, v18
    v_mfma_f32_16x16x32_bf16 v[44:47], a[200:203], a[152:155], v[108:111]
    v_exp_f32 v67, v19
    v_cvt_pk_bf16_f32 v48, v64, v65
    v_mfma_f32_16x16x32_bf16 v[32:35], a[196:199], a[148:151], v[32:35]
    v_exp_f32 v68, v20
    v_mfma_f32_16x16x32_bf16 v[36:39], a[204:207], a[148:151], v[36:39]
    v_exp_f32 v69, v21
    v_mfma_f32_16x16x32_bf16 v[40:43], a[196:199], a[156:159], v[40:43]
    v_exp_f32 v70, v22
    v_cvt_pk_bf16_f32 v49, v66, v67
    v_mfma_f32_16x16x32_bf16 v[44:47], a[204:207], a[156:159], v[44:47]
    v_exp_f32 v71, v23
    v_smfmac_f32_16x16x64_bf16 v[76:79], v[84:87], v[56:63], v88
    v_add_u32 v8, s28, v8
    s_sub_u32 s29, s29, 1
    v_cvt_pk_bf16_f32 v50, v68, v69
    v_cvt_pk_bf16_f32 v51, v70, v71
    v_mfma_f32_16x16x32_bf16 v[160:163], a[240:243], v[56:59], v[160:163]
    v_exp_f32 v64, v24
    v_mfma_f32_16x16x32_bf16 v[164:167], a[244:247], v[56:59], v[164:167]
    v_exp_f32 v65, v25
    v_mfma_f32_16x16x32_bf16 v[168:171], a[248:251], v[56:59], v[168:171]
    v_exp_f32 v66, v26
    v_mfma_f32_16x16x32_bf16 v[172:175], a[252:255], v[56:59], v[172:175]
    v_exp_f32 v67, v27
    v_cvt_pk_bf16_f32 v52, v64, v65
    v_mfma_f32_16x16x32_bf16 v[176:179], a[240:243], v[60:63], v[176:179]
    v_exp_f32 v68, v28
    v_mfma_f32_16x16x32_bf16 v[180:183], a[244:247], v[60:63], v[180:183]
    v_exp_f32 v69, v29
    v_cvt_pk_bf16_f32 v53, v66, v67
    v_mfma_f32_16x16x32_bf16 v[184:187], a[248:251], v[60:63], v[184:187]
    v_exp_f32 v70, v30
    v_mfma_f32_16x16x32_bf16 v[188:191], a[252:255], v[60:63], v[188:191]
    v_exp_f32 v71, v31
    v_cvt_pk_bf16_f32 v54, v68, v69
    v_mfma_f32_16x16x32_bf16 v[16:19], a[192:195], a[160:163], v[112:115]
    v_cvt_pk_bf16_f32 v55, v70, v71
    v_exp_f32 v64, v32
    v_mfma_f32_16x16x32_bf16 v[20:23], a[200:203], a[160:163], v[112:115]
    v_exp_f32 v65, v33
    v_mfma_f32_16x16x32_bf16 v[24:27], a[192:195], a[168:171], v[116:119]
    v_exp_f32 v66, v34
    v_mfma_f32_16x16x32_bf16 v[28:31], a[200:203], a[168:171], v[116:119]
    v_exp_f32 v67, v35
    v_cvt_pk_bf16_f32 v56, v64, v65
    v_mfma_f32_16x16x32_bf16 v[16:19], a[196:199], a[164:167], v[16:19]
    v_exp_f32 v68, v36
    v_mfma_f32_16x16x32_bf16 v[20:23], a[204:207], a[164:167], v[20:23]
    v_exp_f32 v69, v37
    v_mfma_f32_16x16x32_bf16 v[24:27], a[196:199], a[172:175], v[24:27]
    v_exp_f32 v70, v38
    v_cvt_pk_bf16_f32 v57, v66, v67
    v_mfma_f32_16x16x32_bf16 v[28:31], a[204:207], a[172:175], v[28:31]
    v_exp_f32 v71, v39
    v_smfmac_f32_16x16x64_bf16 v[72:75], v[80:83], v[48:55], v88
    global_load_dwordx4 a[240:243], v8, s[42:43] offset:0 sc1
    global_load_dwordx4 a[244:247], v8, s[42:43] offset:1024 sc1
    global_load_dwordx4 a[248:251], v8, s[42:43] offset:2048 sc1
    global_load_dwordx4 a[252:255], v8, s[42:43] offset:3072 sc1
    v_cvt_pk_bf16_f32 v58, v68, v69
    v_cvt_pk_bf16_f32 v59, v70, v71
    s_waitcnt vmcnt(8)
    v_mfma_f32_16x16x32_bf16 a[0:3], a[224:227], v[48:51], a[0:3]
    v_exp_f32 v64, v40
    v_mfma_f32_16x16x32_bf16 a[4:7], a[228:231], v[48:51], a[4:7]
    v_exp_f32 v65, v41
    v_mfma_f32_16x16x32_bf16 a[8:11], a[232:235], v[48:51], a[8:11]
    v_exp_f32 v66, v42
    v_mfma_f32_16x16x32_bf16 a[12:15], a[236:239], v[48:51], a[12:15]
    v_exp_f32 v67, v43
    v_cvt_pk_bf16_f32 v60, v64, v65
    v_mfma_f32_16x16x32_bf16 a[16:19], a[224:227], v[52:55], a[16:19]
    v_exp_f32 v68, v44
    v_mfma_f32_16x16x32_bf16 a[20:23], a[228:231], v[52:55], a[20:23]
    v_exp_f32 v69, v45
    v_cvt_pk_bf16_f32 v61, v66, v67
    v_mfma_f32_16x16x32_bf16 a[24:27], a[232:235], v[52:55], a[24:27]
    v_exp_f32 v70, v46
    v_mfma_f32_16x16x32_bf16 a[28:31], a[236:239], v[52:55], a[28:31]
    v_exp_f32 v71, v47
    v_cvt_pk_bf16_f32 v62, v68, v69
    v_mfma_f32_16x16x32_bf16 v[32:35], a[192:195], a[176:179], v[120:123]
    v_cvt_pk_bf16_f32 v63, v70, v71
    v_exp_f32 v64, v16
    v_mfma_f32_16x16x32_bf16 v[36:39], a[200:203], a[176:179], v[120:123]
    v_exp_f32 v65, v17
    v_mfma_f32_16x16x32_bf16 v[40:43], a[192:195], a[184:187], v[124:127]
    v_exp_f32 v66, v18
    v_mfma_f32_16x16x32_bf16 v[44:47], a[200:203], a[184:187], v[124:127]
    v_exp_f32 v67, v19
    v_cvt_pk_bf16_f32 v48, v64, v65
    v_mfma_f32_16x16x32_bf16 v[32:35], a[196:199], a[180:183], v[32:35]
    v_exp_f32 v68, v20
    v_mfma_f32_16x16x32_bf16 v[36:39], a[204:207], a[180:183], v[36:39]
    v_exp_f32 v69, v21
    v_mfma_f32_16x16x32_bf16 v[40:43], a[196:199], a[188:191], v[40:43]
    v_exp_f32 v70, v22
    v_cvt_pk_bf16_f32 v49, v66, v67
    v_mfma_f32_16x16x32_bf16 v[44:47], a[204:207], a[188:191], v[44:47]
    v_exp_f32 v71, v23
    v_smfmac_f32_16x16x64_bf16 v[72:75], v[84:87], v[56:63], v88
    global_load_dwordx4 a[192:195], v8, s[40:41] offset:0 sc1
    global_load_dwordx4 a[196:199], v8, s[40:41] offset:1024 sc1
    global_load_dwordx4 a[200:203], v8, s[40:41] offset:2048 sc1
    global_load_dwordx4 a[204:207], v8, s[40:41] offset:3072 sc1
    v_cvt_pk_bf16_f32 v50, v68, v69
    v_cvt_pk_bf16_f32 v51, v70, v71
    v_mfma_f32_16x16x32_bf16 a[32:35], a[224:227], v[56:59], a[32:35]
    v_exp_f32 v64, v24
    v_mfma_f32_16x16x32_bf16 a[36:39], a[228:231], v[56:59], a[36:39]
    v_exp_f32 v65, v25
    v_mfma_f32_16x16x32_bf16 a[40:43], a[232:235], v[56:59], a[40:43]
    v_exp_f32 v66, v26
    v_mfma_f32_16x16x32_bf16 a[44:47], a[236:239], v[56:59], a[44:47]
    v_exp_f32 v67, v27
    v_cvt_pk_bf16_f32 v52, v64, v65
    v_mfma_f32_16x16x32_bf16 a[48:51], a[224:227], v[60:63], a[48:51]
    v_exp_f32 v68, v28
    v_mfma_f32_16x16x32_bf16 a[52:55], a[228:231], v[60:63], a[52:55]
    v_exp_f32 v69, v29
    v_cvt_pk_bf16_f32 v53, v66, v67
    v_mfma_f32_16x16x32_bf16 a[56:59], a[232:235], v[60:63], a[56:59]
    v_exp_f32 v70, v30
    s_waitcnt vmcnt(8)
    v_mfma_f32_16x16x32_bf16 a[60:63], a[236:239], v[60:63], a[60:63]
    v_exp_f32 v71, v31
    v_cvt_pk_bf16_f32 v54, v68, v69
    v_mfma_f32_16x16x32_bf16 v[16:19], a[208:211], a[128:131], v[96:99]
    v_cvt_pk_bf16_f32 v55, v70, v71
    v_exp_f32 v64, v32
    v_mfma_f32_16x16x32_bf16 v[20:23], a[216:219], a[128:131], v[96:99]
    v_exp_f32 v65, v33
    v_mfma_f32_16x16x32_bf16 v[24:27], a[208:211], a[136:139], v[100:103]
    v_exp_f32 v66, v34
    v_mfma_f32_16x16x32_bf16 v[28:31], a[216:219], a[136:139], v[100:103]
    v_exp_f32 v67, v35
    v_cvt_pk_bf16_f32 v56, v64, v65
    v_mfma_f32_16x16x32_bf16 v[16:19], a[212:215], a[132:135], v[16:19]
    v_exp_f32 v68, v36
    v_mfma_f32_16x16x32_bf16 v[20:23], a[220:223], a[132:135], v[20:23]
    v_exp_f32 v69, v37
    v_mfma_f32_16x16x32_bf16 v[24:27], a[212:215], a[140:143], v[24:27]
    v_exp_f32 v70, v38
    v_cvt_pk_bf16_f32 v57, v66, v67
    v_mfma_f32_16x16x32_bf16 v[28:31], a[220:223], a[140:143], v[28:31]
    v_exp_f32 v71, v39
    v_smfmac_f32_16x16x64_bf16 v[76:79], v[80:83], v[48:55], v88
    global_load_dword v12, v10, s[58:59]
    v_cvt_pk_bf16_f32 v58, v68, v69
    v_cvt_pk_bf16_f32 v59, v70, v71
    v_mfma_f32_16x16x32_bf16 a[64:67], a[224:227], v[48:51], a[64:67]
    v_exp_f32 v64, v40
    v_mfma_f32_16x16x32_bf16 a[68:71], a[228:231], v[48:51], a[68:71]
    v_exp_f32 v65, v41
    v_mfma_f32_16x16x32_bf16 a[72:75], a[232:235], v[48:51], a[72:75]
    v_exp_f32 v66, v42
    v_mfma_f32_16x16x32_bf16 a[76:79], a[236:239], v[48:51], a[76:79]
    v_add_u32 v10, v11, v10
    v_exp_f32 v67, v43
    v_cvt_pk_bf16_f32 v60, v64, v65
    v_mfma_f32_16x16x32_bf16 a[80:83], a[224:227], v[52:55], a[80:83]
    v_exp_f32 v68, v44
    v_mfma_f32_16x16x32_bf16 a[84:87], a[228:231], v[52:55], a[84:87]
    v_exp_f32 v69, v45
    v_cvt_pk_bf16_f32 v61, v66, v67
    v_mfma_f32_16x16x32_bf16 a[88:91], a[232:235], v[52:55], a[88:91]
    v_exp_f32 v70, v46
    v_mfma_f32_16x16x32_bf16 a[92:95], a[236:239], v[52:55], a[92:95]
    v_exp_f32 v71, v47
    v_cvt_pk_bf16_f32 v62, v68, v69
    s_cbranch_scc0 K2_LOOP
    s_sub_u32 s63, s63, 1
    s_cbranch_scc1 K2_TAIL
    s_cmp_eq_u32 s63, 0
    s_cbranch_scc1 K2_M2
    global_load_dword v203, v201, s[4:5] sc1
    global_load_dword v207, v204, s[4:5] sc1
    s_mov_b32 s29, 0
    s_branch K2_LOOP
K2_M2:
    s_mov_b32 s29, 11
    s_mov_b64 s[58:59], s[4:5]
    v_and_b32 v203, v203, v207
    v_mov_b32 v10, v205
    v_cmp_eq_u32 vcc, 0, v203
    v_mov_b32 v11, v206
    s_nop 3
    s_cbranch_vccz K2_LOOP
    s_mov_b32 s56, 0
K2_MP:
    global_load_dword v203, v201, s[4:5] sc1
    global_load_dword v207, v204, s[4:5] sc1
    s_add_u32 s56, s56, 1
    s_waitcnt vmcnt(0)
    v_and_b32 v203, v203, v207
    v_cmp_eq_u32 vcc, 0, v203
    s_cmp_lt_u32 s56, 0x20000
    s_nop 0
    s_cselect_b64 s[30:31], vcc, 0
    s_cmp_lg_u64 s[30:31], 0
    s_cbranch_scc1 K2_MP
    s_branch K2_LOOP
K2_TAIL:
    v_mfma_f32_16x16x32_bf16 v[32:35], a[208:211], a[144:147], v[104:107]
    v_add_u32 v247, s62, v7
    v_cvt_pk_bf16_f32 v63, v70, v71
    v_exp_f32 v64, v16
    v_mfma_f32_16x16x32_bf16 v[36:39], a[216:219], a[144:147], v[104:107]
    v_exp_f32 v65, v17
    v_mfma_f32_16x16x32_bf16 v[40:43], a[208:211], a[152:155], v[108:111]
    v_exp_f32 v66, v18
    v_mfma_f32_16x16x32_bf16 v[44:47], a[216:219], a[152:155], v[108:111]
    v_exp_f32 v67, v19
    v_cvt_pk_bf16_f32 v48, v64, v65
    v_mfma_f32_16x16x32_bf16 v[32:35], a[212:215], a[148:151], v[32:35]
    v_exp_f32 v68, v20
    v_mfma_f32_16x16x32_bf16 v[36:39], a[220:223], a[148:151], v[36:39]
    v_exp_f32 v69, v21
    v_mfma_f32_16x16x32_bf16 v[40:43], a[212:215], a[156:159], v[40:43]
    v_exp_f32 v70, v22
    v_cvt_pk_bf16_f32 v49, v66, v67
    v_mfma_f32_16x16x32_bf16 v[44:47], a[220:223], a[156:159], v[44:47]
    v_exp_f32 v71, v23
    v_smfmac_f32_16x16x64_bf16 v[76:79], v[84:87], v[56:63], v88
    v_add_u32 v8, s28, v8
    global_load_dwordx4 v[200:203], v247, s[60:61] offset:-4096 sc1
    global_load_dwordx4 v[204:207], v247, s[60:61] offset:-3072 sc1
    global_load_dwordx4 v[208:211], v247, s[60:61] offset:-2048 sc1
    global_load_dwordx4 v[212:215], v247, s[60:61] offset:-1024 sc1
    v_cvt_pk_bf16_f32 v50, v68, v69
    v_cvt_pk_bf16_f32 v51, v70, v71
    v_mfma_f32_16x16x32_bf16 v[160:163], a[224:227], v[56:59], v[160:163]
    v_exp_f32 v64, v24
    v_mfma_f32_16x16x32_bf16 v[164:167], a[228:231], v[56:59], v[164:167]
    v_exp_f32 v65, v25
    v_mfma_f32_16x16x32_bf16 v[168:171], a[232:235], v[56:59], v[168:171]
    v_exp_f32 v66, v26
    v_mfma_f32_16x16x32_bf16 v[172:175], a[236:239], v[56:59], v[172:175]
    global_load_dwordx4 v[216:219], v247, s[60:61] offset:0 sc1
    global_load_dwordx4 v[220:223], v247, s[60:61] offset:1024 sc1
    global_load_dwordx4 v[224:227], v247, s[60:61] offset:2048 sc1
    global_load_dwordx4 v[228:231], v247, s[60:61] offset:3072 sc1
    v_exp_f32 v67, v27
    v_cvt_pk_bf16_f32 v52, v64, v65
    v_mfma_f32_16x16x32_bf16 v[176:179], a[224:227], v[60:63], v[176:179]
    v_exp_f32 v68, v28
    v_mfma_f32_16x16x32_bf16 v[180:183], a[228:231], v[60:63], v[180:183]
    v_exp_f32 v69, v29
    v_cvt_pk_bf16_f32 v53, v66, v67
    v_mfma_f32_16x16x32_bf16 v[184:187], a[232:235], v[60:63], v[184:187]
    v_exp_f32 v70, v30
    v_mfma_f32_16x16x32_bf16 v[188:191], a[236:239], v[60:63], v[188:191]
    v_exp_f32 v71, v31
    v_cvt_pk_bf16_f32 v54, v68, v69
    v_mfma_f32_16x16x32_bf16 v[16:19], a[208:211], a[160:163], v[112:115]
    v_cvt_pk_bf16_f32 v55, v70, v71
    v_exp_f32 v64, v32
    v_mfma_f32_16x16x32_bf16 v[20:23], a[216:219], a[160:163], v[112:115]
    v_exp_f32 v65, v33
    v_mfma_f32_16x16x32_bf16 v[24:27], a[208:211], a[168:171], v[116:119]
    v_exp_f32 v66, v34
    v_mfma_f32_16x16x32_bf16 v[28:31], a[216:219], a[168:171], v[116:119]
    v_exp_f32 v67, v35
    v_cvt_pk_bf16_f32 v56, v64, v65
    v_mfma_f32_16x16x32_bf16 v[16:19], a[212:215], a[164:167], v[16:19]
    v_exp_f32 v68, v36
    v_mfma_f32_16x16x32_bf16 v[20:23], a[220:223], a[164:167], v[20:23]
    v_exp_f32 v69, v37
    v_mfma_f32_16x16x32_bf16 v[24:27], a[212:215], a[172:175], v[24:27]
    v_exp_f32 v70, v38
    v_cvt_pk_bf16_f32 v57, v66, v67
    v_mfma_f32_16x16x32_bf16 v[28:31], a[220:223], a[172:175], v[28:31]
    v_exp_f32 v71, v39
    v_smfmac_f32_16x16x64_bf16 v[72:75], v[80:83], v[48:55], v88
    global_load_dwordx4 a[224:227], v8, s[42:43] offset:0 sc1
    global_load_dwordx4 a[228:231], v8, s[42:43] offset:1024 sc1
    global_load_dwordx4 a[232:235], v8, s[42:43] offset:2048 sc1
    global_load_dwordx4 a[236:239], v8, s[42:43] offset:3072 sc1
    v_cvt_pk_bf16_f32 v58, v68, v69
    v_cvt_pk_bf16_f32 v59, v70, v71
    s_waitcnt vmcnt(17)
    v_mfma_f32_16x16x32_bf16 a[0:3], a[240:243], v[48:51], a[0:3]
    v_exp_f32 v64, v40
    v_mfma_f32_16x16x32_bf16 a[4:7], a[244:247], v[48:51], a[4:7]
    v_exp_f32 v65, v41
    v_mfma_f32_16x16x32_bf16 a[8:11], a[248:251], v[48:51], a[8:11]
    v_exp_f32 v66, v42
    v_mfma_f32_16x16x32_bf16 a[12:15], a[252:255], v[48:51], a[12:15]
    v_exp_f32 v67, v43
    v_cvt_pk_bf16_f32 v60, v64, v65
    v_mfma_f32_16x16x32_bf16 a[16:19], a[240:243], v[52:55], a[16:19]
    v_exp_f32 v68, v44
    v_mfma_f32_16x16x32_bf16 a[20:23], a[244:247], v[52:55], a[20:23]
    v_exp_f32 v69, v45
    v_cvt_pk_bf16_f32 v61, v66, v67
    v_mfma_f32_16x16x32_bf16 a[24:27], a[248:251], v[52:55], a[24:27]
    v_exp_f32 v70, v46
    v_mfma_f32_16x16x32_bf16 a[28:31], a[252:255], v[52:55], a[28:31]
    v_exp_f32 v71, v47
    v_cvt_pk_bf16_f32 v62, v68, v69
    v_mfma_f32_16x16x32_bf16 v[32:35], a[208:211], a[176:179], v[120:123]
    v_cvt_pk_bf16_f32 v63, v70, v71
    v_exp_f32 v64, v16
    v_mfma_f32_16x16x32_bf16 v[36:39], a[216:219], a[176:179], v[120:123]
    v_exp_f32 v65, v17
    v_mfma_f32_16x16x32_bf16 v[40:43], a[208:211], a[184:187], v[124:127]
    v_exp_f32 v66, v18
    v_mfma_f32_16x16x32_bf16 v[44:47], a[216:219], a[184:187], v[124:127]
    v_exp_f32 v67, v19
    v_cvt_pk_bf16_f32 v48, v64, v65
    v_mfma_f32_16x16x32_bf16 v[32:35], a[212:215], a[180:183], v[32:35]
    v_exp_f32 v68, v20
    v_mfma_f32_16x16x32_bf16 v[36:39], a[220:223], a[180:183], v[36:39]
    v_exp_f32 v69, v21
    v_mfma_f32_16x16x32_bf16 v[40:43], a[212:215], a[188:191], v[40:43]
    v_exp_f32 v70, v22
    v_cvt_pk_bf16_f32 v49, v66, v67
    v_mfma_f32_16x16x32_bf16 v[44:47], a[220:223], a[188:191], v[44:47]
    v_exp_f32 v71, v23
    v_smfmac_f32_16x16x64_bf16 v[72:75], v[84:87], v[56:63], v88
    v_cvt_pk_bf16_f32 v50, v68, v69
    v_cvt_pk_bf16_f32 v51, v70, v71
    v_mfma_f32_16x16x32_bf16 a[32:35], a[240:243], v[56:59], a[32:35]
    v_exp_f32 v64, v24
    v_mfma_f32_16x16x32_bf16 a[36:39], a[244:247], v[56:59], a[36:39]
    v_exp_f32 v65, v25
    v_mfma_f32_16x16x32_bf16 a[40:43], a[248:251], v[56:59], a[40:43]
    v_exp_f32 v66, v26
    v_mfma_f32_16x16x32_bf16 a[44:47], a[252:255], v[56:59], a[44:47]
    v_add_u32 v247, 0x2000, v247
    global_load_dwordx4 a[96:99], v247, s[60:61] offset:-4096 sc1
    global_load_dwordx4 a[100:103], v247, s[60:61] offset:-3072 sc1
    global_load_dwordx4 a[104:107], v247, s[60:61] offset:-2048 sc1
    global_load_dwordx4 a[108:111], v247, s[60:61] offset:-1024 sc1
    v_exp_f32 v67, v27
    v_cvt_pk_bf16_f32 v52, v64, v65
    v_mfma_f32_16x16x32_bf16 a[48:51], a[240:243], v[60:63], a[48:51]
    v_exp_f32 v68, v28
    v_mfma_f32_16x16x32_bf16 a[52:55], a[244:247], v[60:63], a[52:55]
    v_exp_f32 v69, v29
    v_cvt_pk_bf16_f32 v53, v66, v67
    v_mfma_f32_16x16x32_bf16 a[56:59], a[248:251], v[60:63], a[56:59]
    v_exp_f32 v70, v30
    s_waitcnt vmcnt(17)
    v_mfma_f32_16x16x32_bf16 a[60:63], a[252:255], v[60:63], a[60:63]
    v_exp_f32 v71, v31
    v_cvt_pk_bf16_f32 v54, v68, v69
    v_mfma_f32_16x16x32_bf16 v[16:19], a[192:195], a[128:131], v[96:99]
    v_cvt_pk_bf16_f32 v55, v70, v71
    v_exp_f32 v64, v32
    v_mfma_f32_16x16x32_bf16 v[20:23], a[200:203], a[128:131], v[96:99]
    v_exp_f32 v65, v33
    v_mfma_f32_16x16x32_bf16 v[24:27], a[192:195], a[136:139], v[100:103]
    v_exp_f32 v66, v34
    v_mfma_f32_16x16x32_bf16 v[28:31], a[200:203], a[136:139], v[100:103]
    v_exp_f32 v67, v35
    v_cvt_pk_bf16_f32 v56, v64, v65
    v_mfma_f32_16x16x32_bf16 v[16:19], a[196:199], a[132:135], v[16:19]
    v_exp_f32 v68, v36
    v_mfma_f32_16x16x32_bf16 v[20:23], a[204:207], a[132:135], v[20:23]
    v_exp_f32 v69, v37
    v_mfma_f32_16x16x32_bf16 v[24:27], a[196:199], a[140:143], v[24:27]
    v_exp_f32 v70, v38
    v_cvt_pk_bf16_f32 v57, v66, v67
    v_mfma_f32_16x16x32_bf16 v[28:31], a[204:207], a[140:143], v[28:31]
    v_exp_f32 v71, v39
    v_smfmac_f32_16x16x64_bf16 v[76:79], v[80:83], v[48:55], v88
    global_load_dwordx4 a[112:115], v247, s[60:61] offset:0 sc1
    global_load_dwordx4 a[116:119], v247, s[60:61] offset:1024 sc1
    global_load_dwordx4 a[120:123], v247, s[60:61] offset:2048 sc1
    global_load_dwordx4 a[124:127], v247, s[60:61] offset:3072 sc1
    v_cvt_pk_bf16_f32 v58, v68, v69
    v_cvt_pk_bf16_f32 v59, v70, v71
    v_mfma_f32_16x16x32_bf16 a[64:67], a[240:243], v[48:51], a[64:67]
    v_exp_f32 v64, v40
    v_mfma_f32_16x16x32_bf16 a[68:71], a[244:247], v[48:51], a[68:71]
    v_exp_f32 v65, v41
    v_mfma_f32_16x16x32_bf16 a[72:75], a[248:251], v[48:51], a[72:75]
    v_exp_f32 v66, v42
    v_mfma_f32_16x16x32_bf16 a[76:79], a[252:255], v[48:51], a[76:79]
    v_exp_f32 v67, v43
    v_cvt_pk_bf16_f32 v60, v64, v65
    v_mfma_f32_16x16x32_bf16 a[80:83], a[240:243], v[52:55], a[80:83]
    v_exp_f32 v68, v44
    v_mfma_f32_16x16x32_bf16 a[84:87], a[244:247], v[52:55], a[84:87]
    v_exp_f32 v69, v45
    v_cvt_pk_bf16_f32 v61, v66, v67
    v_mfma_f32_16x16x32_bf16 a[88:91], a[248:251], v[52:55], a[88:91]
    v_exp_f32 v70, v46
    v_mfma_f32_16x16x32_bf16 a[92:95], a[252:255], v[52:55], a[92:95]
    v_exp_f32 v71, v47
    v_cvt_pk_bf16_f32 v62, v68, v69
    v_mfma_f32_16x16x32_bf16 v[32:35], a[192:195], a[144:147], v[104:107]
    v_cvt_pk_bf16_f32 v63, v70, v71
    v_exp_f32 v64, v16
    v_mfma_f32_16x16x32_bf16 v[36:39], a[200:203], a[144:147], v[104:107]
    v_exp_f32 v65, v17
    v_mfma_f32_16x16x32_bf16 v[40:43], a[192:195], a[152:155], v[108:111]
    v_exp_f32 v66, v18
    v_mfma_f32_16x16x32_bf16 v[44:47], a[200:203], a[152:155], v[108:111]
    v_exp_f32 v67, v19
    v_cvt_pk_bf16_f32 v48, v64, v65
    v_mfma_f32_16x16x32_bf16 v[32:35], a[196:199], a[148:151], v[32:35]
    v_exp_f32 v68, v20
    v_mfma_f32_16x16x32_bf16 v[36:39], a[204:207], a[148:151], v[36:39]
    v_exp_f32 v69, v21
    v_mfma_f32_16x16x32_bf16 v[40:43], a[196:199], a[156:159], v[40:43]
    v_exp_f32 v70, v22
    v_cvt_pk_bf16_f32 v49, v66, v67
    v_mfma_f32_16x16x32_bf16 v[44:47], a[204:207], a[156:159], v[44:47]
    v_exp_f32 v71, v23
    v_smfmac_f32_16x16x64_bf16 v[76:79], v[84:87], v[56:63], v88
    v_add_u32 v247, 0x2000, v247
    global_load_dwordx4 a[208:211], v247, s[60:61] offset:-4096 sc1
    global_load_dwordx4 a[212:215], v247, s[60:61] offset:-3072 sc1
    global_load_dwordx4 a[216:219], v247, s[60:61] offset:-2048 sc1
    global_load_dwordx4 a[220:223], v247, s[60:61] offset:-1024 sc1
    v_cvt_pk_bf16_f32 v50, v68, v69
    v_cvt_pk_bf16_f32 v51, v70, v71
    v_mfma_f32_16x16x32_bf16 v[160:163], a[240:243], v[56:59], v[160:163]
    v_exp_f32 v64, v24
    v_mfma_f32_16x16x32_bf16 v[164:167], a[244:247], v[56:59], v[164:167]
    v_exp_f32 v65, v25
    v_mfma_f32_16x16x32_bf16 v[168:171], a[248:251], v[56:59], v[168:171]
    v_exp_f32 v66, v26
    v_mfma_f32_16x16x32_bf16 v[172:175], a[252:255], v[56:59], v[172:175]
    v_exp_f32 v67, v27
    v_cvt_pk_bf16_f32 v52, v64, v65
    v_mfma_f32_16x16x32_bf16 v[176:179], a[240:243], v[60:63], v[176:179]
    v_exp_f32 v68, v28
    v_mfma_f32_16x16x32_bf16 v[180:183], a[244:247], v[60:63], v[180:183]
    v_exp_f32 v69, v29
    v_cvt_pk_bf16_f32 v53, v66, v67
    v_mfma_f32_16x16x32_bf16 v[184:187], a[248:251], v[60:63], v[184:187]
    v_exp_f32 v70, v30
    v_mfma_f32_16x16x32_bf16 v[188:191], a[252:255], v[60:63], v[188:191]
    v_exp_f32 v71, v31
    v_cvt_pk_bf16_f32 v54, v68, v69
    v_mfma_f32_16x16x32_bf16 v[16:19], a[192:195], a[160:163], v[112:115]
    v_cvt_pk_bf16_f32 v55, v70, v71
    v_exp_f32 v64, v32
    v_mfma_f32_16x16x32_bf16 v[20:23], a[200:203], a[160:163], v[112:115]
    v_exp_f32 v65, v33
    v_mfma_f32_16x16x32_bf16 v[24:27], a[192:195], a[168:171], v[116:119]
    v_exp_f32 v66, v34
    v_mfma_f32_16x16x32_bf16 v[28:31], a[200:203], a[168:171], v[116:119]
    v_exp_f32 v67, v35
    v_cvt_pk_bf16_f32 v56, v64, v65
    v_mfma_f32_16x16x32_bf16 v[16:19], a[196:199], a[164:167], v[16:19]
    v_exp_f32 v68, v36
    v_mfma_f32_16x16x32_bf16 v[20:23], a[204:207], a[164:167], v[20:23]
    v_exp_f32 v69, v37
    v_mfma_f32_16x16x32_bf16 v[24:27], a[196:199], a[172:175], v[24:27]
    v_exp_f32 v70, v38
    v_cvt_pk_bf16_f32 v57, v66, v67
    v_mfma_f32_16x16x32_bf16 v[28:31], a[204:207], a[172:175], v[28:31]
    v_exp_f32 v71, v39
    v_smfmac_f32_16x16x64_bf16 v[72:75], v[80:83], v[48:55], v88
    global_load_dwordx4 a[128:131], v247, s[60:61] offset:0 sc1
    global_load_dwordx4 a[132:135], v247, s[60:61] offset:1024 sc1
    global_load_dwordx4 a[136:139], v247, s[60:61] offset:2048 sc1
    global_load_dwordx4 a[140:143], v247, s[60:61] offset:3072 sc1
    v_cvt_pk_bf16_f32 v58, v68, v69
    v_cvt_pk_bf16_f32 v59, v70, v71
    s_waitcnt vmcnt(16)
    v_mfma_f32_16x16x32_bf16 a[0:3], a[224:227], v[48:51], a[0:3]
    v_exp_f32 v64, v40
    v_mfma_f32_16x16x32_bf16 a[4:7], a[228:231], v[48:51], a[4:7]
    v_exp_f32 v65, v41
    v_mfma_f32_16x16x32_bf16 a[8:11], a[232:235], v[48:51], a[8:11]
    v_exp_f32 v66, v42
    v_mfma_f32_16x16x32_bf16 a[12:15], a[236:239], v[48:51], a[12:15]
    v_exp_f32 v67, v43
    v_cvt_pk_bf16_f32 v60, v64, v65
    v_mfma_f32_16x16x32_bf16 a[16:19], a[224:227], v[52:55], a[16:19]
    v_exp_f32 v68, v44
    v_mfma_f32_16x16x32_bf16 a[20:23], a[228:231], v[52:55], a[20:23]
    v_exp_f32 v69, v45
    v_cvt_pk_bf16_f32 v61, v66, v67
    v_mfma_f32_16x16x32_bf16 a[24:27], a[232:235], v[52:55], a[24:27]
    v_exp_f32 v70, v46
    v_mfma_f32_16x16x32_bf16 a[28:31], a[236:239], v[52:55], a[28:31]
    v_exp_f32 v71, v47
    v_cvt_pk_bf16_f32 v62, v68, v69
    v_mfma_f32_16x16x32_bf16 v[32:35], a[192:195], a[176:179], v[120:123]
    v_cvt_pk_bf16_f32 v63, v70, v71
    v_exp_f32 v64, v16
    v_mfma_f32_16x16x32_bf16 v[36:39], a[200:203], a[176:179], v[120:123]
    v_exp_f32 v65, v17
    v_mfma_f32_16x16x32_bf16 v[40:43], a[192:195], a[184:187], v[124:127]
    ds_write_b128 v192, a[0:3] offset:0
    v_exp_f32 v66, v18
    v_mfma_f32_16x16x32_bf16 v[44:47], a[200:203], a[184:187], v[124:127]
    v_exp_f32 v67, v19
    v_cvt_pk_bf16_f32 v48, v64, v65
    v_mfma_f32_16x16x32_bf16 v[32:35], a[196:199], a[180:183], v[32:35]
    ds_write_b128 v192, a[4:7] offset:1024
    v_exp_f32 v68, v20
    v_mfma_f32_16x16x32_bf16 v[36:39], a[204:207], a[180:183], v[36:39]
    v_exp_f32 v69, v21
    v_mfma_f32_16x16x32_bf16 v[40:43], a[196:199], a[188:191], v[40:43]
    ds_write_b128 v192, a[8:11] offset:2048
    v_exp_f32 v70, v22
    v_cvt_pk_bf16_f32 v49, v66, v67
    v_mfma_f32_16x16x32_bf16 v[44:47], a[204:207], a[188:191], v[44:47]
    v_exp_f32 v71, v23
    v_smfmac_f32_16x16x64_bf16 v[72:75], v[84:87], v[56:63], v88
    ds_write_b128 v192, a[12:15] offset:3072
    v_cvt_pk_bf16_f32 v50, v68, v69
    v_cvt_pk_bf16_f32 v51, v70, v71
    v_mfma_f32_16x16x32_bf16 a[32:35], a[224:227], v[56:59], a[32:35]
    v_add_u32 v247, 0x2000, v247
    global_load_dwordx4 a[144:147], v247, s[60:61] offset:-4096 sc1
    global_load_dwordx4 a[148:151], v247, s[60:61] offset:-3072 sc1
    global_load_dwordx4 a[152:155], v247, s[60:61] offset:-2048 sc1
    global_load_dwordx4 a[156:159], v247, s[60:61] offset:-1024 sc1
    v_exp_f32 v64, v24
    v_mfma_f32_16x16x32_bf16 a[36:39], a[228:231], v[56:59], a[36:39]
    ds_write_b128 v192, a[16:19] offset:4096
    v_exp_f32 v65, v25
    v_mfma_f32_16x16x32_bf16 a[40:43], a[232:235], v[56:59], a[40:43]
    v_exp_f32 v66, v26
    v_mfma_f32_16x16x32_bf16 a[44:47], a[236:239], v[56:59], a[44:47]
    ds_write_b128 v192, a[20:23] offset:5120
    v_exp_f32 v67, v27
    v_cvt_pk_bf16_f32 v52, v64, v65
    v_mfma_f32_16x16x32_bf16 a[48:51], a[224:227], v[60:63], a[48:51]
    global_load_dwordx4 a[240:243], v247, s[60:61] offset:0 sc1
    global_load_dwordx4 a[244:247], v247, s[60:61] offset:1024 sc1
    global_load_dwordx4 a[248:251], v247, s[60:61] offset:2048 sc1
    global_load_dwordx4 a[252:255], v247, s[60:61] offset:3072 sc1
    v_exp_f32 v68, v28
    v_mfma_f32_16x16x32_bf16 a[52:55], a[228:231], v[60:63], a[52:55]
    ds_write_b128 v192, a[24:27] offset:6144
    v_exp_f32 v69, v29
    v_cvt_pk_bf16_f32 v53, v66, v67
    v_mfma_f32_16x16x32_bf16 a[56:59], a[232:235], v[60:63], a[56:59]
    v_exp_f32 v70, v30
    v_mfma_f32_16x16x32_bf16 a[60:63], a[236:239], v[60:63], a[60:63]
    ds_write_b128 v192, a[28:31] offset:7168
    v_exp_f32 v71, v31
    v_cvt_pk_bf16_f32 v54, v68, v69
    v_cvt_pk_bf16_f32 v55, v70, v71
    v_exp_f32 v64, v32
    v_exp_f32 v65, v33
    ds_write_b128 v193, a[32:35] offset:0
    v_exp_f32 v66, v34
    v_exp_f32 v67, v35
    v_cvt_pk_bf16_f32 v56, v64, v65
    ds_write_b128 v193, a[36:39] offset:1024
    v_exp_f32 v68, v36
    v_exp_f32 v69, v37
    ds_write_b128 v193, a[40:43] offset:2048
    v_exp_f32 v70, v38
    v_cvt_pk_bf16_f32 v57, v66, v67
    v_exp_f32 v71, v39
    v_smfmac_f32_16x16x64_bf16 v[76:79], v[80:83], v[48:55], v88
    ds_write_b128 v193, a[44:47] offset:3072
    v_cvt_pk_bf16_f32 v58, v68, v69
    v_cvt_pk_bf16_f32 v59, v70, v71
    v_mfma_f32_16x16x32_bf16 a[64:67], a[224:227], v[48:51], a[64:67]
    v_add_u32 v247, 0x2000, v247
    global_load_dwordx4 a[160:163], v247, s[60:61] offset:-4096 sc1
    global_load_dwordx4 a[164:167], v247, s[60:61] offset:0 sc1
    v_add_u32 v247, 0x2000, v247
    global_load_dwordx4 a[168:171], v247, s[60:61] offset:-4096 sc1
    global_load_dwordx4 a[172:175], v247, s[60:61] offset:0 sc1
    v_exp_f32 v64, v40
    v_mfma_f32_16x16x32_bf16 a[68:71], a[228:231], v[48:51], a[68:71]
    ds_write_b128 v193, a[48:51] offset:4096
    v_exp_f32 v65, v41
    v_mfma_f32_16x16x32_bf16 a[72:75], a[232:235], v[48:51], a[72:75]
    v_exp_f32 v66, v42
    v_mfma_f32_16x16x32_bf16 a[76:79], a[236:239], v[48:51], a[76:79]
    ds_write_b128 v193, a[52:55] offset:5120
    v_exp_f32 v67, v43
    v_cvt_pk_bf16_f32 v60, v64, v65
    v_mfma_f32_16x16x32_bf16 a[80:83], a[224:227], v[52:55], a[80:83]
    v_exp_f32 v68, v44
    v_mfma_f32_16x16x32_bf16 a[84:87], a[228:231], v[52:55], a[84:87]
    ds_write_b128 v193, a[56:59] offset:6144
    v_exp_f32 v69, v45
    v_cvt_pk_bf16_f32 v61, v66, v67
    v_mfma_f32_16x16x32_bf16 a[88:91], a[232:235], v[52:55], a[88:91]
    v_exp_f32 v70, v46
    v_mfma_f32_16x16x32_bf16 a[92:95], a[236:239], v[52:55], a[92:95]
    ds_write_b128 v193, a[60:63] offset:7168
    v_exp_f32 v71, v47
    v_cvt_pk_bf16_f32 v62, v68, v69
    v_cvt_pk_bf16_f32 v63, v70, v71
    s_nop 1
    v_smfmac_f32_16x16x64_bf16 v[76:79], v[84:87], v[56:63], v88
    v_add_u32 v247, 0x2000, v247
    global_load_dwordx4 a[176:179], v247, s[60:61] offset:-4096 sc1
    global_load_dwordx4 a[180:183], v247, s[60:61] offset:0 sc1
    v_add_u32 v247, 0x2000, v247
    global_load_dwordx4 a[184:187], v247, s[60:61] offset:-4096 sc1
    global_load_dwordx4 a[188:191], v247, s[60:61] offset:0 sc1
    v_mfma_f32_16x16x32_bf16 v[160:163], a[224:227], v[56:59], v[160:163]
    v_mfma_f32_16x16x32_bf16 v[164:167], a[228:231], v[56:59], v[164:167]
    v_mfma_f32_16x16x32_bf16 v[168:171], a[232:235], v[56:59], v[168:171]
    ds_write_b128 v194, a[64:67] offset:0
    v_mfma_f32_16x16x32_bf16 v[172:175], a[236:239], v[56:59], v[172:175]
    ds_write_b128 v194, a[68:71] offset:1024
    v_mfma_f32_16x16x32_bf16 v[176:179], a[224:227], v[60:63], v[176:179]
    ds_write_b128 v194, a[72:75] offset:2048
    v_mfma_f32_16x16x32_bf16 v[180:183], a[228:231], v[60:63], v[180:183]
    ds_write_b128 v194, a[76:79] offset:3072
    v_mfma_f32_16x16x32_bf16 v[184:187], a[232:235], v[60:63], v[184:187]
    ds_write_b128 v194, a[80:83] offset:4096
    v_mfma_f32_16x16x32_bf16 v[188:191], a[236:239], v[60:63], v[188:191]
    ds_write_b128 v194, a[84:87] offset:5120
    v_add_f32 v72, v72, v73
    v_add_f32 v76, v76, v77
    ds_write_b32 v13, v72 offset:0
    ds_write_b32 v14, v76 offset:0
    ds_write_b128 v194, a[88:91] offset:6144
    ds_write_b128 v194, a[92:95] offset:7168
    s_waitcnt lgkmcnt(0)
    s_barrier
    ds_read_b128 v[16:19], v7 offset:0
    ds_read_b128 v[20:23], v7 offset:1024
    ds_read_b128 v[24:27], v196 offset:0
    ds_read_b128 v[28:31], v196 offset:256
    ds_read_b128 v[32:35], v195 offset:0
    ds_read_b128 v[36:39], v195 offset:8192
    ds_read_b128 v[40:43], v195 offset:16384
    ds_read_b128 v[44:47], v195 offset:1024
    ds_read_b128 v[48:51], v195 offset:9216
    ds_read_b128 v[52:55], v195 offset:17408
    ds_read_b128 v[56:59], v195 offset:2048
    ds_read_b128 v[60:63], v195 offset:10240
    s_waitcnt lgkmcnt(11)
    v_pk_add_f32 v[16:17], v[16:17], v[18:19]
    s_waitcnt lgkmcnt(10)
    v_pk_add_f32 v[20:21], v[20:21], v[22:23]
    v_pk_add_f32 v[16:17], v[16:17], v[20:21]
    v_add_f32 v16, v16, v17
    v_cmp_nge_f32 vcc, 0x5d800000, v16
    s_waitcnt lgkmcnt(9)
    v_add_f32 v24, v24, v25
    v_add_f32 v26, v26, v27
    s_waitcnt lgkmcnt(8)
    v_add_f32 v28, v28, v29
    v_add_f32 v30, v30, v31
    s_cmp_eq_u32 s36, 0
    s_cselect_b64 s[30:31], vcc, 0
    s_cmp_lg_u64 s[30:31], 0
    s_cbranch_scc1 K2_FB
    v_add_f32 v24, v24, v26
    v_add_f32 v28, v28, v30
    v_rcp_f32 v24, v24
    v_rcp_f32 v28, v28
    v_mul_f32 v24, 0xc038aa3b, v24
    v_mul_f32 v26, 0xc038aa3b, v28
    s_waitcnt lgkmcnt(7)
    v_pk_add_f32 v[160:161], v[160:161], v[32:33]
    v_pk_add_f32 v[162:163], v[162:163], v[34:35]
    ds_read_b128 v[32:35], v195 offset:18432
    s_waitcnt lgkmcnt(7)
    v_pk_add_f32 v[160:161], v[160:161], v[36:37]
    v_pk_add_f32 v[162:163], v[162:163], v[38:39]
    ds_read_b128 v[36:39], v195 offset:3072
    s_waitcnt lgkmcnt(7)
    v_pk_add_f32 v[160:161], v[160:161], v[40:41]
    v_pk_add_f32 v[162:163], v[162:163], v[42:43]
    ds_read_b128 v[40:43], v195 offset:11264
    s_waitcnt lgkmcnt(7)
    v_pk_add_f32 v[164:165], v[164:165], v[44:45]
    v_pk_add_f32 v[166:167], v[166:167], v[46:47]
    ds_read_b128 v[44:47], v195 offset:19456
    s_waitcnt lgkmcnt(7)
    v_pk_add_f32 v[164:165], v[164:165], v[48:49]
    v_pk_add_f32 v[166:167], v[166:167], v[50:51]
    ds_read_b128 v[48:51], v195 offset:4096
    s_waitcnt lgkmcnt(7)
    v_pk_add_f32 v[164:165], v[164:165], v[52:53]
    v_pk_add_f32 v[166:167], v[166:167], v[54:55]
    ds_read_b128 v[52:55], v195 offset:12288
    s_waitcnt lgkmcnt(7)
    v_pk_add_f32 v[168:169], v[168:169], v[56:57]
    v_pk_add_f32 v[170:171], v[170:171], v[58:59]
    ds_read_b128 v[56:59], v195 offset:20480
    s_waitcnt lgkmcnt(7)
    v_pk_add_f32 v[168:169], v[168:169], v[60:61]
    v_pk_add_f32 v[170:171], v[170:171], v[62:63]
    ds_read_b128 v[60:63], v195 offset:5120
    s_waitcnt lgkmcnt(7)
    v_pk_add_f32 v[168:169], v[168:169], v[32:33]
    v_pk_add_f32 v[170:171], v[170:171], v[34:35]
    ds_read_b128 v[32:35], v195 offset:13312
    s_waitcnt lgkmcnt(7)
    v_pk_add_f32 v[172:173], v[172:173], v[36:37]
    v_pk_add_f32 v[174:175], v[174:175], v[38:39]
    ds_read_b128 v[36:39], v195 offset:21504
    s_waitcnt lgkmcnt(7)
    v_pk_add_f32 v[172:173], v[172:173], v[40:41]
    v_pk_add_f32 v[174:175], v[174:175], v[42:43]
    ds_read_b128 v[40:43], v195 offset:6144
    s_waitcnt lgkmcnt(7)
    v_pk_add_f32 v[172:173], v[172:173], v[44:45]
    v_pk_add_f32 v[174:175], v[174:175], v[46:47]
    ds_read_b128 v[44:47], v195 offset:14336
    s_waitcnt lgkmcnt(7)
    v_pk_add_f32 v[176:177], v[176:177], v[48:49]
    v_pk_add_f32 v[178:179], v[178:179], v[50:51]
    ds_read_b128 v[48:51], v195 offset:22528
    s_waitcnt lgkmcnt(7)
    v_pk_add_f32 v[176:177], v[176:177], v[52:53]
    v_pk_add_f32 v[178:179], v[178:179], v[54:55]
    ds_read_b128 v[52:55], v195 offset:7168
    s_waitcnt lgkmcnt(7)
    v_pk_add_f32 v[176:177], v[176:177], v[56:57]
    v_pk_add_f32 v[178:179], v[178:179], v[58:59]
    ds_read_b128 v[56:59], v195 offset:15360
    s_waitcnt lgkmcnt(7)
    v_pk_add_f32 v[180:181], v[180:181], v[60:61]
    v_pk_add_f32 v[182:183], v[182:183], v[62:63]
    ds_read_b128 v[60:63], v195 offset:23552
    v_pk_mul_f32 v[160:161], v[160:161], v[24:25] op_sel_hi:[1,0]
    v_pk_mul_f32 v[164:165], v[164:165], v[24:25] op_sel_hi:[1,0]
    v_pk_mul_f32 v[168:169], v[168:169], v[24:25] op_sel_hi:[1,0]
    v_pk_mul_f32 v[172:173], v[172:173], v[24:25] op_sel_hi:[1,0]
    v_cvt_pk_bf16_f32 v64, v160, v161
    v_cvt_pk_bf16_f32 v65, v164, v165
    v_cvt_pk_bf16_f32 v66, v168, v169
    v_cvt_pk_bf16_f32 v67, v172, v173
    buffer_store_dwordx4 v[64:67], v15, s[20:23], s37 offen offset:0 sc1
    v_pk_mul_f32 v[162:163], v[162:163], v[24:25] op_sel_hi:[1,0]
    v_pk_mul_f32 v[166:167], v[166:167], v[24:25] op_sel_hi:[1,0]
    v_pk_mul_f32 v[170:171], v[170:171], v[24:25] op_sel_hi:[1,0]
    v_pk_mul_f32 v[174:175], v[174:175], v[24:25] op_sel_hi:[1,0]
    v_cvt_pk_bf16_f32 v68, v162, v163
    v_cvt_pk_bf16_f32 v69, v166, v167
    v_cvt_pk_bf16_f32 v70, v170, v171
    v_cvt_pk_bf16_f32 v71, v174, v175
    buffer_store_dwordx4 v[68:71], v15, s[20:23], s37 offen offset:512 sc1
    s_waitcnt lgkmcnt(7)
    v_pk_add_f32 v[180:181], v[180:181], v[32:33]
    v_pk_add_f32 v[182:183], v[182:183], v[34:35]
    s_waitcnt lgkmcnt(6)
    v_pk_add_f32 v[180:181], v[180:181], v[36:37]
    v_pk_add_f32 v[182:183], v[182:183], v[38:39]
    s_waitcnt lgkmcnt(5)
    v_pk_add_f32 v[184:185], v[184:185], v[40:41]
    v_pk_add_f32 v[186:187], v[186:187], v[42:43]
    s_waitcnt lgkmcnt(4)
    v_pk_add_f32 v[184:185], v[184:185], v[44:45]
    v_pk_add_f32 v[186:187], v[186:187], v[46:47]
    s_waitcnt lgkmcnt(3)
    v_pk_add_f32 v[184:185], v[184:185], v[48:49]
    v_pk_add_f32 v[186:187], v[186:187], v[50:51]
    s_waitcnt lgkmcnt(2)
    v_pk_add_f32 v[188:189], v[188:189], v[52:53]
    v_pk_add_f32 v[190:191], v[190:191], v[54:55]
    s_waitcnt lgkmcnt(1)
    v_pk_add_f32 v[188:189], v[188:189], v[56:57]
    v_pk_add_f32 v[190:191], v[190:191], v[58:59]
    s_waitcnt lgkmcnt(0)
    v_pk_add_f32 v[188:189], v[188:189], v[60:61]
    v_pk_add_f32 v[190:191], v[190:191], v[62:63]
    v_pk_mul_f32 v[176:177], v[176:177], v[26:27] op_sel_hi:[1,0]
    v_pk_mul_f32 v[180:181], v[180:181], v[26:27] op_sel_hi:[1,0]
    v_pk_mul_f32 v[184:185], v[184:185], v[26:27] op_sel_hi:[1,0]
    v_pk_mul_f32 v[188:189], v[188:189], v[26:27] op_sel_hi:[1,0]
    v_cvt_pk_bf16_f32 v16, v176, v177
    v_cvt_pk_bf16_f32 v17, v180, v181
    v_cvt_pk_bf16_f32 v18, v184, v185
    v_cvt_pk_bf16_f32 v19, v188, v189
    buffer_store_dwordx4 v[16:19], v15, s[20:23], s38 offen offset:0 sc1
    v_pk_mul_f32 v[178:179], v[178:179], v[26:27] op_sel_hi:[1,0]
    v_pk_mul_f32 v[182:183], v[182:183], v[26:27] op_sel_hi:[1,0]
    v_pk_mul_f32 v[186:187], v[186:187], v[26:27] op_sel_hi:[1,0]
    v_pk_mul_f32 v[190:191], v[190:191], v[26:27] op_sel_hi:[1,0]
    v_cvt_pk_bf16_f32 v20, v178, v179
    v_cvt_pk_bf16_f32 v21, v182, v183
    v_cvt_pk_bf16_f32 v22, v186, v187
    v_cvt_pk_bf16_f32 v23, v190, v191
    buffer_store_dwordx4 v[20:23], v15, s[20:23], s38 offen offset:512 sc1
K3_BEGIN:
    s_cmp_ge_u32 s2, 250
    s_cbranch_scc1 K3_NONE
    s_load_dwordx2 s[6:7], s[0:1], 48
    s_load_dwordx2 s[8:9], s[0:1], 80
    s_and_b32 s10, s2, 7
    s_min_u32 s11, s10, 2
    s_mul_i32 s10, s10, 31
    s_add_u32 s10, s10, s11
    s_lshr_b32 s11, s2, 3
    s_add_u32 s10, s10, s11
    s_cmp_ge_u32 s10, 125
    s_cselect_b32 s11, 125, 0
    s_sub_u32 s11, s10, s11
    s_lshl_b32 s12, s10, 14
    s_cmp_eq_u32 s11, 0
    s_cselect_b32 s13, 0, -4096
    s_cselect_b32 s16, 0, -1
    s_cmp_eq_u32 s11, 124
    s_cselect_b32 s14, 3, 4
    s_cselect_b32 s17, 0, -1
    s_lshl_b32 s14, s14, 12
    v_and_b32 v5, 7, v3
    v_lshlrev_b32 v5, 4, v5
    v_lshl_add_u32 v5, v4, 7, v5
    v_lshl_add_u32 v5, v1, 10, v5
    v_add_u32 v5, s12, v5
    v_lshrrev_b32 v6, 3, v3
    v_lshl_add_u32 v9, v6, 12, v5
    v_add_u32 v10, 8192, v9
    v_mov_b32 v11, s13
    v_mov_b32 v12, s14
    v_cmp_gt_u32 vcc, 8, v3
    s_nop 1
    v_cndmask_b32 v11, v12, v11, vcc
    v_add_u32 v11, v11, v5
    v_lshrrev_b32 v12, 3, v2
    v_and_b32 v13, 7, v2
    v_lshlrev_b32 v13, 4, v13
    v_lshl_add_u32 v13, v1, 7, v13
    v_add_u32 v14, 8, v12
    v_min_u32 v14, 14, v14
    v_lshl_add_u32 v12, v12, 9, v13
    v_lshl_add_u32 v13, v14, 9, v13
    s_lshl_b32 s18, s3, 11
    s_mul_i32 s19, s3, 393216
    s_add_u32 s26, s4, 4194304
    s_addc_u32 s27, s5, 0
    global_load_dwordx4 v[64:67], v9, s[4:5] offset:0 sc1
    global_load_dwordx4 v[68:71], v9, s[4:5] offset:512 sc1
    global_load_dwordx4 v[72:75], v10, s[4:5] offset:0 sc1
    global_load_dwordx4 v[76:79], v10, s[4:5] offset:512 sc1
    global_load_dwordx4 v[80:83], v11, s[4:5] offset:0 sc1
    global_load_dwordx4 v[84:87], v11, s[4:5] offset:512 sc1
    s_add_u32 m0, s18, 141312
    s_waitcnt lgkmcnt(0)
    global_load_lds_dwordx4 v12, s[6:7]
    s_add_u32 m0, m0, 1024
    s_nop 0
    global_load_lds_dwordx4 v13, s[6:7]
    v_mov_b32 v97, v9
    v_mov_b32 v98, v10
    v_mov_b32 v99, v11
    s_lshl_b32 s30, s10, 9
    s_lshl_b32 s31, s3, 7
    s_add_u32 s30, s30, s31
    s_add_u32 s30, s30, 25165824
    s_and_b32 s31, s16, -512
    s_and_b32 s33, s17, 512
    v_mov_b32 v96, s30
    v_writelane_b32 v100, s31, 0
    v_writelane_b32 v100, 0, 1
    v_writelane_b32 v100, s33, 2
    v_add_u32 v96, v96, v100
    v_mov_b32 v100, 1
    v_mov_b32 v101, 1
    v_mov_b32 v102, 1
    v_mov_b32 v103, 1
    v_lshrrev_b32 v12, 2, v3
    v_and_b32 v13, 1, v3
    v_lshlrev_b32 v13, 4, v13
    v_mov_b32 v14, 0x3f80
    v_lshlrev_b32 v13, v13, v14
    v_cmp_eq_u32 vcc, v12, v4
    s_nop 1
    v_cndmask_b32 v13, 0, v13, vcc
    v_and_b32 v12, 2, v3
    v_cmp_eq_u32 vcc, 0, v12
    s_nop 1
    v_cndmask_b32 v90, 0, v13, vcc
    v_cndmask_b32 v91, v13, 0, vcc
    v_mov_b32 v88, 0
    v_mov_b32 v89, 0
    v_mov_b32 v92, 0
    v_mov_b32 v93, 0
    v_cndmask_b32_e64 v5, 0, -1, s[16:17]
    v_lshlrev_b32 v12, 1, v2
    v_add_u32 v12, s18, v12
    v_add_u32 v12, 141312, v12
    v_lshl_add_u32 v14, v1, 2, v7
    v_add_u32 v14, 69632, v14
    v_lshlrev_b32 v15, 4, v3
    v_add_u32 v15, 69632, v15
    v_lshrrev_b32 v6, 2, v3
    v_lshl_add_u32 v6, v4, 3, v6
    v_mul_u32_u24 v6, 80, v6
    v_and_b32 v9, 3, v3
    v_lshl_add_u32 v6, v9, 3, v6
    v_add_u32 v6, 49152, v6
    s_lshl_b32 s19, s3, 14
    s_add_u32 s19, s19, 83968
    v_lshrrev_b32 v10, 2, v3
    v_lshl_add_u32 v9, v10, 3, v9
    v_mul_u32_u24 v9, 112, v9
    v_add_u32 v9, s19, v9
    v_lshl_add_u32 v10, v4, 3, v9
    v_add_u32 v9, 16, v10
    v_mov_b32 v11, 64
    v_cmp_lt_u32 vcc, 31, v2
    s_nop 1
    v_cndmask_b32 v11, 0, v11, vcc
    v_add_u32 v10, v10, v11
    v_add_u32 v11, s18, v7
    v_add_u32 v13, s19, v7
    s_waitcnt vmcnt(8)
    s_mov_b64 exec, 1
    buffer_store_dword v100, v7, s[20:23], s46 offen sc1
    s_mov_b64 exec, -1
    v_add_u32 v247, 0x2000, v247
    global_load_dwordx4 a[0:3], v247, s[60:61] offset:-4096 sc1
    global_load_dwordx4 a[4:7], v247, s[60:61] offset:0 sc1
    v_add_u32 v247, 0x2000, v247
    global_load_dwordx4 a[8:11], v247, s[60:61] offset:-4096 sc1
    global_load_dwordx4 a[12:15], v247, s[60:61] offset:0 sc1
    v_add_u32 v247, 0x2000, v247
    global_load_dwordx4 a[16:19], v247, s[60:61] offset:-4096 sc1
    global_load_dwordx4 a[20:23], v247, s[60:61] offset:0 sc1
    s_mov_b64 exec, 7
    s_mov_b32 s33, 0
K3_POLL:
    global_load_dword v101, v96, s[4:5] sc1
    s_add_u32 s33, s33, 1
    s_waitcnt vmcnt(0)
    v_cmp_eq_u32 vcc, 0, v101
    s_cmp_lt_u32 s33, 0x20000
    s_nop 0
    s_cselect_b64 s[30:31], vcc, 0
    s_cmp_lg_u64 s[30:31], 0
    s_cbranch_scc1 K3_POLL
    s_mov_b64 exec, -1
    s_add_u32 m0, s18, 100352
    s_nop 0
    global_load_lds_dwordx4 v97, s[26:27] offset:0 sc1
    s_add_u32 m0, m0, 512
    s_nop 0
    global_load_lds_dwordx4 v97, s[26:27] offset:512 sc1
    s_add_u32 m0, m0, 7680
    s_nop 0
    global_load_lds_dwordx4 v98, s[26:27] offset:0 sc1
    s_add_u32 m0, m0, 512
    s_nop 0
    global_load_lds_dwordx4 v98, s[26:27] offset:512 sc1
    s_add_u32 m0, m0, 7680
    s_nop 0
    global_load_lds_dwordx4 v99, s[26:27] offset:0 sc1
    s_add_u32 m0, m0, 512
    s_nop 0
    global_load_lds_dwordx4 v99, s[26:27] offset:512 sc1
    v_add_u32 v247, 0x2000, v247
    global_load_dwordx4 a[24:27], v247, s[60:61] offset:-4096 sc1
    global_load_dwordx4 a[28:31], v247, s[60:61] offset:0 sc1
    v_add_u32 v247, 0xffff2000, v247
    global_load_dwordx4 a[32:35], v247, s[60:61] offset:-3072 sc1
    global_load_dwordx4 a[36:39], v247, s[60:61] offset:1024 sc1
    v_add_u32 v247, 0x2000, v247
    global_load_dwordx4 a[40:43], v247, s[60:61] offset:-3072 sc1
    global_load_dwordx4 a[44:47], v247, s[60:61] offset:1024 sc1
    v_add_u32 v247, 0x2000, v247
    global_load_dwordx4 a[48:51], v247, s[60:61] offset:-3072 sc1
    global_load_dwordx4 a[52:55], v247, s[60:61] offset:1024 sc1
    v_mfma_f32_16x16x32_bf16 v[16:19], v[90:93], v[64:67], 0
    v_mfma_f32_16x16x32_bf16 v[20:23], v[88:91], v[64:67], 0
    v_mfma_f32_16x16x32_bf16 v[32:35], v[90:93], v[72:75], 0
    v_mfma_f32_16x16x32_bf16 v[36:39], v[88:91], v[72:75], 0
    v_mfma_f32_16x16x32_bf16 v[48:51], v[90:93], v[80:83], 0
    v_mfma_f32_16x16x32_bf16 v[52:55], v[88:91], v[80:83], 0
    v_mfma_f32_16x16x32_bf16 v[24:27], v[90:93], v[68:71], 0
    v_mfma_f32_16x16x32_bf16 v[28:31], v[88:91], v[68:71], 0
    v_mfma_f32_16x16x32_bf16 v[40:43], v[90:93], v[76:79], 0
    v_mfma_f32_16x16x32_bf16 v[44:47], v[88:91], v[76:79], 0
    v_mfma_f32_16x16x32_bf16 v[56:59], v[90:93], v[84:87], 0
    v_mfma_f32_16x16x32_bf16 v[60:63], v[88:91], v[84:87], 0
    v_add_u32 v240, 100352, v7
    s_waitcnt vmcnt(8)
    v_add_u32 v247, 0x2000, v247
    global_load_dwordx4 a[56:59], v247, s[60:61] offset:-3072 sc1
    global_load_dwordx4 a[60:63], v247, s[60:61] offset:1024 sc1
    s_barrier
    v_add_u32 v247, 0x2000, v247
    global_load_dwordx4 a[64:67], v247, s[60:61] offset:-3072 sc1
    global_load_dwordx4 a[68:71], v247, s[60:61] offset:1024 sc1
    ds_read_b128 v[96:99], v240 offset:0
    ds_read_b128 v[100:103], v240 offset:8192
    ds_read_b128 v[104:107], v240 offset:16384
    ds_read_b128 v[108:111], v240 offset:1024
    ds_read_b128 v[112:115], v240 offset:9216
    ds_read_b128 v[116:119], v240 offset:17408
    s_waitcnt lgkmcnt(5)
    v_mfma_f32_16x16x32_bf16 v[16:19], v[200:203], v[96:99], v[16:19]
    v_add_u32 v247, 0x2000, v247
    global_load_dwordx4 a[72:75], v247, s[60:61] offset:-3072 sc1
    global_load_dwordx4 a[76:79], v247, s[60:61] offset:1024 sc1
    ds_read_b128 v[120:123], v240 offset:2048
    ds_read_b128 v[124:127], v240 offset:10240
    ds_read_b128 v[128:131], v240 offset:18432
    s_waitcnt lgkmcnt(7)
    v_mfma_f32_16x16x32_bf16 v[32:35], v[200:203], v[100:103], v[32:35]
    s_waitcnt lgkmcnt(6)
    v_mfma_f32_16x16x32_bf16 v[48:51], v[200:203], v[104:107], v[48:51]
    v_mfma_f32_16x16x32_bf16 v[20:23], v[204:207], v[96:99], v[20:23]
    v_mfma_f32_16x16x32_bf16 v[36:39], v[204:207], v[100:103], v[36:39]
    v_mfma_f32_16x16x32_bf16 v[52:55], v[204:207], v[104:107], v[52:55]
    v_add_u32 v247, 0x2000, v247
    global_load_dwordx4 a[80:83], v247, s[60:61] offset:-3072 sc1
    global_load_dwordx4 a[84:87], v247, s[60:61] offset:1024 sc1
    v_mfma_f32_16x16x32_bf16 v[24:27], v[208:211], v[96:99], v[24:27]
    v_mfma_f32_16x16x32_bf16 v[40:43], v[208:211], v[100:103], v[40:43]
    v_mfma_f32_16x16x32_bf16 v[56:59], v[208:211], v[104:107], v[56:59]
    v_mfma_f32_16x16x32_bf16 v[28:31], v[212:215], v[96:99], v[28:31]
    v_mfma_f32_16x16x32_bf16 v[44:47], v[212:215], v[100:103], v[44:47]
    v_mfma_f32_16x16x32_bf16 v[60:63], v[212:215], v[104:107], v[60:63]
    s_waitcnt lgkmcnt(5)
    v_mfma_f32_16x16x32_bf16 v[16:19], v[216:219], v[108:111], v[16:19]
    ds_read_b128 v[132:135], v240 offset:3072
    ds_read_b128 v[136:139], v240 offset:11264
    ds_read_b128 v[140:143], v240 offset:19456
    s_waitcnt lgkmcnt(7)
    v_mfma_f32_16x16x32_bf16 v[32:35], v[216:219], v[112:115], v[32:35]
    v_add_u32 v247, 0x2000, v247
    global_load_dwordx4 a[88:91], v247, s[60:61] offset:-3072 sc1
    global_load_dwordx4 a[92:95], v247, s[60:61] offset:1024 sc1
    s_waitcnt lgkmcnt(6)
    v_mfma_f32_16x16x32_bf16 v[48:51], v[216:219], v[116:119], v[48:51]
    v_mfma_f32_16x16x32_bf16 v[20:23], v[220:223], v[108:111], v[20:23]
    v_mfma_f32_16x16x32_bf16 v[36:39], v[220:223], v[112:115], v[36:39]
    v_mfma_f32_16x16x32_bf16 v[52:55], v[220:223], v[116:119], v[52:55]
    v_mfma_f32_16x16x32_bf16 v[24:27], v[224:227], v[108:111], v[24:27]
    v_mfma_f32_16x16x32_bf16 v[40:43], v[224:227], v[112:115], v[40:43]
    v_mfma_f32_16x16x32_bf16 v[56:59], v[224:227], v[116:119], v[56:59]
    v_add_u32 v247, 0xffff2000, v247
    global_load_dwordx4 a[192:195], v247, s[60:61] offset:-2048 sc1
    global_load_dwordx4 a[196:199], v247, s[60:61] offset:2048 sc1
    v_mfma_f32_16x16x32_bf16 v[28:31], v[228:231], v[108:111], v[28:31]
    v_mfma_f32_16x16x32_bf16 v[44:47], v[228:231], v[112:115], v[44:47]
    v_mfma_f32_16x16x32_bf16 v[60:63], v[228:231], v[116:119], v[60:63]
    s_waitcnt lgkmcnt(5)
    v_mfma_f32_16x16x32_bf16 v[16:19], a[96:99], v[120:123], v[16:19]
    ds_read_b128 v[144:147], v240 offset:4096
    ds_read_b128 v[148:151], v240 offset:12288
    ds_read_b128 v[152:155], v240 offset:20480
    s_waitcnt lgkmcnt(7)
    v_mfma_f32_16x16x32_bf16 v[32:35], a[96:99], v[124:127], v[32:35]
    s_waitcnt lgkmcnt(6)
    v_mfma_f32_16x16x32_bf16 v[48:51], a[96:99], v[128:131], v[48:51]
    v_mfma_f32_16x16x32_bf16 v[20:23], a[100:103], v[120:123], v[20:23]
    v_mfma_f32_16x16x32_bf16 v[36:39], a[100:103], v[124:127], v[36:39]
    v_add_u32 v247, 0x2000, v247
    global_load_dwordx4 a[200:203], v247, s[60:61] offset:-2048 sc1
    global_load_dwordx4 a[204:207], v247, s[60:61] offset:2048 sc1
    v_mfma_f32_16x16x32_bf16 v[52:55], a[100:103], v[128:131], v[52:55]
    v_mfma_f32_16x16x32_bf16 v[24:27], a[104:107], v[120:123], v[24:27]
    v_mfma_f32_16x16x32_bf16 v[40:43], a[104:107], v[124:127], v[40:43]
    v_mfma_f32_16x16x32_bf16 v[56:59], a[104:107], v[128:131], v[56:59]
    v_mfma_f32_16x16x32_bf16 v[28:31], a[108:111], v[120:123], v[28:31]
    v_mfma_f32_16x16x32_bf16 v[44:47], a[108:111], v[124:127], v[44:47]
    v_mfma_f32_16x16x32_bf16 v[60:63], a[108:111], v[128:131], v[60:63]
    s_waitcnt lgkmcnt(5)
    v_mfma_f32_16x16x32_bf16 v[16:19], a[112:115], v[132:135], v[16:19]
    v_add_u32 v247, 0x2000, v247
    global_load_dwordx4 a[224:227], v247, s[60:61] offset:-2048 sc1
    global_load_dwordx4 a[228:231], v247, s[60:61] offset:2048 sc1
    ds_read_b128 v[156:159], v240 offset:5120
    ds_read_b128 v[160:163], v240 offset:13312
    ds_read_b128 v[164:167], v240 offset:21504
    s_waitcnt lgkmcnt(7)
    v_mfma_f32_16x16x32_bf16 v[32:35], a[112:115], v[136:139], v[32:35]
    s_waitcnt lgkmcnt(6)
    v_mfma_f32_16x16x32_bf16 v[48:51], a[112:115], v[140:143], v[48:51]
    v_mfma_f32_16x16x32_bf16 v[20:23], a[116:119], v[132:135], v[20:23]
    v_mfma_f32_16x16x32_bf16 v[36:39], a[116:119], v[136:139], v[36:39]
    v_mfma_f32_16x16x32_bf16 v[52:55], a[116:119], v[140:143], v[52:55]
    v_mfma_f32_16x16x32_bf16 v[24:27], a[120:123], v[132:135], v[24:27]
    v_mfma_f32_16x16x32_bf16 v[40:43], a[120:123], v[136:139], v[40:43]
    v_add_u32 v247, 0x2000, v247
    global_load_dwordx4 a[232:235], v247, s[60:61] offset:-2048 sc1
    global_load_dwordx4 a[236:239], v247, s[60:61] offset:2048 sc1
    v_mfma_f32_16x16x32_bf16 v[56:59], a[120:123], v[140:143], v[56:59]
    v_mfma_f32_16x16x32_bf16 v[28:31], a[124:127], v[132:135], v[28:31]
    v_mfma_f32_16x16x32_bf16 v[44:47], a[124:127], v[136:139], v[44:47]
    v_mfma_f32_16x16x32_bf16 v[60:63], a[124:127], v[140:143], v[60:63]
    s_waitcnt lgkmcnt(5)
    v_mfma_f32_16x16x32_bf16 v[16:19], a[208:211], v[144:147], v[16:19]
    ds_read_b128 v[168:171], v240 offset:6144
    ds_read_b128 v[172:175], v240 offset:14336
    ds_read_b128 v[176:179], v240 offset:22528
    s_waitcnt lgkmcnt(7)
    v_mfma_f32_16x16x32_bf16 v[32:35], a[208:211], v[148:151], v[32:35]
    s_waitcnt lgkmcnt(6)
    v_mfma_f32_16x16x32_bf16 v[48:51], a[208:211], v[152:155], v[48:51]
    v_add_u32 v247, 0x2000, v247
    global_load_dwordx4 v[80:83], v247, s[60:61] offset:-2048 sc1
    global_load_dwordx4 v[84:87], v247, s[60:61] offset:2048 sc1
    v_mfma_f32_16x16x32_bf16 v[20:23], a[212:215], v[144:147], v[20:23]
    v_mfma_f32_16x16x32_bf16 v[36:39], a[212:215], v[148:151], v[36:39]
    v_mfma_f32_16x16x32_bf16 v[52:55], a[212:215], v[152:155], v[52:55]
    v_mfma_f32_16x16x32_bf16 v[24:27], a[216:219], v[144:147], v[24:27]
    v_mfma_f32_16x16x32_bf16 v[40:43], a[216:219], v[148:151], v[40:43]
    v_mfma_f32_16x16x32_bf16 v[56:59], a[216:219], v[152:155], v[56:59]
    v_mfma_f32_16x16x32_bf16 v[28:31], a[220:223], v[144:147], v[28:31]
    v_mfma_f32_16x16x32_bf16 v[44:47], a[220:223], v[148:151], v[44:47]
    v_add_u32 v247, 0x2000, v247
    global_load_dwordx4 v[88:91], v247, s[60:61] offset:-2048 sc1
    global_load_dwordx4 v[92:95], v247, s[60:61] offset:2048 sc1
    v_mfma_f32_16x16x32_bf16 v[60:63], a[220:223], v[152:155], v[60:63]
    s_waitcnt lgkmcnt(5)
    v_mfma_f32_16x16x32_bf16 v[16:19], a[128:131], v[156:159], v[16:19]
    ds_read_b128 v[180:183], v240 offset:7168
    ds_read_b128 v[184:187], v240 offset:15360
    ds_read_b128 v[188:191], v240 offset:23552
    s_waitcnt lgkmcnt(7)
    v_mfma_f32_16x16x32_bf16 v[32:35], a[128:131], v[160:163], v[32:35]
    s_waitcnt lgkmcnt(6)
    v_mfma_f32_16x16x32_bf16 v[48:51], a[128:131], v[164:167], v[48:51]
    v_mfma_f32_16x16x32_bf16 v[20:23], a[132:135], v[156:159], v[20:23]
    v_mfma_f32_16x16x32_bf16 v[36:39], a[132:135], v[160:163], v[36:39]
    v_mfma_f32_16x16x32_bf16 v[52:55], a[132:135], v[164:167], v[52:55]
    v_add_u32 v247, 0x2000, v247
    global_load_dwordx4 v[248:251], v247, s[60:61] offset:-2048 sc1
    global_load_dwordx4 v[252:255], v247, s[60:61] offset:2048 sc1
    v_mfma_f32_16x16x32_bf16 v[24:27], a[136:139], v[156:159], v[24:27]
    v_mfma_f32_16x16x32_bf16 v[40:43], a[136:139], v[160:163], v[40:43]
    v_mfma_f32_16x16x32_bf16 v[56:59], a[136:139], v[164:167], v[56:59]
    v_mfma_f32_16x16x32_bf16 v[28:31], a[140:143], v[156:159], v[28:31]
    v_mfma_f32_16x16x32_bf16 v[44:47], a[140:143], v[160:163], v[44:47]
    v_mfma_f32_16x16x32_bf16 v[60:63], a[140:143], v[164:167], v[60:63]
    s_waitcnt lgkmcnt(5)
    v_mfma_f32_16x16x32_bf16 v[16:19], a[144:147], v[168:171], v[16:19]
    s_waitcnt lgkmcnt(4)
    v_mfma_f32_16x16x32_bf16 v[32:35], a[144:147], v[172:175], v[32:35]
    v_add_u32 v247, 0x2000, v247
    global_load_dwordx4 a[96:99], v247, s[60:61] offset:-2048 sc1
    global_load_dwordx4 a[100:103], v247, s[60:61] offset:2048 sc1
    s_waitcnt lgkmcnt(3)
    v_mfma_f32_16x16x32_bf16 v[48:51], a[144:147], v[176:179], v[48:51]
    v_mfma_f32_16x16x32_bf16 v[20:23], a[148:151], v[168:171], v[20:23]
    v_mfma_f32_16x16x32_bf16 v[36:39], a[148:151], v[172:175], v[36:39]
    v_mfma_f32_16x16x32_bf16 v[52:55], a[148:151], v[176:179], v[52:55]
    v_mfma_f32_16x16x32_bf16 v[24:27], a[152:155], v[168:171], v[24:27]
    v_mfma_f32_16x16x32_bf16 v[40:43], a[152:155], v[172:175], v[40:43]
    v_mfma_f32_16x16x32_bf16 v[56:59], a[152:155], v[176:179], v[56:59]
    v_mfma_f32_16x16x32_bf16 v[28:31], a[156:159], v[168:171], v[28:31]
    v_add_u32 v247, 0xffff2000, v247
    global_load_dwordx4 a[104:107], v247, s[60:61] offset:-1024 sc1
    global_load_dwordx4 a[108:111], v247, s[60:61] offset:3072 sc1
    v_mfma_f32_16x16x32_bf16 v[44:47], a[156:159], v[172:175], v[44:47]
    v_mfma_f32_16x16x32_bf16 v[60:63], a[156:159], v[176:179], v[60:63]
    s_waitcnt lgkmcnt(2)
    v_mfma_f32_16x16x32_bf16 v[16:19], a[240:243], v[180:183], v[16:19]
    s_waitcnt lgkmcnt(1)
    v_mfma_f32_16x16x32_bf16 v[32:35], a[240:243], v[184:187], v[32:35]
    s_waitcnt lgkmcnt(0)
    v_mfma_f32_16x16x32_bf16 v[48:51], a[240:243], v[188:191], v[48:51]
    v_mfma_f32_16x16x32_bf16 v[20:23], a[244:247], v[180:183], v[20:23]
    v_mfma_f32_16x16x32_bf16 v[36:39], a[244:247], v[184:187], v[36:39]
    v_mfma_f32_16x16x32_bf16 v[52:55], a[244:247], v[188:191], v[52:55]
    v_add_u32 v247, 0x2000, v247
    global_load_dwordx4 a[112:115], v247, s[60:61] offset:-1024 sc1
    global_load_dwordx4 a[116:119], v247, s[60:61] offset:3072 sc1
    v_mfma_f32_16x16x32_bf16 v[24:27], a[248:251], v[180:183], v[24:27]
    v_mfma_f32_16x16x32_bf16 v[40:43], a[248:251], v[184:187], v[40:43]
    v_mfma_f32_16x16x32_bf16 v[56:59], a[248:251], v[188:191], v[56:59]
    v_mfma_f32_16x16x32_bf16 v[28:31], a[252:255], v[180:183], v[28:31]
    v_mfma_f32_16x16x32_bf16 v[44:47], a[252:255], v[184:187], v[44:47]
    v_mfma_f32_16x16x32_bf16 v[60:63], a[252:255], v[188:191], v[60:63]
    s_mov_b32 s24, 0x3b800000
    s_mov_b32 s25, 0x38ae990f
    v_pk_add_f32 v[192:193], v[16:17], v[18:19]
    v_pk_add_f32 v[196:197], v[32:33], v[34:35]
    v_add_u32 v247, 0x2000, v247
    global_load_dwordx4 a[120:123], v247, s[60:61] offset:-1024 sc1
    global_load_dwordx4 a[124:127], v247, s[60:61] offset:3072 sc1
    v_pk_add_f32 v[200:201], v[48:49], v[50:51]
    v_pk_mul_f32 v[194:195], v[16:17], v[16:17]
    v_pk_mul_f32 v[198:199], v[32:33], v[32:33]
    v_pk_mul_f32 v[202:203], v[48:49], v[48:49]
    v_pk_fma_f32 v[194:195], v[18:19], v[18:19], v[194:195]
    v_pk_fma_f32 v[198:199], v[34:35], v[34:35], v[198:199]
    v_pk_fma_f32 v[202:203], v[50:51], v[50:51], v[202:203]
    v_pk_add_f32 v[192:193], v[192:193], v[20:21]
    v_pk_add_f32 v[196:197], v[196:197], v[36:37]
    v_pk_add_f32 v[200:201], v[200:201], v[52:53]
    v_pk_fma_f32 v[194:195], v[20:21], v[20:21], v[194:195]
    v_pk_fma_f32 v[198:199], v[36:37], v[36:37], v[198:199]
    v_pk_fma_f32 v[202:203], v[52:53], v[52:53], v[202:203]
    v_pk_add_f32 v[192:193], v[192:193], v[22:23]
    v_pk_add_f32 v[196:197], v[196:197], v[38:39]
    v_pk_add_f32 v[200:201], v[200:201], v[54:55]
    v_pk_fma_f32 v[194:195], v[22:23], v[22:23], v[194:195]
    v_pk_fma_f32 v[198:199], v[38:39], v[38:39], v[198:199]
    v_pk_fma_f32 v[202:203], v[54:55], v[54:55], v[202:203]
    v_pk_add_f32 v[192:193], v[192:193], v[24:25]
    v_pk_add_f32 v[196:197], v[196:197], v[40:41]
    v_pk_add_f32 v[200:201], v[200:201], v[56:57]
    v_pk_fma_f32 v[194:195], v[24:25], v[24:25], v[194:195]
    v_pk_fma_f32 v[198:199], v[40:41], v[40:41], v[198:199]
    v_pk_fma_f32 v[202:203], v[56:57], v[56:57], v[202:203]
    v_pk_add_f32 v[192:193], v[192:193], v[26:27]
    v_pk_add_f32 v[196:197], v[196:197], v[42:43]
    v_add_u32 v247, 0x2000, v247
    global_load_dwordx4 a[208:211], v247, s[60:61] offset:-1024 sc1
    global_load_dwordx4 a[212:215], v247, s[60:61] offset:3072 sc1
    v_pk_add_f32 v[200:201], v[200:201], v[58:59]
    v_pk_fma_f32 v[194:195], v[26:27], v[26:27], v[194:195]
    v_pk_fma_f32 v[198:199], v[42:43], v[42:43], v[198:199]
    v_pk_fma_f32 v[202:203], v[58:59], v[58:59], v[202:203]
    v_pk_add_f32 v[192:193], v[192:193], v[28:29]
    v_pk_add_f32 v[196:197], v[196:197], v[44:45]
    v_pk_add_f32 v[200:201], v[200:201], v[60:61]
    v_pk_fma_f32 v[194:195], v[28:29], v[28:29], v[194:195]
    v_pk_fma_f32 v[198:199], v[44:45], v[44:45], v[198:199]
    v_pk_fma_f32 v[202:203], v[60:61], v[60:61], v[202:203]
    v_pk_add_f32 v[192:193], v[192:193], v[30:31]
    v_pk_add_f32 v[196:197], v[196:197], v[46:47]
    v_pk_add_f32 v[200:201], v[200:201], v[62:63]
    v_pk_fma_f32 v[194:195], v[30:31], v[30:31], v[194:195]
    v_pk_fma_f32 v[198:199], v[46:47], v[46:47], v[198:199]
    v_pk_fma_f32 v[202:203], v[62:63], v[62:63], v[202:203]
    v_add_f32 v240, v192, v193
    v_add_f32 v242, v196, v197
    v_add_f32 v244, v200, v201
    v_add_f32 v241, v194, v195
    v_add_f32 v243, v198, v199
    v_add_f32 v245, v202, v203
    v_permlane32_swap_b32 v240, v242
    v_permlane32_swap_b32 v241, v243
    v_permlane32_swap_b32 v244, v245
    v_add_f32 v240, v240, v242
    v_add_f32 v241, v241, v243
    v_add_u32 v247, 0x2000, v247
    global_load_dwordx4 a[216:219], v247, s[60:61] offset:-1024 sc1
    global_load_dwordx4 a[220:223], v247, s[60:61] offset:3072 sc1
    v_add_f32 v244, v244, v245
    v_add_f32 v245, 0, v244
    v_permlane16_swap_b32 v240, v241
    s_nop 0
    v_permlane16_swap_b32 v244, v245
    v_add_f32 v240, v240, v241
    ds_write_b32 v14, v240 offset:0
    v_add_f32 v244, v244, v245
    ds_write_b32 v14, v244 offset:1024
    s_waitcnt lgkmcnt(0)
    s_barrier
    ds_read_b128 v[192:195], v15 offset:0
    ds_read_b128 v[196:199], v15 offset:256
    ds_read_b128 v[200:203], v15 offset:512
    v_add_u32 v247, 0x2000, v247
    global_load_dwordx4 a[128:131], v247, s[60:61] offset:-1024 sc1
    global_load_dwordx4 a[132:135], v247, s[60:61] offset:3072 sc1
    ds_read_b128 v[204:207], v15 offset:768
    ds_read_b128 v[208:211], v15 offset:1024
    ds_read_b128 v[212:215], v15 offset:1536
    s_waitcnt lgkmcnt(5)
    v_pk_add_f32 v[192:193], v[192:193], v[194:195]
    v_add_u32 v247, 0x2000, v247
    global_load_dwordx4 a[136:139], v247, s[60:61] offset:-1024 sc1
    global_load_dwordx4 a[140:143], v247, s[60:61] offset:3072 sc1
    s_waitcnt lgkmcnt(3)
    v_pk_add_f32 v[200:201], v[200:201], v[202:203]
    s_waitcnt lgkmcnt(1)
    v_pk_add_f32 v[208:209], v[208:209], v[210:211]
    v_pk_add_f32 v[196:197], v[196:197], v[198:199]
    v_pk_add_f32 v[204:205], v[204:205], v[206:207]
    s_waitcnt lgkmcnt(0)
    v_pk_add_f32 v[212:213], v[212:213], v[214:215]
    v_add_f32 v192, v192, v193
    v_add_f32 v200, v200, v201
    v_add_f32 v208, v208, v209
    v_add_f32 v196, v196, v197
    v_add_f32 v204, v204, v205
    v_add_f32 v212, v212, v213
    v_mul_f32 v192, s24, v192
    v_mul_f32 v200, s24, v200
    v_mul_f32 v208, s24, v208
    v_mul_f32 v193, v192, v192
    v_mul_f32 v201, v200, v200
    v_mul_f32 v209, v208, v208
    v_fma_f32 v196, v196, s24, -v193
    v_fma_f32 v204, v204, s24, -v201
    v_fma_f32 v212, v212, s24, -v209
    v_max_f32 v196, 0, v196
    v_max_f32 v204, 0, v204
    v_max_f32 v212, 0, v212
    v_add_f32 v196, s25, v196
    v_add_f32 v204, s25, v204
    v_add_u32 v247, 0x2000, v247
    global_load_dwordx4 a[144:147], v247, s[60:61] offset:-1024 sc1
    global_load_dwordx4 a[148:151], v247, s[60:61] offset:3072 sc1
    v_add_f32 v212, s25, v212
    v_rsq_f32 v196, v196
    v_rsq_f32 v204, v204
    v_rsq_f32 v212, v212
    v_mul_f32 v240, 0x3fb8aa3b, v196
    v_mul_f32 v242, 0x3fb8aa3b, v204
    v_mul_f32 v244, 0x3fb8aa3b, v212
    v_mul_f32_e64 v241, -v192, v240
    v_mul_f32_e64 v243, -v200, v242
    v_mul_f32_e64 v245, -v208, v244
    v_pk_fma_f32 v[192:193], v[16:17], v[240:241], v[240:241] op_sel:[0,0,1] op_sel_hi:[1,0,1]
    v_pk_fma_f32 v[194:195], v[18:19], v[240:241], v[240:241] op_sel:[0,0,1] op_sel_hi:[1,0,1]
    v_pk_fma_f32 v[196:197], v[20:21], v[240:241], v[240:241] op_sel:[0,0,1] op_sel_hi:[1,0,1]
    v_pk_fma_f32 v[198:199], v[22:23], v[240:241], v[240:241] op_sel:[0,0,1] op_sel_hi:[1,0,1]
    v_cvt_pk_bf16_f32 v192, v192, v193
    v_cvt_pk_bf16_f32 v193, v194, v195
    v_cvt_pk_bf16_f32 v194, v196, v197
    v_cvt_pk_bf16_f32 v195, v198, v199
    ds_write_b128 v11, v[192:195] offset:24576
    v_pk_fma_f32 v[200:201], v[24:25], v[240:241], v[240:241] op_sel:[0,0,1] op_sel_hi:[1,0,1]
    v_pk_fma_f32 v[202:203], v[26:27], v[240:241], v[240:241] op_sel:[0,0,1] op_sel_hi:[1,0,1]
    v_pk_fma_f32 v[204:205], v[28:29], v[240:241], v[240:241] op_sel:[0,0,1] op_sel_hi:[1,0,1]
    v_pk_fma_f32 v[206:207], v[30:31], v[240:241], v[240:241] op_sel:[0,0,1] op_sel_hi:[1,0,1]
    v_cvt_pk_bf16_f32 v200, v200, v201
    v_add_u32 v247, 0x2000, v247
    global_load_dwordx4 a[152:155], v247, s[60:61] offset:-4096 sc1
    global_load_dwordx4 a[156:159], v247, s[60:61] offset:-3072 sc1
    v_cvt_pk_bf16_f32 v201, v202, v203
    v_cvt_pk_bf16_f32 v202, v204, v205
    v_cvt_pk_bf16_f32 v203, v206, v207
    ds_write_b128 v11, v[200:203] offset:25600
    v_pk_fma_f32 v[208:209], v[32:33], v[242:243], v[242:243] op_sel:[0,0,1] op_sel_hi:[1,0,1]
    v_pk_fma_f32 v[210:211], v[34:35], v[242:243], v[242:243] op_sel:[0,0,1] op_sel_hi:[1,0,1]
    v_pk_fma_f32 v[212:213], v[36:37], v[242:243], v[242:243] op_sel:[0,0,1] op_sel_hi:[1,0,1]
    v_pk_fma_f32 v[214:215], v[38:39], v[242:243], v[242:243] op_sel:[0,0,1] op_sel_hi:[1,0,1]
    v_cvt_pk_bf16_f32 v208, v208, v209
    v_cvt_pk_bf16_f32 v209, v210, v211
    v_cvt_pk_bf16_f32 v210, v212, v213
    v_cvt_pk_bf16_f32 v211, v214, v215
    ds_write_b128 v11, v[208:211] offset:32768
    v_pk_fma_f32 v[216:217], v[40:41], v[242:243], v[242:243] op_sel:[0,0,1] op_sel_hi:[1,0,1]
    v_pk_fma_f32 v[218:219], v[42:43], v[242:243], v[242:243] op_sel:[0,0,1] op_sel_hi:[1,0,1]
    v_pk_fma_f32 v[220:221], v[44:45], v[242:243], v[242:243] op_sel:[0,0,1] op_sel_hi:[1,0,1]
    v_pk_fma_f32 v[222:223], v[46:47], v[242:243], v[242:243] op_sel:[0,0,1] op_sel_hi:[1,0,1]
    v_cvt_pk_bf16_f32 v216, v216, v217
    v_cvt_pk_bf16_f32 v217, v218, v219
    v_cvt_pk_bf16_f32 v218, v220, v221
    v_cvt_pk_bf16_f32 v219, v222, v223
    ds_write_b128 v11, v[216:219] offset:33792
    v_pk_fma_f32 v[224:225], v[48:49], v[244:245], v[244:245] op_sel:[0,0,1] op_sel_hi:[1,0,1]
    v_pk_fma_f32 v[226:227], v[50:51], v[244:245], v[244:245] op_sel:[0,0,1] op_sel_hi:[1,0,1]
    v_pk_fma_f32 v[228:229], v[52:53], v[244:245], v[244:245] op_sel:[0,0,1] op_sel_hi:[1,0,1]
    v_pk_fma_f32 v[230:231], v[54:55], v[244:245], v[244:245] op_sel:[0,0,1] op_sel_hi:[1,0,1]
    v_cvt_pk_bf16_f32 v224, v224, v225
    global_load_dwordx4 a[240:243], v247, s[60:61] offset:-2048 sc1
    global_load_dwordx4 a[244:247], v247, s[60:61] offset:-1024 sc1
    v_cvt_pk_bf16_f32 v225, v226, v227
    v_cvt_pk_bf16_f32 v226, v228, v229
    v_cvt_pk_bf16_f32 v227, v230, v231
    ds_write_b128 v11, v[224:227] offset:40960
    v_pk_fma_f32 v[232:233], v[56:57], v[244:245], v[244:245] op_sel:[0,0,1] op_sel_hi:[1,0,1]
    v_pk_fma_f32 v[234:235], v[58:59], v[244:245], v[244:245] op_sel:[0,0,1] op_sel_hi:[1,0,1]
    v_pk_fma_f32 v[236:237], v[60:61], v[244:245], v[244:245] op_sel:[0,0,1] op_sel_hi:[1,0,1]
    v_pk_fma_f32 v[238:239], v[62:63], v[244:245], v[244:245] op_sel:[0,0,1] op_sel_hi:[1,0,1]
    v_cvt_pk_bf16_f32 v232, v232, v233
    v_cvt_pk_bf16_f32 v233, v234, v235
    v_cvt_pk_bf16_f32 v234, v236, v237
    v_cvt_pk_bf16_f32 v235, v238, v239
    ds_write_b128 v11, v[232:235] offset:41984
    s_waitcnt lgkmcnt(0)
    s_barrier
    global_load_dwordx4 v[48:51], v247, s[60:61] offset:0 sc1
    global_load_dwordx4 v[52:55], v247, s[60:61] offset:1024 sc1
    ds_read_b128 v[96:99], v7 offset:24576
    ds_read_b128 v[100:103], v7 offset:32768
    ds_read_b128 v[104:107], v7 offset:40960
    ds_read_b128 v[108:111], v7 offset:25600
    ds_read_b128 v[112:115], v7 offset:33792
    ds_read_b128 v[116:119], v7 offset:41984
    s_waitcnt lgkmcnt(5)
    v_mfma_f32_16x16x32_bf16 v[192:195], v[96:99], a[160:163], 0
    global_load_dwordx4 v[56:59], v247, s[60:61] offset:2048 sc1
    global_load_dwordx4 v[60:63], v247, s[60:61] offset:3072 sc1
    ds_read_b128 v[120:123], v7 offset:26624
    ds_read_b128 v[124:127], v7 offset:34816
    ds_read_b128 v[128:131], v7 offset:43008
    s_waitcnt lgkmcnt(7)
    v_mfma_f32_16x16x32_bf16 v[196:199], v[100:103], a[160:163], 0
    s_waitcnt lgkmcnt(6)
    v_mfma_f32_16x16x32_bf16 v[200:203], v[104:107], a[160:163], 0
    v_mfma_f32_16x16x32_bf16 v[204:207], v[96:99], a[164:167], 0
    v_mfma_f32_16x16x32_bf16 v[208:211], v[100:103], a[164:167], 0
    v_mfma_f32_16x16x32_bf16 v[212:215], v[104:107], a[164:167], 0
    s_waitcnt lgkmcnt(5)
    v_mfma_f32_16x16x32_bf16 v[192:195], v[108:111], a[168:171], v[192:195]
    v_add_u32 v247, 0x2000, v247
    global_load_dwordx4 a[248:251], v247, s[60:61] offset:-4096 sc1
    global_load_dwordx4 a[252:255], v247, s[60:61] offset:-3072 sc1
    ds_read_b128 v[132:135], v7 offset:27648
    ds_read_b128 v[136:139], v7 offset:35840
    ds_read_b128 v[140:143], v7 offset:44032
    s_waitcnt lgkmcnt(7)
    v_mfma_f32_16x16x32_bf16 v[196:199], v[112:115], a[168:171], v[196:199]
    s_waitcnt lgkmcnt(6)
    v_mfma_f32_16x16x32_bf16 v[200:203], v[116:119], a[168:171], v[200:203]
    v_mfma_f32_16x16x32_bf16 v[204:207], v[108:111], a[172:175], v[204:207]
    v_mfma_f32_16x16x32_bf16 v[208:211], v[112:115], a[172:175], v[208:211]
    v_mfma_f32_16x16x32_bf16 v[212:215], v[116:119], a[172:175], v[212:215]
    s_waitcnt lgkmcnt(5)
    v_mfma_f32_16x16x32_bf16 v[192:195], v[120:123], a[176:179], v[192:195]
    ds_read_b128 v[144:147], v7 offset:28672
    ds_read_u16 v216, v12 offset:0
    ds_read_b128 v[148:151], v7 offset:36864
    ds_read_b128 v[152:155], v7 offset:45056
    ds_read_u16 v217, v12 offset:128
    s_waitcnt lgkmcnt(9)
    v_mfma_f32_16x16x32_bf16 v[196:199], v[124:127], a[176:179], v[196:199]
    global_load_dwordx4 a[160:163], v247, s[60:61] offset:-2048 sc1
    global_load_dwordx4 a[164:167], v247, s[60:61] offset:-1024 sc1
    s_waitcnt lgkmcnt(8)
    v_mfma_f32_16x16x32_bf16 v[200:203], v[128:131], a[176:179], v[200:203]
    ds_read_u16 v218, v12 offset:256
    v_mfma_f32_16x16x32_bf16 v[204:207], v[120:123], a[180:183], v[204:207]
    v_mfma_f32_16x16x32_bf16 v[208:211], v[124:127], a[180:183], v[208:211]
    ds_read_u16 v219, v12 offset:384
    v_mfma_f32_16x16x32_bf16 v[212:215], v[128:131], a[180:183], v[212:215]
    s_waitcnt lgkmcnt(9)
    v_mfma_f32_16x16x32_bf16 v[192:195], v[132:135], a[184:187], v[192:195]
    ds_read_u16 v220, v12 offset:512
    ds_read_b128 v[156:159], v7 offset:29696
    ds_read_b128 v[160:163], v7 offset:37888
    ds_read_u16 v221, v12 offset:640
    ds_read_b128 v[164:167], v7 offset:46080
    s_waitcnt lgkmcnt(13)
    v_mfma_f32_16x16x32_bf16 v[196:199], v[136:139], a[184:187], v[196:199]
    ds_read_u16 v222, v12 offset:768
    s_waitcnt lgkmcnt(13)
    v_mfma_f32_16x16x32_bf16 v[200:203], v[140:143], a[184:187], v[200:203]
    s_waitcnt vmcnt(40)
    global_load_dwordx4 a[168:171], v247, s[60:61] offset:0 sc1
    global_load_dwordx4 a[172:175], v247, s[60:61] offset:1024 sc1
    ds_read_u16 v223, v12 offset:896
    v_mfma_f32_16x16x32_bf16 v[204:207], v[132:135], a[188:191], v[204:207]
    v_mfma_f32_16x16x32_bf16 v[208:211], v[136:139], a[188:191], v[208:211]
    ds_read_u16 v224, v12 offset:1024
    v_mfma_f32_16x16x32_bf16 v[212:215], v[140:143], a[188:191], v[212:215]
    ds_read_u16 v225, v12 offset:1152
    s_waitcnt lgkmcnt(15)
    v_mfma_f32_16x16x32_bf16 v[192:195], v[144:147], a[0:3], v[192:195]
    ds_read_b128 v[168:171], v7 offset:30720
    ds_read_u16 v226, v12 offset:1280
    ds_read_b128 v[172:175], v7 offset:38912
    ds_read_b128 v[176:179], v7 offset:47104
    ds_read_u16 v227, v12 offset:1408
    s_waitcnt lgkmcnt(15)
    v_mfma_f32_16x16x32_bf16 v[196:199], v[148:151], a[0:3], v[196:199]
    v_mfma_f32_16x16x32_bf16 v[200:203], v[152:155], a[0:3], v[200:203]
    ds_read_u16 v228, v12 offset:1536
    v_mfma_f32_16x16x32_bf16 v[204:207], v[144:147], a[4:7], v[204:207]
    global_load_dwordx4 a[176:179], v247, s[60:61] offset:2048 sc1
    global_load_dwordx4 a[180:183], v247, s[60:61] offset:3072 sc1
    v_mfma_f32_16x16x32_bf16 v[208:211], v[148:151], a[4:7], v[208:211]
    ds_read_u16 v229, v12 offset:1664
    v_mfma_f32_16x16x32_bf16 v[212:215], v[152:155], a[4:7], v[212:215]
    ds_read_u16 v230, v12 offset:1792
    s_waitcnt lgkmcnt(15)
    v_mfma_f32_16x16x32_bf16 v[192:195], v[156:159], a[8:11], v[192:195]
    ds_read_b128 v[180:183], v7 offset:31744
    ds_read_b128 v[184:187], v7 offset:39936
    ds_read_b128 v[188:191], v7 offset:48128
    s_waitcnt lgkmcnt(15)
    v_mfma_f32_16x16x32_bf16 v[196:199], v[160:163], a[8:11], v[196:199]
    v_mfma_f32_16x16x32_bf16 v[200:203], v[164:167], a[8:11], v[200:203]
    v_mfma_f32_16x16x32_bf16 v[204:207], v[156:159], a[12:15], v[204:207]
    v_mfma_f32_16x16x32_bf16 v[208:211], v[160:163], a[12:15], v[208:211]
    v_add_u32 v247, 0x2000, v247
    global_load_dwordx4 a[184:187], v247, s[60:61] offset:-4096 sc1
    global_load_dwordx4 a[188:191], v247, s[60:61] offset:-3072 sc1
    v_mfma_f32_16x16x32_bf16 v[212:215], v[164:167], a[12:15], v[212:215]
    s_waitcnt lgkmcnt(10)
    v_mfma_f32_16x16x32_bf16 v[192:195], v[168:171], a[16:19], v[192:195]
    v_lshlrev_b32 v72, 16, v216
    s_waitcnt lgkmcnt(8)
    v_mfma_f32_16x16x32_bf16 v[196:199], v[172:175], a[16:19], v[196:199]
    v_lshl_or_b32 v64, v217, 16, v216
    s_waitcnt lgkmcnt(7)
    v_mfma_f32_16x16x32_bf16 v[200:203], v[176:179], a[16:19], v[200:203]
    v_lshl_or_b32 v73, v218, 16, v217
    v_lshl_or_b32 v65, v219, 16, v218
    v_mfma_f32_16x16x32_bf16 v[204:207], v[168:171], a[20:23], v[204:207]
    v_lshl_or_b32 v74, v220, 16, v219
    v_mfma_f32_16x16x32_bf16 v[208:211], v[172:175], a[20:23], v[208:211]
    v_lshl_or_b32 v66, v221, 16, v220
    v_lshl_or_b32 v75, v222, 16, v221
    v_mfma_f32_16x16x32_bf16 v[212:215], v[176:179], a[20:23], v[212:215]
    v_lshl_or_b32 v67, v223, 16, v222
    s_waitcnt lgkmcnt(2)
    v_mfma_f32_16x16x32_bf16 v[192:195], v[180:183], a[24:27], v[192:195]
    global_load_dwordx4 a[0:3], v247, s[60:61] offset:-2048 sc1
    global_load_dwordx4 a[4:7], v247, s[60:61] offset:-1024 sc1
    v_lshl_or_b32 v76, v224, 16, v223
    v_lshl_or_b32 v68, v225, 16, v224
    s_waitcnt lgkmcnt(1)
    v_mfma_f32_16x16x32_bf16 v[196:199], v[184:187], a[24:27], v[196:199]
    v_lshl_or_b32 v77, v226, 16, v225
    s_waitcnt lgkmcnt(0)
    v_mfma_f32_16x16x32_bf16 v[200:203], v[188:191], a[24:27], v[200:203]
    v_lshl_or_b32 v69, v227, 16, v226
    v_lshl_or_b32 v78, v228, 16, v227
    v_mfma_f32_16x16x32_bf16 v[204:207], v[180:183], a[28:31], v[204:207]
    v_lshl_or_b32 v70, v229, 16, v228
    v_mfma_f32_16x16x32_bf16 v[208:211], v[184:187], a[28:31], v[208:211]
    v_lshl_or_b32 v79, v230, 16, v229
    v_mov_b32 v71, v230
    v_mfma_f32_16x16x32_bf16 v[212:215], v[188:191], a[28:31], v[212:215]
    v_mfma_f32_16x16x32_bf16 v[216:219], v[96:99], a[32:35], 0
    v_mfma_f32_16x16x32_bf16 v[220:223], v[100:103], a[32:35], 0
    v_mfma_f32_16x16x32_bf16 v[224:227], v[104:107], a[32:35], 0
    global_load_dwordx4 a[8:11], v247, s[60:61] offset:0 sc1
    global_load_dwordx4 a[12:15], v247, s[60:61] offset:1024 sc1
    v_exp_f32 v204, v204
    v_mfma_f32_16x16x32_bf16 v[228:231], v[96:99], a[36:39], 0
    v_exp_f32 v205, v205
    v_mfma_f32_16x16x32_bf16 v[232:235], v[100:103], a[36:39], 0
    v_add_f32 v204, 1.0, v204
    v_mfma_f32_16x16x32_bf16 v[236:239], v[104:107], a[36:39], 0
    v_exp_f32 v206, v206
    v_mfma_f32_16x16x32_bf16 v[216:219], v[108:111], a[40:43], v[216:219]
    v_add_f32 v205, 1.0, v205
    v_rcp_f32 v204, v204
    v_mfma_f32_16x16x32_bf16 v[220:223], v[112:115], a[40:43], v[220:223]
    v_exp_f32 v207, v207
    v_mfma_f32_16x16x32_bf16 v[224:227], v[116:119], a[40:43], v[224:227]
    v_add_f32 v206, 1.0, v206
    v_mfma_f32_16x16x32_bf16 v[228:231], v[108:111], a[44:47], v[228:231]
    global_load_dwordx4 a[16:19], v247, s[60:61] offset:2048 sc1
    global_load_dwordx4 a[20:23], v247, s[60:61] offset:3072 sc1
    v_rcp_f32 v205, v205
    v_mfma_f32_16x16x32_bf16 v[232:235], v[112:115], a[44:47], v[232:235]
    v_mul_f32 v192, v192, v204
    v_mfma_f32_16x16x32_bf16 v[236:239], v[116:119], a[44:47], v[236:239]
    v_exp_f32 v208, v208
    v_add_f32 v207, 1.0, v207
    v_rcp_f32 v206, v206
    v_mfma_f32_16x16x32_bf16 v[216:219], v[120:123], a[48:51], v[216:219]
    v_mul_f32 v193, v193, v205
    v_mfma_f32_16x16x32_bf16 v[220:223], v[124:127], a[48:51], v[220:223]
    v_exp_f32 v209, v209
    v_mfma_f32_16x16x32_bf16 v[224:227], v[128:131], a[48:51], v[224:227]
    v_add_f32 v208, 1.0, v208
    v_mfma_f32_16x16x32_bf16 v[228:231], v[120:123], a[52:55], v[228:231]
    v_add_u32 v247, 0x2000, v247
    global_load_dwordx4 a[24:27], v247, s[60:61] offset:-4096 sc1
    v_add_u32 v247, 0x2000, v247
    global_load_dwordx4 a[28:31], v247, s[60:61] offset:-4096 sc1
    v_rcp_f32 v207, v207
    v_mul_f32 v194, v194, v206
    v_mfma_f32_16x16x32_bf16 v[232:235], v[124:127], a[52:55], v[232:235]
    v_exp_f32 v210, v210
    v_mfma_f32_16x16x32_bf16 v[236:239], v[128:131], a[52:55], v[236:239]
    v_add_f32 v209, 1.0, v209
    v_mfma_f32_16x16x32_bf16 v[216:219], v[132:135], a[56:59], v[216:219]
    v_rcp_f32 v208, v208
    v_mfma_f32_16x16x32_bf16 v[220:223], v[136:139], a[56:59], v[220:223]
    v_mul_f32 v195, v195, v207
    v_mfma_f32_16x16x32_bf16 v[224:227], v[140:143], a[56:59], v[224:227]
    v_cvt_pk_bf16_f32 v192, v192, v193
    v_cvt_pk_bf16_f32 v193, v194, v195
    v_mfma_f32_16x16x32_bf16 v[228:231], v[132:135], a[60:63], v[228:231]
    ds_write_b64 v9, v[192:193] offset:0
    v_mfma_f32_16x16x32_bf16 v[232:235], v[136:139], a[60:63], v[232:235]
    global_load_dwordx4 a[32:35], v247, s[60:61] offset:-3072 sc1
    global_load_dwordx4 a[36:39], v247, s[60:61] offset:-2048 sc1
    v_exp_f32 v211, v211
    v_mfma_f32_16x16x32_bf16 v[236:239], v[140:143], a[60:63], v[236:239]
    v_add_f32 v210, 1.0, v210
    v_rcp_f32 v209, v209
    v_mfma_f32_16x16x32_bf16 v[216:219], v[144:147], a[64:67], v[216:219]
    v_mul_f32 v196, v196, v208
    v_exp_f32 v212, v212
    v_mfma_f32_16x16x32_bf16 v[220:223], v[148:151], a[64:67], v[220:223]
    v_add_f32 v211, 1.0, v211
    v_mfma_f32_16x16x32_bf16 v[224:227], v[152:155], a[64:67], v[224:227]
    v_rcp_f32 v210, v210
    v_mfma_f32_16x16x32_bf16 v[228:231], v[144:147], a[68:71], v[228:231]
    v_mul_f32 v197, v197, v209
    v_mfma_f32_16x16x32_bf16 v[232:235], v[148:151], a[68:71], v[232:235]
    v_exp_f32 v213, v213
    v_mfma_f32_16x16x32_bf16 v[236:239], v[152:155], a[68:71], v[236:239]
    global_load_dwordx4 a[40:43], v247, s[60:61] offset:-1024 sc1
    global_load_dwordx4 a[44:47], v247, s[60:61] offset:0 sc1
    v_add_f32 v212, 1.0, v212
    v_rcp_f32 v211, v211
    v_mfma_f32_16x16x32_bf16 v[216:219], v[156:159], a[72:75], v[216:219]
    v_mul_f32 v198, v198, v210
    v_mfma_f32_16x16x32_bf16 v[220:223], v[160:163], a[72:75], v[220:223]
    v_exp_f32 v214, v214
    v_mfma_f32_16x16x32_bf16 v[224:227], v[164:167], a[72:75], v[224:227]
    v_add_f32 v213, 1.0, v213
    v_mfma_f32_16x16x32_bf16 v[228:231], v[156:159], a[76:79], v[228:231]
    v_rcp_f32 v212, v212
    v_mfma_f32_16x16x32_bf16 v[232:235], v[160:163], a[76:79], v[232:235]
    v_mul_f32 v199, v199, v211
    v_cvt_pk_bf16_f32 v196, v196, v197
    v_mfma_f32_16x16x32_bf16 v[236:239], v[164:167], a[76:79], v[236:239]
    v_cvt_pk_bf16_f32 v197, v198, v199
    ds_write_b64 v9, v[196:197] offset:32
    v_mfma_f32_16x16x32_bf16 v[216:219], v[168:171], a[80:83], v[216:219]
    global_load_dwordx4 a[48:51], v247, s[60:61] offset:1024 sc1
    global_load_dwordx4 a[52:55], v247, s[60:61] offset:2048 sc1
    v_exp_f32 v215, v215
    v_mfma_f32_16x16x32_bf16 v[220:223], v[172:175], a[80:83], v[220:223]
    v_add_f32 v214, 1.0, v214
    v_mfma_f32_16x16x32_bf16 v[224:227], v[176:179], a[80:83], v[224:227]
    v_rcp_f32 v213, v213
    v_mul_f32 v200, v200, v212
    v_mfma_f32_16x16x32_bf16 v[228:231], v[168:171], a[84:87], v[228:231]
    v_add_f32 v215, 1.0, v215
    v_mfma_f32_16x16x32_bf16 v[232:235], v[172:175], a[84:87], v[232:235]
    v_rcp_f32 v214, v214
    v_mfma_f32_16x16x32_bf16 v[236:239], v[176:179], a[84:87], v[236:239]
    v_mul_f32 v201, v201, v213
    v_mfma_f32_16x16x32_bf16 v[216:219], v[180:183], a[88:91], v[216:219]
    v_rcp_f32 v215, v215
    v_mfma_f32_16x16x32_bf16 v[220:223], v[184:187], a[88:91], v[220:223]
    global_load_dwordx4 a[56:59], v247, s[60:61] offset:3072 sc1
    v_add_u32 v247, 0x2000, v247
    global_load_dwordx4 a[60:63], v247, s[60:61] offset:-4096 sc1
    v_mul_f32 v202, v202, v214
    v_mul_f32 v203, v203, v215
    v_mfma_f32_16x16x32_bf16 v[224:227], v[188:191], a[88:91], v[224:227]
    v_cvt_pk_bf16_f32 v200, v200, v201
    v_mfma_f32_16x16x32_bf16 v[228:231], v[180:183], a[92:95], v[228:231]
    v_cvt_pk_bf16_f32 v201, v202, v203
    v_mfma_f32_16x16x32_bf16 v[232:235], v[184:187], a[92:95], v[232:235]
    v_and_b32 v200, v5, v200
    v_mfma_f32_16x16x32_bf16 v[236:239], v[188:191], a[92:95], v[236:239]
    v_and_b32 v201, v5, v201
    ds_write_b64 v10, v[200:201] offset:0
    v_mfma_f32_16x16x32_bf16 v[192:195], v[96:99], a[192:195], 0
    v_mfma_f32_16x16x32_bf16 v[196:199], v[100:103], a[192:195], 0
    v_mfma_f32_16x16x32_bf16 v[200:203], v[104:107], a[192:195], 0
    s_waitcnt vmcnt(40)
    global_load_dwordx4 a[64:67], v247, s[60:61] offset:-3072 sc1
    global_load_dwordx4 a[68:71], v247, s[60:61] offset:-2048 sc1
    v_exp_f32 v228, v228
    v_mfma_f32_16x16x32_bf16 v[204:207], v[96:99], a[196:199], 0
    v_exp_f32 v229, v229
    v_mfma_f32_16x16x32_bf16 v[208:211], v[100:103], a[196:199], 0
    v_add_f32 v228, 1.0, v228
    v_mfma_f32_16x16x32_bf16 v[212:215], v[104:107], a[196:199], 0
    v_exp_f32 v230, v230
    v_mfma_f32_16x16x32_bf16 v[192:195], v[108:111], a[200:203], v[192:195]
    v_add_f32 v229, 1.0, v229
    v_rcp_f32 v228, v228
    v_mfma_f32_16x16x32_bf16 v[196:199], v[112:115], a[200:203], v[196:199]
    v_exp_f32 v231, v231
    v_mfma_f32_16x16x32_bf16 v[200:203], v[116:119], a[200:203], v[200:203]
    v_add_f32 v230, 1.0, v230
    v_mfma_f32_16x16x32_bf16 v[204:207], v[108:111], a[204:207], v[204:207]
    global_load_dwordx4 a[72:75], v247, s[60:61] offset:-1024 sc1
    global_load_dwordx4 a[76:79], v247, s[60:61] offset:0 sc1
    v_rcp_f32 v229, v229
    v_mfma_f32_16x16x32_bf16 v[208:211], v[112:115], a[204:207], v[208:211]
    v_mul_f32 v216, v216, v228
    v_mfma_f32_16x16x32_bf16 v[212:215], v[116:119], a[204:207], v[212:215]
    v_exp_f32 v232, v232
    v_add_f32 v231, 1.0, v231
    v_rcp_f32 v230, v230
    v_mfma_f32_16x16x32_bf16 v[192:195], v[120:123], a[224:227], v[192:195]
    v_mul_f32 v217, v217, v229
    v_mfma_f32_16x16x32_bf16 v[196:199], v[124:127], a[224:227], v[196:199]
    v_exp_f32 v233, v233
    v_mfma_f32_16x16x32_bf16 v[200:203], v[128:131], a[224:227], v[200:203]
    v_add_f32 v232, 1.0, v232
    v_mfma_f32_16x16x32_bf16 v[204:207], v[120:123], a[228:231], v[204:207]
    v_rcp_f32 v231, v231
    v_mul_f32 v218, v218, v230
    v_mfma_f32_16x16x32_bf16 v[208:211], v[124:127], a[228:231], v[208:211]
    global_load_dwordx4 a[80:83], v247, s[60:61] offset:1024 sc1
    global_load_dwordx4 a[84:87], v247, s[60:61] offset:2048 sc1
    v_exp_f32 v234, v234
    v_mfma_f32_16x16x32_bf16 v[212:215], v[128:131], a[228:231], v[212:215]
    v_add_f32 v233, 1.0, v233
    v_mfma_f32_16x16x32_bf16 v[192:195], v[132:135], a[232:235], v[192:195]
    v_rcp_f32 v232, v232
    v_mfma_f32_16x16x32_bf16 v[196:199], v[136:139], a[232:235], v[196:199]
    v_mul_f32 v219, v219, v231
    v_mfma_f32_16x16x32_bf16 v[200:203], v[140:143], a[232:235], v[200:203]
    v_cvt_pk_bf16_f32 v216, v216, v217
    v_cvt_pk_bf16_f32 v217, v218, v219
    v_mfma_f32_16x16x32_bf16 v[204:207], v[132:135], a[236:239], v[204:207]
    ds_write_b64 v9, v[216:217] offset:448
    v_mfma_f32_16x16x32_bf16 v[208:211], v[136:139], a[236:239], v[208:211]
    v_exp_f32 v235, v235
    v_mfma_f32_16x16x32_bf16 v[212:215], v[140:143], a[236:239], v[212:215]
    global_load_dwordx4 a[88:91], v247, s[60:61] offset:3072 sc1
    v_add_u32 v247, 0x2000, v247
    global_load_dwordx4 a[92:95], v247, s[60:61] offset:-4096 sc1
    v_add_f32 v234, 1.0, v234
    v_rcp_f32 v233, v233
    v_mfma_f32_16x16x32_bf16 v[192:195], v[144:147], v[80:83], v[192:195]
    v_mul_f32 v220, v220, v232
    v_exp_f32 v236, v236
    v_mfma_f32_16x16x32_bf16 v[196:199], v[148:151], v[80:83], v[196:199]
    v_add_f32 v235, 1.0, v235
    v_mfma_f32_16x16x32_bf16 v[200:203], v[152:155], v[80:83], v[200:203]
    v_rcp_f32 v234, v234
    v_mfma_f32_16x16x32_bf16 v[204:207], v[144:147], v[84:87], v[204:207]
    v_mul_f32 v221, v221, v233
    v_mfma_f32_16x16x32_bf16 v[208:211], v[148:151], v[84:87], v[208:211]
    v_exp_f32 v237, v237
    v_mfma_f32_16x16x32_bf16 v[212:215], v[152:155], v[84:87], v[212:215]
    v_add_f32 v236, 1.0, v236
    v_rcp_f32 v235, v235
    v_mfma_f32_16x16x32_bf16 v[192:195], v[156:159], v[88:91], v[192:195]
    global_load_dwordx4 a[192:195], v247, s[60:61] offset:-3072 sc1
    global_load_dwordx4 a[196:199], v247, s[60:61] offset:-2048 sc1
    v_mul_f32 v222, v222, v234
    v_mfma_f32_16x16x32_bf16 v[196:199], v[160:163], v[88:91], v[196:199]
    v_exp_f32 v238, v238
    v_mfma_f32_16x16x32_bf16 v[200:203], v[164:167], v[88:91], v[200:203]
    v_add_f32 v237, 1.0, v237
    v_mfma_f32_16x16x32_bf16 v[204:207], v[156:159], v[92:95], v[204:207]
    v_rcp_f32 v236, v236
    v_mfma_f32_16x16x32_bf16 v[208:211], v[160:163], v[92:95], v[208:211]
    v_mul_f32 v223, v223, v235
    v_cvt_pk_bf16_f32 v220, v220, v221
    v_mfma_f32_16x16x32_bf16 v[212:215], v[164:167], v[92:95], v[212:215]
    v_cvt_pk_bf16_f32 v221, v222, v223
    ds_write_b64 v9, v[220:221] offset:480
    v_mfma_f32_16x16x32_bf16 v[192:195], v[168:171], v[248:251], v[192:195]
    v_exp_f32 v239, v239
    v_mfma_f32_16x16x32_bf16 v[196:199], v[172:175], v[248:251], v[196:199]
    global_load_dwordx4 a[200:203], v247, s[60:61] offset:-1024 sc1
    v_add_u32 v247, 0x4000, v247
    global_load_dwordx4 a[204:207], v247, s[60:61] offset:-4096 sc1
    v_add_f32 v238, 1.0, v238
    v_mfma_f32_16x16x32_bf16 v[200:203], v[176:179], v[248:251], v[200:203]
    v_rcp_f32 v237, v237
    v_mul_f32 v224, v224, v236
    v_mfma_f32_16x16x32_bf16 v[204:207], v[168:171], v[252:255], v[204:207]
    v_add_f32 v239, 1.0, v239
    v_mfma_f32_16x16x32_bf16 v[208:211], v[172:175], v[252:255], v[208:211]
    v_rcp_f32 v238, v238
    v_mfma_f32_16x16x32_bf16 v[212:215], v[176:179], v[252:255], v[212:215]
    v_mul_f32 v225, v225, v237
    v_mfma_f32_16x16x32_bf16 v[192:195], v[180:183], a[96:99], v[192:195]
    v_rcp_f32 v239, v239
    v_mfma_f32_16x16x32_bf16 v[196:199], v[184:187], a[96:99], v[196:199]
    v_mul_f32 v226, v226, v238
    v_mul_f32 v227, v227, v239
    v_mfma_f32_16x16x32_bf16 v[200:203], v[188:191], a[96:99], v[200:203]
    global_load_dwordx4 a[224:227], v247, s[60:61] offset:-3072 sc1
    global_load_dwordx4 a[228:231], v247, s[60:61] offset:-2048 sc1
    v_cvt_pk_bf16_f32 v224, v224, v225
    v_mfma_f32_16x16x32_bf16 v[204:207], v[180:183], a[100:103], v[204:207]
    v_cvt_pk_bf16_f32 v225, v226, v227
    v_mfma_f32_16x16x32_bf16 v[208:211], v[184:187], a[100:103], v[208:211]
    v_and_b32 v224, v5, v224
    v_mfma_f32_16x16x32_bf16 v[212:215], v[188:191], a[100:103], v[212:215]
    v_and_b32 v225, v5, v225
    ds_write_b64 v10, v[224:225] offset:448
    v_mfma_f32_16x16x32_bf16 v[216:219], v[96:99], a[104:107], 0
    v_mfma_f32_16x16x32_bf16 v[220:223], v[100:103], a[104:107], 0
    v_mfma_f32_16x16x32_bf16 v[224:227], v[104:107], a[104:107], 0
    v_exp_f32 v204, v204
    v_mfma_f32_16x16x32_bf16 v[228:231], v[96:99], a[108:111], 0
    v_exp_f32 v205, v205
    v_mfma_f32_16x16x32_bf16 v[232:235], v[100:103], a[108:111], 0
    global_load_dwordx4 a[232:235], v247, s[60:61] offset:-1024 sc1
    global_load_dwordx4 a[236:239], v247, s[60:61] offset:0 sc1
    v_add_f32 v204, 1.0, v204
    v_mfma_f32_16x16x32_bf16 v[236:239], v[104:107], a[108:111], 0
    v_exp_f32 v206, v206
    v_mfma_f32_16x16x32_bf16 v[216:219], v[108:111], a[112:115], v[216:219]
    v_add_f32 v205, 1.0, v205
    v_rcp_f32 v204, v204
    v_mfma_f32_16x16x32_bf16 v[220:223], v[112:115], a[112:115], v[220:223]
    v_exp_f32 v207, v207
    v_mfma_f32_16x16x32_bf16 v[224:227], v[116:119], a[112:115], v[224:227]
    v_add_f32 v206, 1.0, v206
    v_mfma_f32_16x16x32_bf16 v[228:231], v[108:111], a[116:119], v[228:231]
    v_rcp_f32 v205, v205
    v_mfma_f32_16x16x32_bf16 v[232:235], v[112:115], a[116:119], v[232:235]
    v_mul_f32 v192, v192, v204
    v_mfma_f32_16x16x32_bf16 v[236:239], v[116:119], a[116:119], v[236:239]
    global_load_dwordx4 v[80:83], v247, s[60:61] offset:1024 sc1
    global_load_dwordx4 v[84:87], v247, s[60:61] offset:2048 sc1
    v_exp_f32 v208, v208
    v_add_f32 v207, 1.0, v207
    v_rcp_f32 v206, v206
    v_mfma_f32_16x16x32_bf16 v[216:219], v[120:123], a[120:123], v[216:219]
    v_mul_f32 v193, v193, v205
    v_mfma_f32_16x16x32_bf16 v[220:223], v[124:127], a[120:123], v[220:223]
    v_exp_f32 v209, v209
    v_mfma_f32_16x16x32_bf16 v[224:227], v[128:131], a[120:123], v[224:227]
    v_add_f32 v208, 1.0, v208
    v_mfma_f32_16x16x32_bf16 v[228:231], v[120:123], a[124:127], v[228:231]
    v_rcp_f32 v207, v207
    v_mul_f32 v194, v194, v206
    v_mfma_f32_16x16x32_bf16 v[232:235], v[124:127], a[124:127], v[232:235]
    v_exp_f32 v210, v210
    v_mfma_f32_16x16x32_bf16 v[236:239], v[128:131], a[124:127], v[236:239]
    global_load_dwordx4 v[88:91], v247, s[60:61] offset:3072 sc1
    v_add_u32 v247, 0x2000, v247
    global_load_dwordx4 v[92:95], v247, s[60:61] offset:-4096 sc1
    v_add_f32 v209, 1.0, v209
    v_mfma_f32_16x16x32_bf16 v[216:219], v[132:135], a[208:211], v[216:219]
    v_rcp_f32 v208, v208
    v_mfma_f32_16x16x32_bf16 v[220:223], v[136:139], a[208:211], v[220:223]
    v_mul_f32 v195, v195, v207
    v_mfma_f32_16x16x32_bf16 v[224:227], v[140:143], a[208:211], v[224:227]
    v_cvt_pk_bf16_f32 v192, v192, v193
    v_cvt_pk_bf16_f32 v193, v194, v195
    v_mfma_f32_16x16x32_bf16 v[228:231], v[132:135], a[212:215], v[228:231]
    ds_write_b64 v9, v[192:193] offset:3584
    v_mfma_f32_16x16x32_bf16 v[232:235], v[136:139], a[212:215], v[232:235]
    v_exp_f32 v211, v211
    v_mfma_f32_16x16x32_bf16 v[236:239], v[140:143], a[212:215], v[236:239]
    v_add_f32 v210, 1.0, v210
    s_waitcnt vmcnt(58)
    v_rcp_f32 v209, v209
    v_mfma_f32_16x16x32_bf16 v[216:219], v[144:147], a[216:219], v[216:219]
    global_load_dwordx4 v[248:251], v247, s[60:61] offset:-3072 sc1
    global_load_dwordx4 v[252:255], v247, s[60:61] offset:-2048 sc1
    v_mul_f32 v196, v196, v208
    v_exp_f32 v212, v212
    v_mfma_f32_16x16x32_bf16 v[220:223], v[148:151], a[216:219], v[220:223]
    v_add_f32 v211, 1.0, v211
    v_mfma_f32_16x16x32_bf16 v[224:227], v[152:155], a[216:219], v[224:227]
    v_rcp_f32 v210, v210
    v_mfma_f32_16x16x32_bf16 v[228:231], v[144:147], a[220:223], v[228:231]
    v_mul_f32 v197, v197, v209
    v_mfma_f32_16x16x32_bf16 v[232:235], v[148:151], a[220:223], v[232:235]
    v_exp_f32 v213, v213
    v_mfma_f32_16x16x32_bf16 v[236:239], v[152:155], a[220:223], v[236:239]
    v_add_f32 v212, 1.0, v212
    v_rcp_f32 v211, v211
    v_mfma_f32_16x16x32_bf16 v[216:219], v[156:159], a[128:131], v[216:219]
    v_mul_f32 v198, v198, v210
    v_mfma_f32_16x16x32_bf16 v[220:223], v[160:163], a[128:131], v[220:223]
    global_load_dwordx4 a[96:99], v247, s[60:61] offset:-1024 sc1
    global_load_dwordx4 a[100:103], v247, s[60:61] offset:0 sc1
    v_exp_f32 v214, v214
    v_mfma_f32_16x16x32_bf16 v[224:227], v[164:167], a[128:131], v[224:227]
    v_add_f32 v213, 1.0, v213
    v_mfma_f32_16x16x32_bf16 v[228:231], v[156:159], a[132:135], v[228:231]
    v_rcp_f32 v212, v212
    v_mfma_f32_16x16x32_bf16 v[232:235], v[160:163], a[132:135], v[232:235]
    v_mul_f32 v199, v199, v211
    v_cvt_pk_bf16_f32 v196, v196, v197
    v_mfma_f32_16x16x32_bf16 v[236:239], v[164:167], a[132:135], v[236:239]
    v_cvt_pk_bf16_f32 v197, v198, v199
    s_waitcnt vmcnt(58)
    ds_write_b64 v9, v[196:197] offset:3616
    v_mfma_f32_16x16x32_bf16 v[216:219], v[168:171], a[136:139], v[216:219]
    v_exp_f32 v215, v215
    v_mfma_f32_16x16x32_bf16 v[220:223], v[172:175], a[136:139], v[220:223]
    v_add_f32 v214, 1.0, v214
    v_mfma_f32_16x16x32_bf16 v[224:227], v[176:179], a[136:139], v[224:227]
    v_rcp_f32 v213, v213
    v_mul_f32 v200, v200, v212
    v_mfma_f32_16x16x32_bf16 v[228:231], v[168:171], a[140:143], v[228:231]
    global_load_dwordx4 a[104:107], v247, s[60:61] offset:1024 sc1
    global_load_dwordx4 a[108:111], v247, s[60:61] offset:2048 sc1
    v_add_f32 v215, 1.0, v215
    v_mfma_f32_16x16x32_bf16 v[232:235], v[172:175], a[140:143], v[232:235]
    v_rcp_f32 v214, v214
    v_mfma_f32_16x16x32_bf16 v[236:239], v[176:179], a[140:143], v[236:239]
    v_mul_f32 v201, v201, v213
    v_mfma_f32_16x16x32_bf16 v[216:219], v[180:183], a[144:147], v[216:219]
    v_rcp_f32 v215, v215
    v_mfma_f32_16x16x32_bf16 v[220:223], v[184:187], a[144:147], v[220:223]
    v_mul_f32 v202, v202, v214
    v_mul_f32 v203, v203, v215
    v_mfma_f32_16x16x32_bf16 v[224:227], v[188:191], a[144:147], v[224:227]
    v_cvt_pk_bf16_f32 v200, v200, v201
    v_mfma_f32_16x16x32_bf16 v[228:231], v[180:183], a[148:151], v[228:231]
    v_cvt_pk_bf16_f32 v201, v202, v203
    v_mfma_f32_16x16x32_bf16 v[232:235], v[184:187], a[148:151], v[232:235]
    global_load_dwordx4 a[112:115], v247, s[60:61] offset:3072 sc1
    v_add_u32 v247, 0x2000, v247
    global_load_dwordx4 a[116:119], v247, s[60:61] offset:-4096 sc1
    v_and_b32 v200, v5, v200
    v_mfma_f32_16x16x32_bf16 v[236:239], v[188:191], a[148:151], v[236:239]
    v_and_b32 v201, v5, v201
    ds_write_b64 v10, v[200:201] offset:3584
    v_exp_f32 v228, v228
    v_exp_f32 v229, v229
    v_add_f32 v228, 1.0, v228
    v_exp_f32 v230, v230
    v_add_f32 v229, 1.0, v229
    v_rcp_f32 v228, v228
    v_exp_f32 v231, v231
    v_add_f32 v230, 1.0, v230
    v_rcp_f32 v229, v229
    v_mul_f32 v216, v216, v228
    v_exp_f32 v232, v232
    v_add_f32 v231, 1.0, v231
    v_rcp_f32 v230, v230
    v_mul_f32 v217, v217, v229
    v_exp_f32 v233, v233
    v_add_u32 v247, 0xffff2400, v247
    s_waitcnt vmcnt(40)
    global_load_dwordx4 v[164:167], v247, s[60:61] offset:-4096 sc1
    global_load_dwordx4 v[168:171], v247, s[60:61] offset:-3072 sc1
    v_add_f32 v232, 1.0, v232
    v_rcp_f32 v231, v231
    v_mul_f32 v218, v218, v230
    v_exp_f32 v234, v234
    v_add_f32 v233, 1.0, v233
    v_rcp_f32 v232, v232
    v_mul_f32 v219, v219, v231
    v_cvt_pk_bf16_f32 v216, v216, v217
    v_cvt_pk_bf16_f32 v217, v218, v219
    ds_write_b64 v9, v[216:217] offset:4032
    v_exp_f32 v235, v235
    v_add_f32 v234, 1.0, v234
    v_rcp_f32 v233, v233
    v_mul_f32 v220, v220, v232
    v_exp_f32 v236, v236
    v_add_f32 v235, 1.0, v235
    v_rcp_f32 v234, v234
    v_mul_f32 v221, v221, v233
    v_exp_f32 v237, v237
    global_load_dwordx4 v[172:175], v247, s[60:61] offset:-2048 sc1
    global_load_dwordx4 v[176:179], v247, s[60:61] offset:-1024 sc1
    v_add_f32 v236, 1.0, v236
    v_rcp_f32 v235, v235
    v_mul_f32 v222, v222, v234
    v_exp_f32 v238, v238
    v_add_f32 v237, 1.0, v237
    v_rcp_f32 v236, v236
    v_mul_f32 v223, v223, v235
    v_cvt_pk_bf16_f32 v220, v220, v221
    v_cvt_pk_bf16_f32 v221, v222, v223
    ds_write_b64 v9, v[220:221] offset:4064
    v_exp_f32 v239, v239
    v_add_f32 v238, 1.0, v238
    v_rcp_f32 v237, v237
    v_mul_f32 v224, v224, v236
    v_add_f32 v239, 1.0, v239
    v_rcp_f32 v238, v238
    v_mul_f32 v225, v225, v237
    v_rcp_f32 v239, v239
    v_mul_f32 v226, v226, v238
    v_mul_f32 v227, v227, v239
    global_load_dwordx4 v[180:183], v247, s[60:61] offset:0 sc1
    global_load_dwordx4 v[184:187], v247, s[60:61] offset:1024 sc1
    v_cvt_pk_bf16_f32 v224, v224, v225
    v_cvt_pk_bf16_f32 v225, v226, v227
    v_and_b32 v224, v5, v224
    v_and_b32 v225, v5, v225
    ds_write_b64 v10, v[224:225] offset:4032
    v_mul_u32_u24 v240, 112, v2
    v_add_u32 v240, s19, v240
    ds_read_b128 v[96:99], v240 offset:0
    ds_read_b128 v[100:103], v240 offset:16
    ds_read_b128 v[104:107], v240 offset:32
    ds_read_b128 v[108:111], v240 offset:48
    ds_read_b128 v[112:115], v240 offset:64
    ds_read_b128 v[116:119], v240 offset:80
    v_lshl_add_u32 v241, v1, 6, v2
    v_mul_u32_u24 v241, 80, v241
    s_waitcnt lgkmcnt(5)
    v_dot2_f32_bf16 v120, v96, v72, 0
    global_load_dwordx4 v[188:191], v247, s[60:61] offset:2048 sc1
    v_add_u32 v247, 0x6c00, v247
    global_load_dwordx4 v[192:195], v247, s[60:61] offset:-4096 sc1
    v_dot2_f32_bf16 v121, v97, v64, 0
    v_dot2_f32_bf16 v122, v97, v72, 0
    v_dot2_f32_bf16 v123, v98, v64, 0
    v_dot2c_f32_bf16 v120, v97, v73
    v_dot2c_f32_bf16 v121, v98, v65
    v_dot2c_f32_bf16 v122, v98, v73
    v_dot2c_f32_bf16 v123, v99, v65
    v_dot2c_f32_bf16 v120, v98, v74
    v_dot2c_f32_bf16 v121, v99, v66
    v_dot2c_f32_bf16 v122, v99, v74
    s_waitcnt lgkmcnt(4)
    v_dot2c_f32_bf16 v123, v100, v66
    v_dot2c_f32_bf16 v120, v99, v75
    v_dot2c_f32_bf16 v121, v100, v67
    v_dot2c_f32_bf16 v122, v100, v75
    global_load_dwordx4 v[196:199], v247, s[60:61] offset:-3072 sc1
    global_load_dwordx4 v[232:235], v247, s[60:61] offset:-2048 sc1
    v_dot2c_f32_bf16 v123, v101, v67
    v_dot2c_f32_bf16 v120, v100, v76
    v_dot2c_f32_bf16 v121, v101, v68
    v_dot2c_f32_bf16 v122, v101, v76
    v_dot2c_f32_bf16 v123, v102, v68
    v_dot2c_f32_bf16 v120, v101, v77
    v_dot2c_f32_bf16 v121, v102, v69
    v_dot2c_f32_bf16 v122, v102, v77
    v_dot2c_f32_bf16 v123, v103, v69
    v_dot2c_f32_bf16 v120, v102, v78
    v_dot2c_f32_bf16 v121, v103, v70
    v_dot2c_f32_bf16 v122, v103, v78
    s_waitcnt lgkmcnt(3)
    v_dot2c_f32_bf16 v123, v104, v70
    v_dot2c_f32_bf16 v120, v103, v79
    v_dot2c_f32_bf16 v121, v104, v71
    v_dot2c_f32_bf16 v122, v104, v79
    v_dot2c_f32_bf16 v123, v105, v71
    v_dot2_f32_bf16 v124, v98, v72, 0
    v_dot2_f32_bf16 v125, v99, v64, 0
    v_dot2_f32_bf16 v126, v99, v72, 0
    v_dot2_f32_bf16 v127, v100, v64, 0
    v_exp_f32 v152, v120
    v_dot2c_f32_bf16 v124, v99, v73
    v_dot2c_f32_bf16 v125, v100, v65
    v_exp_f32 v153, v121
    v_dot2c_f32_bf16 v126, v100, v73
    global_load_dwordx4 v[236:239], v247, s[60:61] offset:-1024 sc1
    global_load_dwordx4 v[200:203], v247, s[60:61] offset:0 sc1
    v_exp_f32 v154, v122
    v_dot2c_f32_bf16 v127, v101, v65
    v_dot2c_f32_bf16 v124, v100, v74
    v_exp_f32 v155, v123
    v_dot2c_f32_bf16 v125, v101, v66
    v_dot2c_f32_bf16 v126, v101, v74
    v_fma_f32 v152, v152, 0.5, 0.5
    v_dot2c_f32_bf16 v127, v102, v66
    v_fma_f32 v153, v153, 0.5, 0.5
    v_dot2c_f32_bf16 v124, v101, v75
    v_dot2c_f32_bf16 v125, v102, v67
    v_fma_f32 v154, v154, 0.5, 0.5
    v_dot2c_f32_bf16 v126, v102, v75
    v_dot2c_f32_bf16 v127, v103, v67
    v_fma_f32 v155, v155, 0.5, 0.5
    v_dot2c_f32_bf16 v124, v102, v76
    v_rcp_f32 v152, v152
    v_dot2c_f32_bf16 v125, v103, v68
    v_dot2c_f32_bf16 v126, v103, v76
    v_rcp_f32 v153, v153
    v_dot2c_f32_bf16 v127, v104, v68
    v_dot2c_f32_bf16 v124, v103, v77
    v_rcp_f32 v154, v154
    global_load_dwordx4 v[204:207], v247, s[60:61] offset:1024 sc1
    global_load_dwordx4 v[208:211], v247, s[60:61] offset:2048 sc1
    v_dot2c_f32_bf16 v125, v104, v69
    v_rcp_f32 v155, v155
    v_dot2c_f32_bf16 v126, v104, v77
    v_dot2c_f32_bf16 v127, v105, v69
    v_mul_f32 v120, v120, v152
    v_dot2c_f32_bf16 v124, v104, v78
    v_dot2c_f32_bf16 v125, v105, v70
    v_mul_f32 v121, v121, v153
    v_dot2c_f32_bf16 v126, v105, v78
    v_mul_f32 v122, v122, v154
    v_dot2c_f32_bf16 v127, v106, v70
    v_dot2c_f32_bf16 v124, v105, v79
    v_mul_f32 v123, v123, v155
    v_dot2c_f32_bf16 v125, v106, v71
    v_dot2c_f32_bf16 v126, v106, v79
    v_cvt_pk_bf16_f32 v156, v120, v121
    v_dot2c_f32_bf16 v127, v107, v71
    v_cvt_pk_bf16_f32 v157, v122, v123
    v_dot2_f32_bf16 v128, v100, v72, 0
    v_dot2_f32_bf16 v129, v101, v64, 0
    v_dot2_f32_bf16 v130, v101, v72, 0
    v_dot2_f32_bf16 v131, v102, v64, 0
    v_exp_f32 v152, v124
    v_dot2c_f32_bf16 v128, v101, v73
    v_dot2c_f32_bf16 v129, v102, v65
    v_exp_f32 v153, v125
    global_load_dwordx4 v[212:215], v247, s[60:61] offset:3072 sc1
    v_add_u32 v247, 0x2000, v247
    global_load_dwordx4 v[216:219], v247, s[60:61] offset:-4096 sc1
    v_dot2c_f32_bf16 v130, v102, v73
    v_exp_f32 v154, v126
    v_dot2c_f32_bf16 v131, v103, v65
    v_dot2c_f32_bf16 v128, v102, v74
    v_exp_f32 v155, v127
    v_dot2c_f32_bf16 v129, v103, v66
    v_fma_f32 v152, v152, 0.5, 0.5
    v_dot2c_f32_bf16 v130, v103, v74
    v_dot2c_f32_bf16 v131, v104, v66
    v_fma_f32 v153, v153, 0.5, 0.5
    v_dot2c_f32_bf16 v128, v103, v75
    v_dot2c_f32_bf16 v129, v104, v67
    v_fma_f32 v154, v154, 0.5, 0.5
    v_dot2c_f32_bf16 v130, v104, v75
    v_fma_f32 v155, v155, 0.5, 0.5
    v_dot2c_f32_bf16 v131, v105, v67
    v_dot2c_f32_bf16 v128, v104, v76
    v_rcp_f32 v152, v152
    v_dot2c_f32_bf16 v129, v105, v68
    v_rcp_f32 v153, v153
    v_dot2c_f32_bf16 v130, v105, v76
    v_dot2c_f32_bf16 v131, v106, v68
    global_load_dwordx4 v[220:223], v247, s[60:61] offset:-3072 sc1
    global_load_dwordx4 v[224:227], v247, s[60:61] offset:-2048 sc1
    v_rcp_f32 v154, v154
    v_dot2c_f32_bf16 v128, v105, v77
    v_rcp_f32 v155, v155
    v_dot2c_f32_bf16 v129, v106, v69
    v_dot2c_f32_bf16 v130, v106, v77
    v_mul_f32 v124, v124, v152
    v_dot2c_f32_bf16 v131, v107, v69
    v_dot2c_f32_bf16 v128, v106, v78
    v_mul_f32 v125, v125, v153
    v_dot2c_f32_bf16 v129, v107, v70
    v_mul_f32 v126, v126, v154
    v_dot2c_f32_bf16 v130, v107, v78
    s_waitcnt lgkmcnt(2)
    v_dot2c_f32_bf16 v131, v108, v70
    v_mul_f32 v127, v127, v155
    v_dot2c_f32_bf16 v128, v107, v79
    v_cvt_pk_bf16_f32 v158, v124, v125
    v_dot2c_f32_bf16 v129, v108, v71
    v_dot2c_f32_bf16 v130, v108, v79
    v_cvt_pk_bf16_f32 v159, v126, v127
    v_dot2c_f32_bf16 v131, v109, v71
    ds_write_b128 v241, v[156:159] offset:49152
    v_dot2_f32_bf16 v132, v102, v72, 0
    v_dot2_f32_bf16 v133, v103, v64, 0
    v_dot2_f32_bf16 v134, v103, v72, 0
    v_dot2_f32_bf16 v135, v104, v64, 0
    v_exp_f32 v152, v128
    global_load_dwordx4 v[228:231], v247, s[60:61] offset:-1024 sc1
    v_add_u32 v247, 0x5400, v247
    global_load_dwordx4 a[120:123], v247, s[60:61] offset:-4096 sc1
    v_dot2c_f32_bf16 v132, v103, v73
    v_dot2c_f32_bf16 v133, v104, v65
    v_exp_f32 v153, v129
    v_dot2c_f32_bf16 v134, v104, v73
    v_exp_f32 v154, v130
    v_dot2c_f32_bf16 v135, v105, v65
    v_dot2c_f32_bf16 v132, v104, v74
    v_exp_f32 v155, v131
    v_dot2c_f32_bf16 v133, v105, v66
    v_dot2c_f32_bf16 v134, v105, v74
    v_fma_f32 v152, v152, 0.5, 0.5
    v_dot2c_f32_bf16 v135, v106, v66
    v_fma_f32 v153, v153, 0.5, 0.5
    v_dot2c_f32_bf16 v132, v105, v75
    v_dot2c_f32_bf16 v133, v106, v67
    v_fma_f32 v154, v154, 0.5, 0.5
    v_dot2c_f32_bf16 v134, v106, v75
    v_dot2c_f32_bf16 v135, v107, v67
    v_fma_f32 v155, v155, 0.5, 0.5
    v_dot2c_f32_bf16 v132, v106, v76
    v_rcp_f32 v152, v152
    v_dot2c_f32_bf16 v133, v107, v68
    global_load_dwordx4 a[124:127], v247, s[60:61] offset:-3072 sc1
    global_load_dwordx4 a[208:211], v247, s[60:61] offset:-2048 sc1
    v_dot2c_f32_bf16 v134, v107, v76
    v_rcp_f32 v153, v153
    v_dot2c_f32_bf16 v135, v108, v68
    v_dot2c_f32_bf16 v132, v107, v77
    v_rcp_f32 v154, v154
    v_dot2c_f32_bf16 v133, v108, v69
    v_rcp_f32 v155, v155
    v_dot2c_f32_bf16 v134, v108, v77
    v_dot2c_f32_bf16 v135, v109, v69
    v_mul_f32 v128, v128, v152
    v_dot2c_f32_bf16 v132, v108, v78
    v_dot2c_f32_bf16 v133, v109, v70
    v_mul_f32 v129, v129, v153
    v_dot2c_f32_bf16 v134, v109, v78
    v_mul_f32 v130, v130, v154
    v_dot2c_f32_bf16 v135, v110, v70
    v_dot2c_f32_bf16 v132, v109, v79
    v_mul_f32 v131, v131, v155
    v_dot2c_f32_bf16 v133, v110, v71
    v_dot2c_f32_bf16 v134, v110, v79
    v_cvt_pk_bf16_f32 v160, v128, v129
    v_dot2c_f32_bf16 v135, v111, v71
    v_cvt_pk_bf16_f32 v161, v130, v131
    v_dot2_f32_bf16 v136, v104, v72, 0
    v_dot2_f32_bf16 v137, v105, v64, 0
    s_waitcnt vmcnt(40)
    global_load_dwordx4 a[212:215], v247, s[60:61] offset:-1024 sc1
    global_load_dwordx4 a[216:219], v247, s[60:61] offset:0 sc1
    v_dot2_f32_bf16 v138, v105, v72, 0
    v_dot2_f32_bf16 v139, v106, v64, 0
    v_exp_f32 v152, v132
    v_dot2c_f32_bf16 v136, v105, v73
    v_dot2c_f32_bf16 v137, v106, v65
    v_exp_f32 v153, v133
    v_dot2c_f32_bf16 v138, v106, v73
    v_exp_f32 v154, v134
    v_dot2c_f32_bf16 v139, v107, v65
    v_dot2c_f32_bf16 v136, v106, v74
    v_exp_f32 v155, v135
    v_dot2c_f32_bf16 v137, v107, v66
    v_fma_f32 v152, v152, 0.5, 0.5
    v_dot2c_f32_bf16 v138, v107, v74
    v_dot2c_f32_bf16 v139, v108, v66
    v_fma_f32 v153, v153, 0.5, 0.5
    v_dot2c_f32_bf16 v136, v107, v75
    v_dot2c_f32_bf16 v137, v108, v67
    v_fma_f32 v154, v154, 0.5, 0.5
    v_dot2c_f32_bf16 v138, v108, v75
    v_fma_f32 v155, v155, 0.5, 0.5
    v_dot2c_f32_bf16 v139, v109, v67
    v_dot2c_f32_bf16 v136, v108, v76
    v_rcp_f32 v152, v152
    global_load_dwordx4 a[220:223], v247, s[60:61] offset:1024 sc1
    global_load_dwordx4 a[128:131], v247, s[60:61] offset:2048 sc1
    v_dot2c_f32_bf16 v137, v109, v68
    v_rcp_f32 v153, v153
    v_dot2c_f32_bf16 v138, v109, v76
    v_dot2c_f32_bf16 v139, v110, v68
    v_rcp_f32 v154, v154
    v_dot2c_f32_bf16 v136, v109, v77
    v_rcp_f32 v155, v155
    v_dot2c_f32_bf16 v137, v110, v69
    v_dot2c_f32_bf16 v138, v110, v77
    v_mul_f32 v132, v132, v152
    v_dot2c_f32_bf16 v139, v111, v69
    v_dot2c_f32_bf16 v136, v110, v78
    v_mul_f32 v133, v133, v153
    v_dot2c_f32_bf16 v137, v111, v70
    v_mul_f32 v134, v134, v154
    v_dot2c_f32_bf16 v138, v111, v78
    s_waitcnt lgkmcnt(2)
    v_dot2c_f32_bf16 v139, v112, v70
    v_mul_f32 v135, v135, v155
    v_dot2c_f32_bf16 v136, v111, v79
    v_cvt_pk_bf16_f32 v162, v132, v133
    v_dot2c_f32_bf16 v137, v112, v71
    v_dot2c_f32_bf16 v138, v112, v79
    v_cvt_pk_bf16_f32 v163, v134, v135
    v_dot2c_f32_bf16 v139, v113, v71
    global_load_dwordx4 a[132:135], v247, s[60:61] offset:3072 sc1
    v_add_u32 v247, 0x2000, v247
    global_load_dwordx4 a[136:139], v247, s[60:61] offset:-4096 sc1
    ds_write_b128 v241, v[160:163] offset:49168
    v_dot2_f32_bf16 v140, v106, v72, 0
    v_dot2_f32_bf16 v141, v107, v64, 0
    v_dot2_f32_bf16 v142, v107, v72, 0
    v_dot2_f32_bf16 v143, v108, v64, 0
    v_exp_f32 v152, v136
    v_dot2c_f32_bf16 v140, v107, v73
    v_dot2c_f32_bf16 v141, v108, v65
    v_exp_f32 v153, v137
    v_dot2c_f32_bf16 v142, v108, v73
    v_exp_f32 v154, v138
    v_dot2c_f32_bf16 v143, v109, v65
    v_dot2c_f32_bf16 v140, v108, v74
    v_exp_f32 v155, v139
    v_dot2c_f32_bf16 v141, v109, v66
    v_dot2c_f32_bf16 v142, v109, v74
    v_fma_f32 v152, v152, 0.5, 0.5
    v_dot2c_f32_bf16 v143, v110, v66
    v_fma_f32 v153, v153, 0.5, 0.5
    v_dot2c_f32_bf16 v140, v109, v75
    v_dot2c_f32_bf16 v141, v110, v67
    v_fma_f32 v154, v154, 0.5, 0.5
    v_dot2c_f32_bf16 v142, v110, v75
    global_load_dwordx4 a[140:143], v247, s[60:61] offset:-3072 sc1
    global_load_dwordx4 a[144:147], v247, s[60:61] offset:-2048 sc1
    v_dot2c_f32_bf16 v143, v111, v67
    v_fma_f32 v155, v155, 0.5, 0.5
    v_dot2c_f32_bf16 v140, v110, v76
    v_rcp_f32 v152, v152
    v_dot2c_f32_bf16 v141, v111, v68
    v_dot2c_f32_bf16 v142, v111, v76
    v_rcp_f32 v153, v153
    v_dot2c_f32_bf16 v143, v112, v68
    v_dot2c_f32_bf16 v140, v111, v77
    v_rcp_f32 v154, v154
    v_dot2c_f32_bf16 v141, v112, v69
    v_rcp_f32 v155, v155
    v_dot2c_f32_bf16 v142, v112, v77
    v_dot2c_f32_bf16 v143, v113, v69
    v_mul_f32 v136, v136, v152
    v_dot2c_f32_bf16 v140, v112, v78
    v_dot2c_f32_bf16 v141, v113, v70
    v_mul_f32 v137, v137, v153
    v_dot2c_f32_bf16 v142, v113, v78
    v_mul_f32 v138, v138, v154
    v_dot2c_f32_bf16 v143, v114, v70
    v_dot2c_f32_bf16 v140, v113, v79
    v_mul_f32 v139, v139, v155
    v_dot2c_f32_bf16 v141, v114, v71
    global_load_dwordx4 a[148:151], v247, s[60:61] offset:-1024 sc1
    v_dot2c_f32_bf16 v142, v114, v79
    v_cvt_pk_bf16_f32 v156, v136, v137
    v_dot2c_f32_bf16 v143, v115, v71
    v_cvt_pk_bf16_f32 v157, v138, v139
    v_dot2_f32_bf16 v144, v108, v72, 0
    v_dot2_f32_bf16 v145, v109, v64, 0
    v_dot2_f32_bf16 v146, v109, v72, 0
    v_dot2_f32_bf16 v147, v110, v64, 0
    v_exp_f32 v152, v140
    v_dot2c_f32_bf16 v144, v109, v73
    v_dot2c_f32_bf16 v145, v110, v65
    v_exp_f32 v153, v141
    v_dot2c_f32_bf16 v146, v110, v73
    v_exp_f32 v154, v142
    v_dot2c_f32_bf16 v147, v111, v65
    v_dot2c_f32_bf16 v144, v110, v74
    v_exp_f32 v155, v143
    v_dot2c_f32_bf16 v145, v111, v66
    v_fma_f32 v152, v152, 0.5, 0.5
    v_dot2c_f32_bf16 v146, v111, v74
    v_dot2c_f32_bf16 v147, v112, v66
    v_fma_f32 v153, v153, 0.5, 0.5
    v_dot2c_f32_bf16 v144, v111, v75
    v_dot2c_f32_bf16 v145, v112, v67
    v_fma_f32 v154, v154, 0.5, 0.5
    v_dot2c_f32_bf16 v146, v112, v75
    v_fma_f32 v155, v155, 0.5, 0.5
    v_dot2c_f32_bf16 v147, v113, v67
    v_dot2c_f32_bf16 v144, v112, v76
    v_rcp_f32 v152, v152
    v_dot2c_f32_bf16 v145, v113, v68
    v_rcp_f32 v153, v153
    v_dot2c_f32_bf16 v146, v113, v76
    v_dot2c_f32_bf16 v147, v114, v68
    v_rcp_f32 v154, v154
    v_dot2c_f32_bf16 v144, v113, v77
    v_rcp_f32 v155, v155
    v_dot2c_f32_bf16 v145, v114, v69
    v_dot2c_f32_bf16 v146, v114, v77
    v_mul_f32 v140, v140, v152
    v_dot2c_f32_bf16 v147, v115, v69
    v_dot2c_f32_bf16 v144, v114, v78
    v_mul_f32 v141, v141, v153
    v_dot2c_f32_bf16 v145, v115, v70
    v_mul_f32 v142, v142, v154
    v_dot2c_f32_bf16 v146, v115, v78
    s_waitcnt lgkmcnt(2)
    v_dot2c_f32_bf16 v147, v116, v70
    v_mul_f32 v143, v143, v155
    v_dot2c_f32_bf16 v144, v115, v79
    v_cvt_pk_bf16_f32 v158, v140, v141
    v_dot2c_f32_bf16 v145, v116, v71
    v_dot2c_f32_bf16 v146, v116, v79
    v_cvt_pk_bf16_f32 v159, v142, v143
    v_dot2c_f32_bf16 v147, v117, v71
    ds_write_b128 v241, v[156:159] offset:49184
    v_dot2_f32_bf16 v148, v110, v72, 0
    v_dot2_f32_bf16 v149, v111, v64, 0
    v_dot2_f32_bf16 v150, v111, v72, 0
    v_dot2_f32_bf16 v151, v112, v64, 0
    v_exp_f32 v152, v144
    v_dot2c_f32_bf16 v148, v111, v73
    v_dot2c_f32_bf16 v149, v112, v65
    v_exp_f32 v153, v145
    v_dot2c_f32_bf16 v150, v112, v73
    v_exp_f32 v154, v146
    v_dot2c_f32_bf16 v151, v113, v65
    v_dot2c_f32_bf16 v148, v112, v74
    v_exp_f32 v155, v147
    v_dot2c_f32_bf16 v149, v113, v66
    v_dot2c_f32_bf16 v150, v113, v74
    v_fma_f32 v152, v152, 0.5, 0.5
    v_dot2c_f32_bf16 v151, v114, v66
    v_fma_f32 v153, v153, 0.5, 0.5
    v_dot2c_f32_bf16 v148, v113, v75
    v_dot2c_f32_bf16 v149, v114, v67
    v_fma_f32 v154, v154, 0.5, 0.5
    v_dot2c_f32_bf16 v150, v114, v75
    v_dot2c_f32_bf16 v151, v115, v67
    v_fma_f32 v155, v155, 0.5, 0.5
    v_dot2c_f32_bf16 v148, v114, v76
    v_rcp_f32 v152, v152
    v_dot2c_f32_bf16 v149, v115, v68
    v_dot2c_f32_bf16 v150, v115, v76
    v_rcp_f32 v153, v153
    v_dot2c_f32_bf16 v151, v116, v68
    v_dot2c_f32_bf16 v148, v115, v77
    v_rcp_f32 v154, v154
    v_dot2c_f32_bf16 v149, v116, v69
    v_rcp_f32 v155, v155
    v_dot2c_f32_bf16 v150, v116, v77
    v_dot2c_f32_bf16 v151, v117, v69
    v_mul_f32 v144, v144, v152
    v_dot2c_f32_bf16 v148, v116, v78
    v_dot2c_f32_bf16 v149, v117, v70
    v_mul_f32 v145, v145, v153
    v_dot2c_f32_bf16 v150, v117, v78
    v_mul_f32 v146, v146, v154
    v_dot2c_f32_bf16 v151, v118, v70
    v_dot2c_f32_bf16 v148, v117, v79
    v_mul_f32 v147, v147, v155
    v_dot2c_f32_bf16 v149, v118, v71
    v_dot2c_f32_bf16 v150, v118, v79
    v_cvt_pk_bf16_f32 v160, v144, v145
    v_dot2c_f32_bf16 v151, v119, v71
    v_cvt_pk_bf16_f32 v161, v146, v147
    v_exp_f32 v152, v148
    global_load_dwordx4 v[64:67], v247, s[60:61] offset:0 sc1
    global_load_dwordx4 v[68:71], v247, s[60:61] offset:1024 sc1
    v_exp_f32 v153, v149
    v_exp_f32 v154, v150
    v_exp_f32 v155, v151
    v_fma_f32 v152, v152, 0.5, 0.5
    v_fma_f32 v153, v153, 0.5, 0.5
    v_fma_f32 v154, v154, 0.5, 0.5
    v_fma_f32 v155, v155, 0.5, 0.5
    v_rcp_f32 v152, v152
    v_rcp_f32 v153, v153
    global_load_dwordx4 v[72:75], v247, s[60:61] offset:2048 sc1
    global_load_dwordx4 v[76:79], v247, s[60:61] offset:3072 sc1
    v_rcp_f32 v154, v154
    v_rcp_f32 v155, v155
    v_mul_f32 v148, v148, v152
    v_mul_f32 v149, v149, v153
    v_mul_f32 v150, v150, v154
    v_mul_f32 v151, v151, v155
    v_cvt_pk_bf16_f32 v162, v148, v149
    v_cvt_pk_bf16_f32 v163, v150, v151
    ds_write_b128 v241, v[160:163] offset:49200
    s_waitcnt lgkmcnt(0)
    s_barrier
    ds_read_b64_tr_b16 v[96:97], v6 offset:0
    ds_read_b64_tr_b16 v[98:99], v6 offset:320
    ds_read_b64_tr_b16 v[100:101], v6 offset:32
    ds_read_b64_tr_b16 v[102:103], v6 offset:352
    ds_read_b64_tr_b16 v[104:105], v6 offset:2560
    ds_read_b64_tr_b16 v[106:107], v6 offset:2880
    ds_read_b64_tr_b16 v[108:109], v6 offset:2592
    ds_read_b64_tr_b16 v[110:111], v6 offset:2912
    s_waitcnt lgkmcnt(6)
    v_mfma_f32_16x16x32_bf16 v[16:19], a[152:155], v[96:99], v[16:19]
    ds_read_b64_tr_b16 v[112:113], v6 offset:5120
    ds_read_b64_tr_b16 v[114:115], v6 offset:5440
    ds_read_b64_tr_b16 v[116:117], v6 offset:5152
    ds_read_b64_tr_b16 v[118:119], v6 offset:5472
    s_waitcnt lgkmcnt(8)
    v_mfma_f32_16x16x32_bf16 v[32:35], a[152:155], v[100:103], v[32:35]
    v_add_u32 v247, 0x2000, v247
    global_load_dwordx4 a[152:155], v247, s[60:61] offset:-4096 sc1
    v_mfma_f32_16x16x32_bf16 v[20:23], a[156:159], v[96:99], v[20:23]
    v_mfma_f32_16x16x32_bf16 v[36:39], a[156:159], v[100:103], v[36:39]
    global_load_dwordx4 a[156:159], v247, s[60:61] offset:-3072 sc1
    v_mfma_f32_16x16x32_bf16 v[24:27], a[240:243], v[96:99], v[24:27]
    v_mfma_f32_16x16x32_bf16 v[40:43], a[240:243], v[100:103], v[40:43]
    v_mfma_f32_16x16x32_bf16 v[28:31], a[244:247], v[96:99], v[28:31]
    global_load_dwordx4 a[240:243], v247, s[60:61] offset:-2048 sc1
    v_mfma_f32_16x16x32_bf16 v[44:47], a[244:247], v[100:103], v[44:47]
    s_waitcnt lgkmcnt(6)
    v_mfma_f32_16x16x32_bf16 v[16:19], v[48:51], v[104:107], v[16:19]
    ds_read_b64_tr_b16 v[120:121], v6 offset:7680
    ds_read_b64_tr_b16 v[122:123], v6 offset:8000
    ds_read_b64_tr_b16 v[124:125], v6 offset:7712
    ds_read_b64_tr_b16 v[126:127], v6 offset:8032
    s_waitcnt lgkmcnt(8)
    v_mfma_f32_16x16x32_bf16 v[32:35], v[48:51], v[108:111], v[32:35]
    global_load_dwordx4 a[244:247], v247, s[60:61] offset:-1024 sc1
    global_load_dwordx4 v[48:51], v247, s[60:61] offset:0 sc1
    v_mfma_f32_16x16x32_bf16 v[20:23], v[52:55], v[104:107], v[20:23]
    v_mfma_f32_16x16x32_bf16 v[36:39], v[52:55], v[108:111], v[36:39]
    v_mfma_f32_16x16x32_bf16 v[24:27], v[56:59], v[104:107], v[24:27]
    v_mfma_f32_16x16x32_bf16 v[40:43], v[56:59], v[108:111], v[40:43]
    v_mfma_f32_16x16x32_bf16 v[28:31], v[60:63], v[104:107], v[28:31]
    v_mfma_f32_16x16x32_bf16 v[44:47], v[60:63], v[108:111], v[44:47]
    s_waitcnt lgkmcnt(6)
    v_mfma_f32_16x16x32_bf16 v[16:19], a[248:251], v[112:115], v[16:19]
    ds_read_b64_tr_b16 v[128:129], v6 offset:10240
    ds_read_b64_tr_b16 v[130:131], v6 offset:10560
    ds_read_b64_tr_b16 v[132:133], v6 offset:10272
    ds_read_b64_tr_b16 v[134:135], v6 offset:10592
    s_waitcnt lgkmcnt(8)
    v_mfma_f32_16x16x32_bf16 v[32:35], a[248:251], v[116:119], v[32:35]
    global_load_dwordx4 v[52:55], v247, s[60:61] offset:1024 sc1
    global_load_dwordx4 v[56:59], v247, s[60:61] offset:2048 sc1
    v_mfma_f32_16x16x32_bf16 v[20:23], a[252:255], v[112:115], v[20:23]
    v_mfma_f32_16x16x32_bf16 v[36:39], a[252:255], v[116:119], v[36:39]
    v_mfma_f32_16x16x32_bf16 v[24:27], a[160:163], v[112:115], v[24:27]
    v_mfma_f32_16x16x32_bf16 v[40:43], a[160:163], v[116:119], v[40:43]
    v_mfma_f32_16x16x32_bf16 v[28:31], a[164:167], v[112:115], v[28:31]
    v_mfma_f32_16x16x32_bf16 v[44:47], a[164:167], v[116:119], v[44:47]
    s_waitcnt lgkmcnt(6)
    v_mfma_f32_16x16x32_bf16 v[16:19], a[168:171], v[120:123], v[16:19]
    ds_read_b64_tr_b16 v[136:137], v6 offset:12800
    ds_read_b64_tr_b16 v[138:139], v6 offset:13120
    ds_read_b64_tr_b16 v[140:141], v6 offset:12832
    ds_read_b64_tr_b16 v[142:143], v6 offset:13152
    s_waitcnt lgkmcnt(8)
    v_mfma_f32_16x16x32_bf16 v[32:35], a[168:171], v[124:127], v[32:35]
    global_load_dwordx4 v[60:63], v247, s[60:61] offset:3072 sc1
    v_add_u32 v247, 0x2000, v247
    global_load_dwordx4 a[248:251], v247, s[60:61] offset:-4096 sc1
    v_mfma_f32_16x16x32_bf16 v[20:23], a[172:175], v[120:123], v[20:23]
    v_mfma_f32_16x16x32_bf16 v[36:39], a[172:175], v[124:127], v[36:39]
    v_mfma_f32_16x16x32_bf16 v[24:27], a[176:179], v[120:123], v[24:27]
    v_mfma_f32_16x16x32_bf16 v[40:43], a[176:179], v[124:127], v[40:43]
    v_mfma_f32_16x16x32_bf16 v[28:31], a[180:183], v[120:123], v[28:31]
    v_mfma_f32_16x16x32_bf16 v[44:47], a[180:183], v[124:127], v[44:47]
    s_waitcnt lgkmcnt(6)
    v_mfma_f32_16x16x32_bf16 v[16:19], a[184:187], v[128:131], v[16:19]
    s_waitcnt vmcnt(40)
    global_load_dwordx4 a[252:255], v247, s[60:61] offset:-3072 sc1
    global_load_dwordx4 a[160:163], v247, s[60:61] offset:-2048 sc1
    ds_read_b64_tr_b16 v[144:145], v6 offset:15360
    ds_read_b64_tr_b16 v[146:147], v6 offset:15680
    ds_read_b64_tr_b16 v[148:149], v6 offset:15392
    ds_read_b64_tr_b16 v[150:151], v6 offset:15712
    s_waitcnt lgkmcnt(8)
    v_mfma_f32_16x16x32_bf16 v[32:35], a[184:187], v[132:135], v[32:35]
    v_mfma_f32_16x16x32_bf16 v[20:23], a[188:191], v[128:131], v[20:23]
    v_mfma_f32_16x16x32_bf16 v[36:39], a[188:191], v[132:135], v[36:39]
    v_mfma_f32_16x16x32_bf16 v[24:27], a[0:3], v[128:131], v[24:27]
    v_mfma_f32_16x16x32_bf16 v[40:43], a[0:3], v[132:135], v[40:43]
    v_mfma_f32_16x16x32_bf16 v[28:31], a[4:7], v[128:131], v[28:31]
    v_mfma_f32_16x16x32_bf16 v[44:47], a[4:7], v[132:135], v[44:47]
    global_load_dwordx4 a[164:167], v247, s[60:61] offset:-1024 sc1
    global_load_dwordx4 a[168:171], v247, s[60:61] offset:0 sc1
    s_waitcnt lgkmcnt(6)
    v_mfma_f32_16x16x32_bf16 v[16:19], a[8:11], v[136:139], v[16:19]
    ds_read_b64_tr_b16 v[152:153], v6 offset:17920
    ds_read_b64_tr_b16 v[154:155], v6 offset:18240
    ds_read_b64_tr_b16 v[156:157], v6 offset:17952
    ds_read_b64_tr_b16 v[158:159], v6 offset:18272
    s_waitcnt lgkmcnt(8)
    v_mfma_f32_16x16x32_bf16 v[32:35], a[8:11], v[140:143], v[32:35]
    v_mfma_f32_16x16x32_bf16 v[20:23], a[12:15], v[136:139], v[20:23]
    v_mfma_f32_16x16x32_bf16 v[36:39], a[12:15], v[140:143], v[36:39]
    v_mfma_f32_16x16x32_bf16 v[24:27], a[16:19], v[136:139], v[24:27]
    v_mfma_f32_16x16x32_bf16 v[40:43], a[16:19], v[140:143], v[40:43]
    v_mfma_f32_16x16x32_bf16 v[28:31], a[20:23], v[136:139], v[28:31]
    global_load_dwordx4 a[172:175], v247, s[60:61] offset:1024 sc1
    global_load_dwordx4 a[176:179], v247, s[60:61] offset:2048 sc1
    v_mfma_f32_16x16x32_bf16 v[44:47], a[20:23], v[140:143], v[44:47]
    s_waitcnt lgkmcnt(6)
    v_mfma_f32_16x16x32_bf16 v[16:19], a[24:27], v[144:147], v[16:19]
    s_waitcnt lgkmcnt(4)
    v_mfma_f32_16x16x32_bf16 v[32:35], a[24:27], v[148:151], v[32:35]
    v_mfma_f32_16x16x32_bf16 v[20:23], v[164:167], v[144:147], v[20:23]
    v_mfma_f32_16x16x32_bf16 v[36:39], v[164:167], v[148:151], v[36:39]
    v_mfma_f32_16x16x32_bf16 v[24:27], v[168:171], v[144:147], v[24:27]
    v_mfma_f32_16x16x32_bf16 v[40:43], v[168:171], v[148:151], v[40:43]
    v_mfma_f32_16x16x32_bf16 v[28:31], v[172:175], v[144:147], v[28:31]
    global_load_dwordx4 a[180:183], v247, s[60:61] offset:3072 sc1
    v_add_u32 v247, 0x2000, v247
    global_load_dwordx4 a[184:187], v247, s[60:61] offset:-4096 sc1
    v_mfma_f32_16x16x32_bf16 v[44:47], v[172:175], v[148:151], v[44:47]
    s_waitcnt vmcnt(45)
    s_waitcnt lgkmcnt(2)
    v_mfma_f32_16x16x32_bf16 v[16:19], v[176:179], v[152:155], v[16:19]
    s_waitcnt lgkmcnt(0)
    v_mfma_f32_16x16x32_bf16 v[32:35], v[176:179], v[156:159], v[32:35]
    v_mfma_f32_16x16x32_bf16 v[20:23], v[180:183], v[152:155], v[20:23]
    v_mfma_f32_16x16x32_bf16 v[36:39], v[180:183], v[156:159], v[36:39]
    v_mfma_f32_16x16x32_bf16 v[24:27], v[184:187], v[152:155], v[24:27]
    v_mfma_f32_16x16x32_bf16 v[40:43], v[184:187], v[156:159], v[40:43]
    v_mfma_f32_16x16x32_bf16 v[28:31], v[188:191], v[152:155], v[28:31]
    global_load_dwordx4 a[188:191], v247, s[60:61] offset:-3072 sc1
    global_load_dwordx4 a[0:3], v247, s[60:61] offset:-2048 sc1
    v_mfma_f32_16x16x32_bf16 v[44:47], v[188:191], v[156:159], v[44:47]
    v_pk_add_f32 v[144:145], v[16:17], v[18:19]
    v_pk_add_f32 v[148:149], v[32:33], v[34:35]
    v_pk_mul_f32 v[146:147], v[16:17], v[16:17]
    v_pk_mul_f32 v[150:151], v[32:33], v[32:33]
    v_pk_fma_f32 v[146:147], v[18:19], v[18:19], v[146:147]
    v_pk_fma_f32 v[150:151], v[34:35], v[34:35], v[150:151]
    v_pk_add_f32 v[144:145], v[144:145], v[20:21]
    v_pk_add_f32 v[148:149], v[148:149], v[36:37]
    v_pk_fma_f32 v[146:147], v[20:21], v[20:21], v[146:147]
    v_pk_fma_f32 v[150:151], v[36:37], v[36:37], v[150:151]
    v_pk_add_f32 v[144:145], v[144:145], v[22:23]
    v_pk_add_f32 v[148:149], v[148:149], v[38:39]
    v_pk_fma_f32 v[146:147], v[22:23], v[22:23], v[146:147]
    v_pk_fma_f32 v[150:151], v[38:39], v[38:39], v[150:151]
    v_pk_add_f32 v[144:145], v[144:145], v[24:25]
    v_pk_add_f32 v[148:149], v[148:149], v[40:41]
    v_pk_fma_f32 v[146:147], v[24:25], v[24:25], v[146:147]
    v_pk_fma_f32 v[150:151], v[40:41], v[40:41], v[150:151]
    v_pk_add_f32 v[144:145], v[144:145], v[26:27]
    v_pk_add_f32 v[148:149], v[148:149], v[42:43]
    v_pk_fma_f32 v[146:147], v[26:27], v[26:27], v[146:147]
    v_pk_fma_f32 v[150:151], v[42:43], v[42:43], v[150:151]
    v_pk_add_f32 v[144:145], v[144:145], v[28:29]
    v_pk_add_f32 v[148:149], v[148:149], v[44:45]
    v_pk_fma_f32 v[146:147], v[28:29], v[28:29], v[146:147]
    v_pk_fma_f32 v[150:151], v[44:45], v[44:45], v[150:151]
    v_pk_add_f32 v[144:145], v[144:145], v[30:31]
    global_load_dwordx4 a[4:7], v247, s[60:61] offset:-1024 sc1
    global_load_dwordx4 a[8:11], v247, s[60:61] offset:0 sc1
    v_pk_add_f32 v[148:149], v[148:149], v[46:47]
    v_pk_fma_f32 v[146:147], v[30:31], v[30:31], v[146:147]
    v_pk_fma_f32 v[150:151], v[46:47], v[46:47], v[150:151]
    v_add_f32 v240, v144, v145
    v_add_f32 v242, v148, v149
    v_add_f32 v241, v146, v147
    v_add_f32 v243, v150, v151
    v_permlane32_swap_b32 v240, v242
    s_nop 0
    v_permlane32_swap_b32 v241, v243
    v_add_f32 v240, v240, v242
    v_add_f32 v241, v241, v243
    s_nop 1
    v_permlane16_swap_b32 v240, v241
    v_add_f32 v240, v240, v241
    ds_write_b32 v14, v240 offset:2048
    s_waitcnt lgkmcnt(0)
    s_barrier
    global_load_dwordx4 a[12:15], v247, s[60:61] offset:1024 sc1
    global_load_dwordx4 a[16:19], v247, s[60:61] offset:2048 sc1
    ds_read_b128 v[96:99], v15 offset:2048
    ds_read_b128 v[100:103], v15 offset:2304
    ds_read_b128 v[104:107], v15 offset:2560
    ds_read_b128 v[108:111], v15 offset:2816
    s_waitcnt lgkmcnt(3)
    v_pk_add_f32 v[96:97], v[96:97], v[98:99]
    global_load_dwordx4 a[20:23], v247, s[60:61] offset:3072 sc1
    v_add_u32 v247, 0x2000, v247
    global_load_dwordx4 a[24:27], v247, s[60:61] offset:-4096 sc1
    s_waitcnt lgkmcnt(1)
    v_pk_add_f32 v[104:105], v[104:105], v[106:107]
    v_pk_add_f32 v[100:101], v[100:101], v[102:103]
    s_waitcnt lgkmcnt(0)
    v_pk_add_f32 v[108:109], v[108:109], v[110:111]
    v_add_f32 v96, v96, v97
    v_add_f32 v104, v104, v105
    v_add_f32 v100, v100, v101
    v_add_f32 v108, v108, v109
    v_mul_f32 v96, s24, v96
    v_mul_f32 v104, s24, v104
    v_mul_f32 v97, v96, v96
    v_mul_f32 v105, v104, v104
    v_fma_f32 v100, v100, s24, -v97
    v_fma_f32 v108, v108, s24, -v105
    v_max_f32 v100, 0, v100
    v_max_f32 v108, 0, v108
    v_add_f32 v100, s25, v100
    v_add_f32 v108, s25, v108
    v_rsq_f32 v100, v100
    v_rsq_f32 v108, v108
    v_mul_f32 v240, 0x3fb8aa3b, v100
    v_mul_f32 v242, 0x3fb8aa3b, v108
    v_mul_f32_e64 v241, -v96, v240
    v_mul_f32_e64 v243, -v104, v242
    v_pk_fma_f32 v[112:113], v[16:17], v[240:241], v[240:241] op_sel:[0,0,1] op_sel_hi:[1,0,1]
    v_pk_fma_f32 v[114:115], v[18:19], v[240:241], v[240:241] op_sel:[0,0,1] op_sel_hi:[1,0,1]
    v_pk_fma_f32 v[116:117], v[20:21], v[240:241], v[240:241] op_sel:[0,0,1] op_sel_hi:[1,0,1]
    v_pk_fma_f32 v[118:119], v[22:23], v[240:241], v[240:241] op_sel:[0,0,1] op_sel_hi:[1,0,1]
    v_cvt_pk_bf16_f32 v112, v112, v113
    v_cvt_pk_bf16_f32 v113, v114, v115
    v_cvt_pk_bf16_f32 v114, v116, v117
    v_cvt_pk_bf16_f32 v115, v118, v119
    ds_write_b128 v11, v[112:115] offset:0
    v_pk_fma_f32 v[120:121], v[24:25], v[240:241], v[240:241] op_sel:[0,0,1] op_sel_hi:[1,0,1]
    v_pk_fma_f32 v[122:123], v[26:27], v[240:241], v[240:241] op_sel:[0,0,1] op_sel_hi:[1,0,1]
    v_pk_fma_f32 v[124:125], v[28:29], v[240:241], v[240:241] op_sel:[0,0,1] op_sel_hi:[1,0,1]
    v_pk_fma_f32 v[126:127], v[30:31], v[240:241], v[240:241] op_sel:[0,0,1] op_sel_hi:[1,0,1]
    v_cvt_pk_bf16_f32 v120, v120, v121
    v_cvt_pk_bf16_f32 v121, v122, v123
    v_cvt_pk_bf16_f32 v122, v124, v125
    v_cvt_pk_bf16_f32 v123, v126, v127
    ds_write_b128 v11, v[120:123] offset:1024
    v_pk_fma_f32 v[128:129], v[32:33], v[242:243], v[242:243] op_sel:[0,0,1] op_sel_hi:[1,0,1]
    v_pk_fma_f32 v[130:131], v[34:35], v[242:243], v[242:243] op_sel:[0,0,1] op_sel_hi:[1,0,1]
    v_pk_fma_f32 v[132:133], v[36:37], v[242:243], v[242:243] op_sel:[0,0,1] op_sel_hi:[1,0,1]
    v_pk_fma_f32 v[134:135], v[38:39], v[242:243], v[242:243] op_sel:[0,0,1] op_sel_hi:[1,0,1]
    v_cvt_pk_bf16_f32 v128, v128, v129
    v_cvt_pk_bf16_f32 v129, v130, v131
    v_cvt_pk_bf16_f32 v130, v132, v133
    v_cvt_pk_bf16_f32 v131, v134, v135
    ds_write_b128 v11, v[128:131] offset:8192
    v_pk_fma_f32 v[136:137], v[40:41], v[242:243], v[242:243] op_sel:[0,0,1] op_sel_hi:[1,0,1]
    v_pk_fma_f32 v[138:139], v[42:43], v[242:243], v[242:243] op_sel:[0,0,1] op_sel_hi:[1,0,1]
    v_pk_fma_f32 v[140:141], v[44:45], v[242:243], v[242:243] op_sel:[0,0,1] op_sel_hi:[1,0,1]
    v_pk_fma_f32 v[142:143], v[46:47], v[242:243], v[242:243] op_sel:[0,0,1] op_sel_hi:[1,0,1]
    v_cvt_pk_bf16_f32 v136, v136, v137
    v_cvt_pk_bf16_f32 v137, v138, v139
    v_cvt_pk_bf16_f32 v138, v140, v141
    v_cvt_pk_bf16_f32 v139, v142, v143
    ds_write_b128 v11, v[136:139] offset:9216
    s_waitcnt lgkmcnt(0)
    s_barrier
    ds_read_b128 v[96:99], v7 offset:0
    ds_read_b128 v[100:103], v7 offset:8192
    ds_read_b128 v[104:107], v7 offset:1024
    ds_read_b128 v[108:111], v7 offset:9216
    ds_read_b128 v[112:115], v7 offset:2048
    ds_read_b128 v[116:119], v7 offset:10240
    s_waitcnt lgkmcnt(5)
    v_mfma_f32_16x16x32_bf16 v[160:163], a[28:31], v[96:99], 0
    ds_read_b128 v[120:123], v7 offset:3072
    ds_read_b128 v[124:127], v7 offset:11264
    s_waitcnt lgkmcnt(6)
    v_mfma_f32_16x16x32_bf16 v[176:179], a[28:31], v[100:103], 0
    global_load_dwordx4 a[28:31], v247, s[60:61] offset:-3072 sc1
    v_mfma_f32_16x16x32_bf16 v[164:167], a[32:35], v[96:99], 0
    v_mfma_f32_16x16x32_bf16 v[180:183], a[32:35], v[100:103], 0
    global_load_dwordx4 a[32:35], v247, s[60:61] offset:-2048 sc1
    v_mfma_f32_16x16x32_bf16 v[168:171], a[36:39], v[96:99], 0
    v_mfma_f32_16x16x32_bf16 v[184:187], a[36:39], v[100:103], 0
    v_mfma_f32_16x16x32_bf16 v[172:175], a[40:43], v[96:99], 0
    global_load_dwordx4 a[36:39], v247, s[60:61] offset:-1024 sc1
    v_mfma_f32_16x16x32_bf16 v[188:191], a[40:43], v[100:103], 0
    s_waitcnt lgkmcnt(5)
    v_mfma_f32_16x16x32_bf16 v[160:163], a[44:47], v[104:107], v[160:163]
    ds_read_b128 v[128:131], v7 offset:4096
    ds_read_b128 v[132:135], v7 offset:12288
    s_waitcnt lgkmcnt(6)
    v_mfma_f32_16x16x32_bf16 v[176:179], a[44:47], v[108:111], v[176:179]
    v_mfma_f32_16x16x32_bf16 v[164:167], a[48:51], v[104:107], v[164:167]
    global_load_dwordx4 a[40:43], v247, s[60:61] offset:0 sc1
    global_load_dwordx4 a[44:47], v247, s[60:61] offset:1024 sc1
    v_mfma_f32_16x16x32_bf16 v[180:183], a[48:51], v[108:111], v[180:183]
    v_mfma_f32_16x16x32_bf16 v[168:171], a[52:55], v[104:107], v[168:171]
    v_mfma_f32_16x16x32_bf16 v[184:187], a[52:55], v[108:111], v[184:187]
    v_mfma_f32_16x16x32_bf16 v[172:175], a[56:59], v[104:107], v[172:175]
    v_mfma_f32_16x16x32_bf16 v[188:191], a[56:59], v[108:111], v[188:191]
    s_waitcnt lgkmcnt(5)
    v_mfma_f32_16x16x32_bf16 v[160:163], a[60:63], v[112:115], v[160:163]
    ds_read_b128 v[136:139], v7 offset:5120
    ds_read_b128 v[140:143], v7 offset:13312
    s_waitcnt lgkmcnt(6)
    v_mfma_f32_16x16x32_bf16 v[176:179], a[60:63], v[116:119], v[176:179]
    v_mfma_f32_16x16x32_bf16 v[164:167], a[64:67], v[112:115], v[164:167]
    global_load_dwordx4 a[48:51], v247, s[60:61] offset:2048 sc1
    global_load_dwordx4 a[52:55], v247, s[60:61] offset:3072 sc1
    v_mfma_f32_16x16x32_bf16 v[180:183], a[64:67], v[116:119], v[180:183]
    v_mfma_f32_16x16x32_bf16 v[168:171], a[68:71], v[112:115], v[168:171]
    v_mfma_f32_16x16x32_bf16 v[184:187], a[68:71], v[116:119], v[184:187]
    v_mfma_f32_16x16x32_bf16 v[172:175], a[72:75], v[112:115], v[172:175]
    v_mfma_f32_16x16x32_bf16 v[188:191], a[72:75], v[116:119], v[188:191]
    s_waitcnt lgkmcnt(5)
    v_mfma_f32_16x16x32_bf16 v[160:163], a[76:79], v[120:123], v[160:163]
    ds_read_b128 v[144:147], v7 offset:6144
    ds_read_b128 v[148:151], v7 offset:14336
    s_waitcnt lgkmcnt(6)
    v_mfma_f32_16x16x32_bf16 v[176:179], a[76:79], v[124:127], v[176:179]
    v_mfma_f32_16x16x32_bf16 v[164:167], a[80:83], v[120:123], v[164:167]
    v_add_u32 v247, 0x2000, v247
    global_load_dwordx4 a[56:59], v247, s[60:61] offset:-4096 sc1
    global_load_dwordx4 a[60:63], v247, s[60:61] offset:-3072 sc1
    v_mfma_f32_16x16x32_bf16 v[180:183], a[80:83], v[124:127], v[180:183]
    v_mfma_f32_16x16x32_bf16 v[168:171], a[84:87], v[120:123], v[168:171]
    v_mfma_f32_16x16x32_bf16 v[184:187], a[84:87], v[124:127], v[184:187]
    v_mfma_f32_16x16x32_bf16 v[172:175], a[88:91], v[120:123], v[172:175]
    v_mfma_f32_16x16x32_bf16 v[188:191], a[88:91], v[124:127], v[188:191]
    s_waitcnt lgkmcnt(5)
    v_mfma_f32_16x16x32_bf16 v[160:163], a[92:95], v[128:131], v[160:163]
    ds_read_b128 v[152:155], v7 offset:7168
    ds_read_b128 v[156:159], v7 offset:15360
    s_waitcnt lgkmcnt(6)
    v_mfma_f32_16x16x32_bf16 v[176:179], a[92:95], v[132:135], v[176:179]
    s_waitcnt vmcnt(40)
    global_load_dwordx4 a[64:67], v247, s[60:61] offset:-2048 sc1
    global_load_dwordx4 a[68:71], v247, s[60:61] offset:-1024 sc1
    v_mfma_f32_16x16x32_bf16 v[164:167], a[192:195], v[128:131], v[164:167]
    v_mfma_f32_16x16x32_bf16 v[180:183], a[192:195], v[132:135], v[180:183]
    v_mfma_f32_16x16x32_bf16 v[168:171], a[196:199], v[128:131], v[168:171]
    v_mfma_f32_16x16x32_bf16 v[184:187], a[196:199], v[132:135], v[184:187]
    v_mfma_f32_16x16x32_bf16 v[172:175], a[200:203], v[128:131], v[172:175]
    v_mfma_f32_16x16x32_bf16 v[188:191], a[200:203], v[132:135], v[188:191]
    s_waitcnt lgkmcnt(5)
    v_mfma_f32_16x16x32_bf16 v[160:163], v[192:195], v[136:139], v[160:163]
    s_waitcnt lgkmcnt(4)
    v_mfma_f32_16x16x32_bf16 v[176:179], v[192:195], v[140:143], v[176:179]
    global_load_dwordx4 a[72:75], v247, s[60:61] offset:0 sc1
    global_load_dwordx4 a[76:79], v247, s[60:61] offset:1024 sc1
    v_mfma_f32_16x16x32_bf16 v[164:167], v[196:199], v[136:139], v[164:167]
    v_mfma_f32_16x16x32_bf16 v[180:183], v[196:199], v[140:143], v[180:183]
    v_mfma_f32_16x16x32_bf16 v[168:171], v[232:235], v[136:139], v[168:171]
    v_mfma_f32_16x16x32_bf16 v[184:187], v[232:235], v[140:143], v[184:187]
    v_mfma_f32_16x16x32_bf16 v[172:175], v[236:239], v[136:139], v[172:175]
    v_mfma_f32_16x16x32_bf16 v[188:191], v[236:239], v[140:143], v[188:191]
    s_waitcnt lgkmcnt(3)
    v_mfma_f32_16x16x32_bf16 v[160:163], v[200:203], v[144:147], v[160:163]
    s_waitcnt lgkmcnt(2)
    v_mfma_f32_16x16x32_bf16 v[176:179], v[200:203], v[148:151], v[176:179]
    global_load_dwordx4 a[80:83], v247, s[60:61] offset:2048 sc1
    global_load_dwordx4 a[84:87], v247, s[60:61] offset:3072 sc1
    v_mfma_f32_16x16x32_bf16 v[164:167], v[204:207], v[144:147], v[164:167]
    v_mfma_f32_16x16x32_bf16 v[180:183], v[204:207], v[148:151], v[180:183]
    v_mfma_f32_16x16x32_bf16 v[168:171], v[208:211], v[144:147], v[168:171]
    v_mfma_f32_16x16x32_bf16 v[184:187], v[208:211], v[148:151], v[184:187]
    v_mfma_f32_16x16x32_bf16 v[172:175], v[212:215], v[144:147], v[172:175]
    v_mfma_f32_16x16x32_bf16 v[188:191], v[212:215], v[148:151], v[188:191]
    s_waitcnt lgkmcnt(1)
    v_mfma_f32_16x16x32_bf16 v[160:163], v[216:219], v[152:155], v[160:163]
    s_waitcnt lgkmcnt(0)
    v_mfma_f32_16x16x32_bf16 v[176:179], v[216:219], v[156:159], v[176:179]
    v_add_u32 v247, 0x2000, v247
    global_load_dwordx4 a[88:91], v247, s[60:61] offset:-4096 sc1
    global_load_dwordx4 a[92:95], v247, s[60:61] offset:-3072 sc1
    v_mfma_f32_16x16x32_bf16 v[164:167], v[220:223], v[152:155], v[164:167]
    v_mfma_f32_16x16x32_bf16 v[180:183], v[220:223], v[156:159], v[180:183]
    v_mfma_f32_16x16x32_bf16 v[168:171], v[224:227], v[152:155], v[168:171]
    v_mfma_f32_16x16x32_bf16 v[184:187], v[224:227], v[156:159], v[184:187]
    v_mfma_f32_16x16x32_bf16 v[172:175], v[228:231], v[152:155], v[172:175]
    v_mfma_f32_16x16x32_bf16 v[188:191], v[228:231], v[156:159], v[188:191]
    v_mfma_f32_16x16x32_bf16 v[192:195], a[204:207], v[96:99], 0
    v_mfma_f32_16x16x32_bf16 v[208:211], a[204:207], v[100:103], 0
    global_load_dwordx4 a[192:195], v247, s[60:61] offset:-2048 sc1
    global_load_dwordx4 a[196:199], v247, s[60:61] offset:-1024 sc1
    v_mfma_f32_16x16x32_bf16 v[196:199], a[224:227], v[96:99], 0
    v_exp_f32 v224, v160
    v_exp_f32 v225, v161
    v_mfma_f32_16x16x32_bf16 v[212:215], a[224:227], v[100:103], 0
    v_add_f32 v224, 1.0, v224
    v_exp_f32 v226, v162
    v_mfma_f32_16x16x32_bf16 v[200:203], a[228:231], v[96:99], 0
    v_add_f32 v225, 1.0, v225
    v_rcp_f32 v224, v224
    v_mfma_f32_16x16x32_bf16 v[216:219], a[228:231], v[100:103], 0
    v_exp_f32 v227, v163
    v_add_f32 v226, 1.0, v226
    v_mfma_f32_16x16x32_bf16 v[204:207], a[232:235], v[96:99], 0
    v_rcp_f32 v225, v225
    v_mul_f32 v160, v160, v224
    v_mfma_f32_16x16x32_bf16 v[220:223], a[232:235], v[100:103], 0
    v_exp_f32 v224, v164
    v_add_f32 v227, 1.0, v227
    v_rcp_f32 v226, v226
    v_mul_f32 v161, v161, v225
    v_cvt_pk_bf16_f32 v228, v160, v161
    v_mfma_f32_16x16x32_bf16 v[192:195], a[236:239], v[104:107], v[192:195]
    global_load_dwordx4 a[200:203], v247, s[60:61] offset:0 sc1
    global_load_dwordx4 a[204:207], v247, s[60:61] offset:1024 sc1
    v_exp_f32 v225, v165
    v_add_f32 v224, 1.0, v224
    v_mfma_f32_16x16x32_bf16 v[208:211], a[236:239], v[108:111], v[208:211]
    v_rcp_f32 v227, v227
    v_mul_f32 v162, v162, v226
    v_mfma_f32_16x16x32_bf16 v[196:199], v[80:83], v[104:107], v[196:199]
    v_exp_f32 v226, v166
    v_add_f32 v225, 1.0, v225
    v_mfma_f32_16x16x32_bf16 v[212:215], v[80:83], v[108:111], v[212:215]
    v_rcp_f32 v224, v224
    v_mul_f32 v163, v163, v227
    v_mfma_f32_16x16x32_bf16 v[200:203], v[84:87], v[104:107], v[200:203]
    v_cvt_pk_bf16_f32 v229, v162, v163
    v_exp_f32 v227, v167
    v_mfma_f32_16x16x32_bf16 v[216:219], v[84:87], v[108:111], v[216:219]
    global_load_dwordx4 a[224:227], v247, s[60:61] offset:2048 sc1
    global_load_dwordx4 a[228:231], v247, s[60:61] offset:3072 sc1
    v_add_f32 v226, 1.0, v226
    v_rcp_f32 v225, v225
    v_mfma_f32_16x16x32_bf16 v[204:207], v[88:91], v[104:107], v[204:207]
    v_mul_f32 v164, v164, v224
    v_exp_f32 v224, v168
    v_add_f32 v227, 1.0, v227
    v_mfma_f32_16x16x32_bf16 v[220:223], v[88:91], v[108:111], v[220:223]
    v_rcp_f32 v226, v226
    v_mul_f32 v165, v165, v225
    v_cvt_pk_bf16_f32 v230, v164, v165
    v_exp_f32 v225, v169
    v_mfma_f32_16x16x32_bf16 v[192:195], v[92:95], v[112:115], v[192:195]
    v_add_f32 v224, 1.0, v224
    v_rcp_f32 v227, v227
    v_mfma_f32_16x16x32_bf16 v[208:211], v[92:95], v[116:119], v[208:211]
    v_mul_f32 v166, v166, v226
    v_exp_f32 v226, v170
    v_mfma_f32_16x16x32_bf16 v[196:199], v[248:251], v[112:115], v[196:199]
    v_add_u32 v247, 0x2000, v247
    global_load_dwordx4 a[232:235], v247, s[60:61] offset:-4096 sc1
    global_load_dwordx4 a[236:239], v247, s[60:61] offset:-3072 sc1
    v_add_f32 v225, 1.0, v225
    v_rcp_f32 v224, v224
    v_mfma_f32_16x16x32_bf16 v[212:215], v[248:251], v[116:119], v[212:215]
    v_mul_f32 v167, v167, v227
    v_cvt_pk_bf16_f32 v231, v166, v167
    v_mfma_f32_16x16x32_bf16 v[200:203], v[252:255], v[112:115], v[200:203]
    ds_write_b128 v13, v[228:231] offset:0
    v_exp_f32 v227, v171
    v_add_f32 v226, 1.0, v226
    v_mfma_f32_16x16x32_bf16 v[216:219], v[252:255], v[116:119], v[216:219]
    v_rcp_f32 v225, v225
    v_mul_f32 v168, v168, v224
    v_mfma_f32_16x16x32_bf16 v[204:207], a[96:99], v[112:115], v[204:207]
    v_exp_f32 v224, v172
    v_add_f32 v227, 1.0, v227
    v_mfma_f32_16x16x32_bf16 v[220:223], a[96:99], v[116:119], v[220:223]
    global_load_dwordx4 v[80:83], v247, s[60:61] offset:-2048 sc1
    global_load_dwordx4 v[84:87], v247, s[60:61] offset:-1024 sc1
    v_rcp_f32 v226, v226
    v_mul_f32 v169, v169, v225
    v_cvt_pk_bf16_f32 v232, v168, v169
    v_exp_f32 v225, v173
    v_mfma_f32_16x16x32_bf16 v[192:195], a[100:103], v[120:123], v[192:195]
    v_add_f32 v224, 1.0, v224
    v_rcp_f32 v227, v227
    v_mfma_f32_16x16x32_bf16 v[208:211], a[100:103], v[124:127], v[208:211]
    v_mul_f32 v170, v170, v226
    v_exp_f32 v226, v174
    v_mfma_f32_16x16x32_bf16 v[196:199], a[104:107], v[120:123], v[196:199]
    v_add_f32 v225, 1.0, v225
    v_rcp_f32 v224, v224
    v_mul_f32 v171, v171, v227
    v_mfma_f32_16x16x32_bf16 v[212:215], a[104:107], v[124:127], v[212:215]
    v_cvt_pk_bf16_f32 v233, v170, v171
    v_exp_f32 v227, v175
    v_mfma_f32_16x16x32_bf16 v[200:203], a[108:111], v[120:123], v[200:203]
    global_load_dwordx4 v[88:91], v247, s[60:61] offset:0 sc1
    global_load_dwordx4 v[92:95], v247, s[60:61] offset:1024 sc1
    v_add_f32 v226, 1.0, v226
    v_rcp_f32 v225, v225
    v_mfma_f32_16x16x32_bf16 v[216:219], a[108:111], v[124:127], v[216:219]
    v_mul_f32 v172, v172, v224
    v_exp_f32 v224, v176
    v_mfma_f32_16x16x32_bf16 v[204:207], a[112:115], v[120:123], v[204:207]
    v_add_f32 v227, 1.0, v227
    v_rcp_f32 v226, v226
    v_mfma_f32_16x16x32_bf16 v[220:223], a[112:115], v[124:127], v[220:223]
    v_mul_f32 v173, v173, v225
    v_cvt_pk_bf16_f32 v234, v172, v173
    v_exp_f32 v225, v177
    v_add_f32 v224, 1.0, v224
    v_mfma_f32_16x16x32_bf16 v[192:195], a[116:119], v[128:131], v[192:195]
    v_rcp_f32 v227, v227
    v_mul_f32 v174, v174, v226
    v_exp_f32 v226, v178
    v_mfma_f32_16x16x32_bf16 v[208:211], a[116:119], v[132:135], v[208:211]
    global_load_dwordx4 v[248:251], v247, s[60:61] offset:2048 sc1
    global_load_dwordx4 v[252:255], v247, s[60:61] offset:3072 sc1
    v_add_f32 v225, 1.0, v225
    v_rcp_f32 v224, v224
    v_mfma_f32_16x16x32_bf16 v[196:199], a[120:123], v[128:131], v[196:199]
    v_mul_f32 v175, v175, v227
    v_cvt_pk_bf16_f32 v235, v174, v175
    v_mfma_f32_16x16x32_bf16 v[212:215], a[120:123], v[132:135], v[212:215]
    ds_write_b128 v13, v[232:235] offset:2048
    v_exp_f32 v227, v179
    v_mfma_f32_16x16x32_bf16 v[200:203], a[124:127], v[128:131], v[200:203]
    v_add_f32 v226, 1.0, v226
    v_rcp_f32 v225, v225
    v_mfma_f32_16x16x32_bf16 v[216:219], a[124:127], v[132:135], v[216:219]
    v_mul_f32 v176, v176, v224
    v_exp_f32 v224, v180
    v_mfma_f32_16x16x32_bf16 v[204:207], a[208:211], v[128:131], v[204:207]
    v_add_f32 v227, 1.0, v227
    v_rcp_f32 v226, v226
    v_mfma_f32_16x16x32_bf16 v[220:223], a[208:211], v[132:135], v[220:223]
    v_mul_f32 v177, v177, v225
    v_cvt_pk_bf16_f32 v228, v176, v177
    v_exp_f32 v225, v181
    v_add_f32 v224, 1.0, v224
    v_rcp_f32 v227, v227
    v_mfma_f32_16x16x32_bf16 v[192:195], a[212:215], v[136:139], v[192:195]
    v_add_u32 v247, 0x2000, v247
    s_waitcnt vmcnt(40)
    global_load_dwordx4 a[96:99], v247, s[60:61] offset:-4096 sc1
    global_load_dwordx4 a[100:103], v247, s[60:61] offset:-3072 sc1
    v_mul_f32 v178, v178, v226
    v_exp_f32 v226, v182
    v_mfma_f32_16x16x32_bf16 v[208:211], a[212:215], v[140:143], v[208:211]
    v_add_f32 v225, 1.0, v225
    v_rcp_f32 v224, v224
    v_mfma_f32_16x16x32_bf16 v[196:199], a[216:219], v[136:139], v[196:199]
    v_mul_f32 v179, v179, v227
    v_cvt_pk_bf16_f32 v229, v178, v179
    v_mfma_f32_16x16x32_bf16 v[212:215], a[216:219], v[140:143], v[212:215]
    v_exp_f32 v227, v183
    v_add_f32 v226, 1.0, v226
    v_mfma_f32_16x16x32_bf16 v[200:203], a[220:223], v[136:139], v[200:203]
    v_rcp_f32 v225, v225
    v_mul_f32 v180, v180, v224
    v_mfma_f32_16x16x32_bf16 v[216:219], a[220:223], v[140:143], v[216:219]
    global_load_dwordx4 a[104:107], v247, s[60:61] offset:-2048 sc1
    global_load_dwordx4 a[108:111], v247, s[60:61] offset:-1024 sc1
    v_exp_f32 v224, v184
    v_add_f32 v227, 1.0, v227
    v_rcp_f32 v226, v226
    v_mfma_f32_16x16x32_bf16 v[204:207], a[128:131], v[136:139], v[204:207]
    v_mul_f32 v181, v181, v225
    v_cvt_pk_bf16_f32 v230, v180, v181
    v_mfma_f32_16x16x32_bf16 v[220:223], a[128:131], v[140:143], v[220:223]
    v_exp_f32 v225, v185
    v_add_f32 v224, 1.0, v224
    v_rcp_f32 v227, v227
    v_mul_f32 v182, v182, v226
    v_mfma_f32_16x16x32_bf16 v[192:195], a[132:135], v[144:147], v[192:195]
    v_exp_f32 v226, v186
    v_add_f32 v225, 1.0, v225
    v_mfma_f32_16x16x32_bf16 v[208:211], a[132:135], v[148:151], v[208:211]
    v_rcp_f32 v224, v224
    v_mul_f32 v183, v183, v227
    v_mfma_f32_16x16x32_bf16 v[196:199], a[136:139], v[144:147], v[196:199]
    global_load_dwordx4 a[112:115], v247, s[60:61] offset:0 sc1
    global_load_dwordx4 a[116:119], v247, s[60:61] offset:1024 sc1
    v_cvt_pk_bf16_f32 v231, v182, v183
    ds_write_b128 v13, v[228:231] offset:1024
    v_mfma_f32_16x16x32_bf16 v[212:215], a[136:139], v[148:151], v[212:215]
    v_exp_f32 v227, v187
    v_add_f32 v226, 1.0, v226
    v_rcp_f32 v225, v225
    v_mfma_f32_16x16x32_bf16 v[200:203], a[140:143], v[144:147], v[200:203]
    v_mul_f32 v184, v184, v224
    v_exp_f32 v224, v188
    v_mfma_f32_16x16x32_bf16 v[216:219], a[140:143], v[148:151], v[216:219]
    v_add_f32 v227, 1.0, v227
    v_rcp_f32 v226, v226
    v_mfma_f32_16x16x32_bf16 v[204:207], a[144:147], v[144:147], v[204:207]
    v_mul_f32 v185, v185, v225
    v_cvt_pk_bf16_f32 v232, v184, v185
    v_mfma_f32_16x16x32_bf16 v[220:223], a[144:147], v[148:151], v[220:223]
    v_exp_f32 v225, v189
    v_add_f32 v224, 1.0, v224
    v_rcp_f32 v227, v227
    v_mul_f32 v186, v186, v226
    v_mfma_f32_16x16x32_bf16 v[192:195], a[148:151], v[152:155], v[192:195]
    global_load_dwordx4 a[120:123], v247, s[60:61] offset:2048 sc1
    global_load_dwordx4 a[124:127], v247, s[60:61] offset:3072 sc1
    v_exp_f32 v226, v190
    v_add_f32 v225, 1.0, v225
    v_mfma_f32_16x16x32_bf16 v[208:211], a[148:151], v[156:159], v[208:211]
    v_rcp_f32 v224, v224
    v_mul_f32 v187, v187, v227
    v_cvt_pk_bf16_f32 v233, v186, v187
    v_mfma_f32_16x16x32_bf16 v[196:199], v[64:67], v[152:155], v[196:199]
    v_exp_f32 v227, v191
    v_add_f32 v226, 1.0, v226
    v_mfma_f32_16x16x32_bf16 v[212:215], v[64:67], v[156:159], v[212:215]
    v_rcp_f32 v225, v225
    v_mul_f32 v188, v188, v224
    v_mfma_f32_16x16x32_bf16 v[200:203], v[68:71], v[152:155], v[200:203]
    v_add_f32 v227, 1.0, v227
    v_rcp_f32 v226, v226
    v_mfma_f32_16x16x32_bf16 v[216:219], v[68:71], v[156:159], v[216:219]
    v_add_u32 v247, 0x2000, v247
    global_load_dwordx4 a[208:211], v247, s[60:61] offset:-4096 sc1
    global_load_dwordx4 a[212:215], v247, s[60:61] offset:-3072 sc1
    v_mul_f32 v189, v189, v225
    v_cvt_pk_bf16_f32 v234, v188, v189
    v_mfma_f32_16x16x32_bf16 v[204:207], v[72:75], v[152:155], v[204:207]
    v_rcp_f32 v227, v227
    v_mul_f32 v190, v190, v226
    v_mfma_f32_16x16x32_bf16 v[220:223], v[72:75], v[156:159], v[220:223]
    v_mul_f32 v191, v191, v227
    v_cvt_pk_bf16_f32 v235, v190, v191
    ds_write_b128 v13, v[232:235] offset:3072
    v_mfma_f32_16x16x32_bf16 v[160:163], v[76:79], v[96:99], 0
    v_mfma_f32_16x16x32_bf16 v[176:179], v[76:79], v[100:103], 0
    v_mfma_f32_16x16x32_bf16 v[164:167], a[152:155], v[96:99], 0
    v_exp_f32 v224, v192
    v_exp_f32 v225, v193
    v_mfma_f32_16x16x32_bf16 v[180:183], a[152:155], v[100:103], 0
    global_load_dwordx4 a[216:219], v247, s[60:61] offset:-2048 sc1
    global_load_dwordx4 a[220:223], v247, s[60:61] offset:-1024 sc1
    v_add_f32 v224, 1.0, v224
    v_exp_f32 v226, v194
    v_mfma_f32_16x16x32_bf16 v[168:171], a[156:159], v[96:99], 0
    v_add_f32 v225, 1.0, v225
    v_rcp_f32 v224, v224
    v_mfma_f32_16x16x32_bf16 v[184:187], a[156:159], v[100:103], 0
    v_exp_f32 v227, v195
    v_add_f32 v226, 1.0, v226
    v_mfma_f32_16x16x32_bf16 v[172:175], a[240:243], v[96:99], 0
    v_rcp_f32 v225, v225
    v_mul_f32 v192, v192, v224
    v_mfma_f32_16x16x32_bf16 v[188:191], a[240:243], v[100:103], 0
    v_exp_f32 v224, v196
    v_add_f32 v227, 1.0, v227
    v_rcp_f32 v226, v226
    v_mul_f32 v193, v193, v225
    v_cvt_pk_bf16_f32 v228, v192, v193
    v_mfma_f32_16x16x32_bf16 v[160:163], a[244:247], v[104:107], v[160:163]
    global_load_dwordx4 a[128:131], v247, s[60:61] offset:0 sc1
    global_load_dwordx4 a[132:135], v247, s[60:61] offset:1024 sc1
    v_exp_f32 v225, v197
    v_add_f32 v224, 1.0, v224
    v_mfma_f32_16x16x32_bf16 v[176:179], a[244:247], v[108:111], v[176:179]
    v_rcp_f32 v227, v227
    v_mul_f32 v194, v194, v226
    v_mfma_f32_16x16x32_bf16 v[164:167], v[48:51], v[104:107], v[164:167]
    v_exp_f32 v226, v198
    v_add_f32 v225, 1.0, v225
    v_mfma_f32_16x16x32_bf16 v[180:183], v[48:51], v[108:111], v[180:183]
    v_rcp_f32 v224, v224
    v_mul_f32 v195, v195, v227
    v_mfma_f32_16x16x32_bf16 v[168:171], v[52:55], v[104:107], v[168:171]
    v_cvt_pk_bf16_f32 v229, v194, v195
    v_exp_f32 v227, v199
    v_mfma_f32_16x16x32_bf16 v[184:187], v[52:55], v[108:111], v[184:187]
    v_add_f32 v226, 1.0, v226
    v_rcp_f32 v225, v225
    v_mfma_f32_16x16x32_bf16 v[172:175], v[56:59], v[104:107], v[172:175]
    global_load_dwordx4 a[136:139], v247, s[60:61] offset:2048 sc1
    global_load_dwordx4 a[140:143], v247, s[60:61] offset:3072 sc1
    v_mul_f32 v196, v196, v224
    v_exp_f32 v224, v200
    v_add_f32 v227, 1.0, v227
    v_mfma_f32_16x16x32_bf16 v[188:191], v[56:59], v[108:111], v[188:191]
    v_rcp_f32 v226, v226
    v_mul_f32 v197, v197, v225
    v_cvt_pk_bf16_f32 v230, v196, v197
    v_exp_f32 v225, v201
    v_mfma_f32_16x16x32_bf16 v[160:163], v[60:63], v[112:115], v[160:163]
    v_add_f32 v224, 1.0, v224
    v_rcp_f32 v227, v227
    v_mfma_f32_16x16x32_bf16 v[176:179], v[60:63], v[116:119], v[176:179]
    v_mul_f32 v198, v198, v226
    v_exp_f32 v226, v202
    v_mfma_f32_16x16x32_bf16 v[164:167], a[248:251], v[112:115], v[164:167]
    v_add_f32 v225, 1.0, v225
    v_rcp_f32 v224, v224
    v_mfma_f32_16x16x32_bf16 v[180:183], a[248:251], v[116:119], v[180:183]
    v_add_u32 v247, 0x2000, v247
    global_load_dwordx4 a[144:147], v247, s[60:61] offset:-4096 sc1
    global_load_dwordx4 a[148:151], v247, s[60:61] offset:-3072 sc1
    v_mul_f32 v199, v199, v227
    v_cvt_pk_bf16_f32 v231, v198, v199
    v_mfma_f32_16x16x32_bf16 v[168:171], a[252:255], v[112:115], v[168:171]
    ds_write_b128 v13, v[228:231] offset:4096
    v_exp_f32 v227, v203
    v_add_f32 v226, 1.0, v226
    v_mfma_f32_16x16x32_bf16 v[184:187], a[252:255], v[116:119], v[184:187]
    v_rcp_f32 v225, v225
    v_mul_f32 v200, v200, v224
    v_mfma_f32_16x16x32_bf16 v[172:175], a[160:163], v[112:115], v[172:175]
    v_exp_f32 v224, v204
    v_add_f32 v227, 1.0, v227
    v_mfma_f32_16x16x32_bf16 v[188:191], a[160:163], v[116:119], v[188:191]
    v_rcp_f32 v226, v226
    v_mul_f32 v201, v201, v225
    v_cvt_pk_bf16_f32 v232, v200, v201
    v_exp_f32 v225, v205
    v_mfma_f32_16x16x32_bf16 v[160:163], a[164:167], v[120:123], v[160:163]
    global_load_dwordx4 v[64:67], v247, s[60:61] offset:-2048 sc1
    global_load_dwordx4 v[68:71], v247, s[60:61] offset:-1024 sc1
    v_add_f32 v224, 1.0, v224
    v_rcp_f32 v227, v227
    v_mfma_f32_16x16x32_bf16 v[176:179], a[164:167], v[124:127], v[176:179]
    v_mul_f32 v202, v202, v226
    v_exp_f32 v226, v206
    v_mfma_f32_16x16x32_bf16 v[164:167], a[168:171], v[120:123], v[164:167]
    v_add_f32 v225, 1.0, v225
    v_rcp_f32 v224, v224
    v_mul_f32 v203, v203, v227
    v_mfma_f32_16x16x32_bf16 v[180:183], a[168:171], v[124:127], v[180:183]
    v_cvt_pk_bf16_f32 v233, v202, v203
    v_exp_f32 v227, v207
    v_mfma_f32_16x16x32_bf16 v[168:171], a[172:175], v[120:123], v[168:171]
    v_add_f32 v226, 1.0, v226
    v_rcp_f32 v225, v225
    v_mfma_f32_16x16x32_bf16 v[184:187], a[172:175], v[124:127], v[184:187]
    global_load_dwordx4 v[72:75], v247, s[60:61] offset:0 sc1
    global_load_dwordx4 v[76:79], v247, s[60:61] offset:1024 sc1
    v_mul_f32 v204, v204, v224
    v_exp_f32 v224, v208
    v_mfma_f32_16x16x32_bf16 v[172:175], a[176:179], v[120:123], v[172:175]
    v_add_f32 v227, 1.0, v227
    v_rcp_f32 v226, v226
    v_mfma_f32_16x16x32_bf16 v[188:191], a[176:179], v[124:127], v[188:191]
    v_mul_f32 v205, v205, v225
    v_cvt_pk_bf16_f32 v234, v204, v205
    s_waitcnt vmcnt(59)
    v_exp_f32 v225, v209
    v_add_f32 v224, 1.0, v224
    v_mfma_f32_16x16x32_bf16 v[160:163], a[180:183], v[128:131], v[160:163]
    v_rcp_f32 v227, v227
    v_mul_f32 v206, v206, v226
    v_exp_f32 v226, v210
    v_mfma_f32_16x16x32_bf16 v[176:179], a[180:183], v[132:135], v[176:179]
    v_add_f32 v225, 1.0, v225
    v_rcp_f32 v224, v224
    v_mfma_f32_16x16x32_bf16 v[164:167], a[184:187], v[128:131], v[164:167]
    global_load_dwordx4 a[152:155], v247, s[60:61] offset:2048 sc1
    global_load_dwordx4 a[156:159], v247, s[60:61] offset:3072 sc1
    v_mul_f32 v207, v207, v227
    v_cvt_pk_bf16_f32 v235, v206, v207
    v_mfma_f32_16x16x32_bf16 v[180:183], a[184:187], v[132:135], v[180:183]
    ds_write_b128 v13, v[232:235] offset:6144
    v_exp_f32 v227, v211
    v_mfma_f32_16x16x32_bf16 v[168:171], a[188:191], v[128:131], v[168:171]
    v_add_f32 v226, 1.0, v226
    v_rcp_f32 v225, v225
    v_mfma_f32_16x16x32_bf16 v[184:187], a[188:191], v[132:135], v[184:187]
    v_mul_f32 v208, v208, v224
    v_exp_f32 v224, v212
    v_mfma_f32_16x16x32_bf16 v[172:175], a[0:3], v[128:131], v[172:175]
    v_add_f32 v227, 1.0, v227
    v_rcp_f32 v226, v226
    v_mfma_f32_16x16x32_bf16 v[188:191], a[0:3], v[132:135], v[188:191]
    v_mul_f32 v209, v209, v225
    v_cvt_pk_bf16_f32 v228, v208, v209
    v_exp_f32 v225, v213
    s_waitcnt vmcnt(57)
    v_add_f32 v224, 1.0, v224
    v_rcp_f32 v227, v227
    v_mfma_f32_16x16x32_bf16 v[160:163], a[4:7], v[136:139], v[160:163]
    v_add_u32 v247, 0x2000, v247
    global_load_dwordx4 a[240:243], v247, s[60:61] offset:-4096 sc1
    global_load_dwordx4 a[244:247], v247, s[60:61] offset:-3072 sc1
    v_mul_f32 v210, v210, v226
    v_exp_f32 v226, v214
    v_mfma_f32_16x16x32_bf16 v[176:179], a[4:7], v[140:143], v[176:179]
    v_add_f32 v225, 1.0, v225
    v_rcp_f32 v224, v224
    v_mfma_f32_16x16x32_bf16 v[164:167], a[8:11], v[136:139], v[164:167]
    v_mul_f32 v211, v211, v227
    v_cvt_pk_bf16_f32 v229, v210, v211
    v_mfma_f32_16x16x32_bf16 v[180:183], a[8:11], v[140:143], v[180:183]
    v_exp_f32 v227, v215
    v_add_f32 v226, 1.0, v226
    v_mfma_f32_16x16x32_bf16 v[168:171], a[12:15], v[136:139], v[168:171]
    v_rcp_f32 v225, v225
    v_mul_f32 v212, v212, v224
    v_mfma_f32_16x16x32_bf16 v[184:187], a[12:15], v[140:143], v[184:187]
    v_exp_f32 v224, v216
    v_add_f32 v227, 1.0, v227
    v_rcp_f32 v226, v226
    v_mfma_f32_16x16x32_bf16 v[172:175], a[16:19], v[136:139], v[172:175]
    global_load_dwordx4 v[48:51], v247, s[60:61] offset:-2048 sc1
    global_load_dwordx4 v[52:55], v247, s[60:61] offset:-1024 sc1
    v_mul_f32 v213, v213, v225
    v_cvt_pk_bf16_f32 v230, v212, v213
    v_mfma_f32_16x16x32_bf16 v[188:191], a[16:19], v[140:143], v[188:191]
    v_exp_f32 v225, v217
    v_add_f32 v224, 1.0, v224
    s_waitcnt vmcnt(57)
    v_rcp_f32 v227, v227
    v_mul_f32 v214, v214, v226
    v_mfma_f32_16x16x32_bf16 v[160:163], a[20:23], v[144:147], v[160:163]
    v_exp_f32 v226, v218
    v_add_f32 v225, 1.0, v225
    v_mfma_f32_16x16x32_bf16 v[176:179], a[20:23], v[148:151], v[176:179]
    v_rcp_f32 v224, v224
    v_mul_f32 v215, v215, v227
    v_mfma_f32_16x16x32_bf16 v[164:167], a[24:27], v[144:147], v[164:167]
    v_cvt_pk_bf16_f32 v231, v214, v215
    ds_write_b128 v13, v[228:231] offset:5120
    v_mfma_f32_16x16x32_bf16 v[180:183], a[24:27], v[148:151], v[180:183]
    global_load_dwordx4 v[56:59], v247, s[60:61] offset:0 sc1
    global_load_dwordx4 v[60:63], v247, s[60:61] offset:1024 sc1
    v_exp_f32 v227, v219
    v_add_f32 v226, 1.0, v226
    v_rcp_f32 v225, v225
    v_mfma_f32_16x16x32_bf16 v[168:171], a[28:31], v[144:147], v[168:171]
    v_mul_f32 v216, v216, v224
    v_exp_f32 v224, v220
    v_mfma_f32_16x16x32_bf16 v[184:187], a[28:31], v[148:151], v[184:187]
    v_add_f32 v227, 1.0, v227
    v_rcp_f32 v226, v226
    v_mfma_f32_16x16x32_bf16 v[172:175], a[32:35], v[144:147], v[172:175]
    v_mul_f32 v217, v217, v225
    v_cvt_pk_bf16_f32 v232, v216, v217
    v_mfma_f32_16x16x32_bf16 v[188:191], a[32:35], v[148:151], v[188:191]
    v_exp_f32 v225, v221
    v_add_f32 v224, 1.0, v224
    s_waitcnt vmcnt(55)
    v_rcp_f32 v227, v227
    v_mul_f32 v218, v218, v226
    v_mfma_f32_16x16x32_bf16 v[160:163], a[36:39], v[152:155], v[160:163]
    global_load_dwordx4 a[248:251], v247, s[60:61] offset:2048 sc1
    global_load_dwordx4 a[252:255], v247, s[60:61] offset:3072 sc1
    v_exp_f32 v226, v222
    v_add_f32 v225, 1.0, v225
    v_mfma_f32_16x16x32_bf16 v[176:179], a[36:39], v[156:159], v[176:179]
    v_rcp_f32 v224, v224
    v_mul_f32 v219, v219, v227
    v_cvt_pk_bf16_f32 v233, v218, v219
    v_mfma_f32_16x16x32_bf16 v[164:167], a[40:43], v[152:155], v[164:167]
    v_exp_f32 v227, v223
    v_add_f32 v226, 1.0, v226
    v_mfma_f32_16x16x32_bf16 v[180:183], a[40:43], v[156:159], v[180:183]
    v_rcp_f32 v225, v225
    v_mul_f32 v220, v220, v224
    v_mfma_f32_16x16x32_bf16 v[168:171], a[44:47], v[152:155], v[168:171]
    v_add_f32 v227, 1.0, v227
    v_rcp_f32 v226, v226
    v_mfma_f32_16x16x32_bf16 v[184:187], a[44:47], v[156:159], v[184:187]
    v_mul_f32 v221, v221, v225
    v_cvt_pk_bf16_f32 v234, v220, v221
    v_mfma_f32_16x16x32_bf16 v[172:175], a[48:51], v[152:155], v[172:175]
    v_add_u32 v247, 0x2000, v247
    global_load_dwordx4 a[160:163], v247, s[60:61] offset:-4096 sc1
    global_load_dwordx4 a[164:167], v247, s[60:61] offset:-3072 sc1
    v_rcp_f32 v227, v227
    v_mul_f32 v222, v222, v226
    v_mfma_f32_16x16x32_bf16 v[188:191], a[48:51], v[156:159], v[188:191]
    v_mul_f32 v223, v223, v227
    v_cvt_pk_bf16_f32 v235, v222, v223
    ds_write_b128 v13, v[232:235] offset:7168
    s_waitcnt vmcnt(55)
    v_mfma_f32_16x16x32_bf16 v[192:195], a[52:55], v[96:99], 0
    v_mfma_f32_16x16x32_bf16 v[208:211], a[52:55], v[100:103], 0
    v_mfma_f32_16x16x32_bf16 v[196:199], a[56:59], v[96:99], 0
    v_exp_f32 v224, v160
    v_exp_f32 v225, v161
    v_mfma_f32_16x16x32_bf16 v[212:215], a[56:59], v[100:103], 0
    v_add_f32 v224, 1.0, v224
    v_exp_f32 v226, v162
    v_mfma_f32_16x16x32_bf16 v[200:203], a[60:63], v[96:99], 0
    global_load_dwordx4 a[168:171], v247, s[60:61] offset:-2048 sc1
    global_load_dwordx4 a[172:175], v247, s[60:61] offset:-1024 sc1
    v_add_f32 v225, 1.0, v225
    v_rcp_f32 v224, v224
    v_mfma_f32_16x16x32_bf16 v[216:219], a[60:63], v[100:103], 0
    v_exp_f32 v227, v163
    v_add_f32 v226, 1.0, v226
    v_mfma_f32_16x16x32_bf16 v[204:207], a[64:67], v[96:99], 0
    v_rcp_f32 v225, v225
    v_mul_f32 v160, v160, v224
    v_mfma_f32_16x16x32_bf16 v[220:223], a[64:67], v[100:103], 0
    v_exp_f32 v224, v164
    v_add_f32 v227, 1.0, v227
    s_waitcnt vmcnt(53)
    v_rcp_f32 v226, v226
    v_mul_f32 v161, v161, v225
    v_cvt_pk_bf16_f32 v228, v160, v161
    v_mfma_f32_16x16x32_bf16 v[192:195], a[68:71], v[104:107], v[192:195]
    v_exp_f32 v225, v165
    v_add_f32 v224, 1.0, v224
    v_mfma_f32_16x16x32_bf16 v[208:211], a[68:71], v[108:111], v[208:211]
    global_load_dwordx4 a[176:179], v247, s[60:61] offset:0 sc1
    global_load_dwordx4 a[180:183], v247, s[60:61] offset:1024 sc1
    v_rcp_f32 v227, v227
    v_mul_f32 v162, v162, v226
    v_mfma_f32_16x16x32_bf16 v[196:199], a[72:75], v[104:107], v[196:199]
    v_exp_f32 v226, v166
    v_add_f32 v225, 1.0, v225
    v_mfma_f32_16x16x32_bf16 v[212:215], a[72:75], v[108:111], v[212:215]
    v_rcp_f32 v224, v224
    v_mul_f32 v163, v163, v227
    v_mfma_f32_16x16x32_bf16 v[200:203], a[76:79], v[104:107], v[200:203]
    v_cvt_pk_bf16_f32 v229, v162, v163
    v_exp_f32 v227, v167
    v_mfma_f32_16x16x32_bf16 v[216:219], a[76:79], v[108:111], v[216:219]
    v_add_f32 v226, 1.0, v226
    v_rcp_f32 v225, v225
    v_mfma_f32_16x16x32_bf16 v[204:207], a[80:83], v[104:107], v[204:207]
    v_mul_f32 v164, v164, v224
    v_exp_f32 v224, v168
    v_add_f32 v227, 1.0, v227
    v_mfma_f32_16x16x32_bf16 v[220:223], a[80:83], v[108:111], v[220:223]
    global_load_dwordx4 a[184:187], v247, s[60:61] offset:2048 sc1
    global_load_dwordx4 a[188:191], v247, s[60:61] offset:3072 sc1
    v_rcp_f32 v226, v226
    v_mul_f32 v165, v165, v225
    s_waitcnt vmcnt(53)
    v_cvt_pk_bf16_f32 v230, v164, v165
    v_exp_f32 v225, v169
    v_mfma_f32_16x16x32_bf16 v[192:195], a[84:87], v[112:115], v[192:195]
    v_add_f32 v224, 1.0, v224
    v_rcp_f32 v227, v227
    v_mfma_f32_16x16x32_bf16 v[208:211], a[84:87], v[116:119], v[208:211]
    v_mul_f32 v166, v166, v226
    v_exp_f32 v226, v170
    v_mfma_f32_16x16x32_bf16 v[196:199], a[88:91], v[112:115], v[196:199]
    v_add_f32 v225, 1.0, v225
    v_rcp_f32 v224, v224
    v_mfma_f32_16x16x32_bf16 v[212:215], a[88:91], v[116:119], v[212:215]
    v_mul_f32 v167, v167, v227
    v_cvt_pk_bf16_f32 v231, v166, v167
    v_mfma_f32_16x16x32_bf16 v[200:203], a[92:95], v[112:115], v[200:203]
    v_add_u32 v247, 0x2000, v247
    global_load_dwordx4 a[0:3], v247, s[60:61] offset:-4096 sc1
    global_load_dwordx4 a[4:7], v247, s[60:61] offset:-3072 sc1
    ds_write_b128 v13, v[228:231] offset:8192
    v_exp_f32 v227, v171
    v_add_f32 v226, 1.0, v226
    v_mfma_f32_16x16x32_bf16 v[216:219], a[92:95], v[116:119], v[216:219]
    v_rcp_f32 v225, v225
    v_mul_f32 v168, v168, v224
    v_mfma_f32_16x16x32_bf16 v[204:207], a[192:195], v[112:115], v[204:207]
    v_exp_f32 v224, v172
    v_add_f32 v227, 1.0, v227
    v_mfma_f32_16x16x32_bf16 v[220:223], a[192:195], v[116:119], v[220:223]
    v_rcp_f32 v226, v226
    v_mul_f32 v169, v169, v225
    s_waitcnt vmcnt(51)
    v_cvt_pk_bf16_f32 v232, v168, v169
    v_exp_f32 v225, v173
    v_mfma_f32_16x16x32_bf16 v[192:195], a[196:199], v[120:123], v[192:195]
    v_add_f32 v224, 1.0, v224
    v_rcp_f32 v227, v227
    v_mfma_f32_16x16x32_bf16 v[208:211], a[196:199], v[124:127], v[208:211]
    global_load_dwordx4 a[8:11], v247, s[60:61] offset:-2048 sc1
    global_load_dwordx4 a[12:15], v247, s[60:61] offset:-1024 sc1
    v_mul_f32 v170, v170, v226
    v_exp_f32 v226, v174
    v_mfma_f32_16x16x32_bf16 v[196:199], a[200:203], v[120:123], v[196:199]
    v_add_f32 v225, 1.0, v225
    v_rcp_f32 v224, v224
    v_mul_f32 v171, v171, v227
    v_mfma_f32_16x16x32_bf16 v[212:215], a[200:203], v[124:127], v[212:215]
    v_cvt_pk_bf16_f32 v233, v170, v171
    v_exp_f32 v227, v175
    v_mfma_f32_16x16x32_bf16 v[200:203], a[204:207], v[120:123], v[200:203]
    v_add_f32 v226, 1.0, v226
    v_rcp_f32 v225, v225
    v_mfma_f32_16x16x32_bf16 v[216:219], a[204:207], v[124:127], v[216:219]
    v_mul_f32 v172, v172, v224
    v_exp_f32 v224, v176
    v_mfma_f32_16x16x32_bf16 v[204:207], a[224:227], v[120:123], v[204:207]
    global_load_dwordx4 a[16:19], v247, s[60:61] offset:0 sc1
    global_load_dwordx4 a[20:23], v247, s[60:61] offset:1024 sc1
    v_add_f32 v227, 1.0, v227
    v_rcp_f32 v226, v226
    v_mfma_f32_16x16x32_bf16 v[220:223], a[224:227], v[124:127], v[220:223]
    v_mul_f32 v173, v173, v225
    v_cvt_pk_bf16_f32 v234, v172, v173
    s_waitcnt vmcnt(51)
    v_exp_f32 v225, v177
    v_add_f32 v224, 1.0, v224
    v_mfma_f32_16x16x32_bf16 v[192:195], a[228:231], v[128:131], v[192:195]
    v_rcp_f32 v227, v227
    v_mul_f32 v174, v174, v226
    v_exp_f32 v226, v178
    v_mfma_f32_16x16x32_bf16 v[208:211], a[228:231], v[132:135], v[208:211]
    v_add_f32 v225, 1.0, v225
    v_rcp_f32 v224, v224
    v_mfma_f32_16x16x32_bf16 v[196:199], a[232:235], v[128:131], v[196:199]
    v_mul_f32 v175, v175, v227
    v_cvt_pk_bf16_f32 v235, v174, v175
    v_mfma_f32_16x16x32_bf16 v[212:215], a[232:235], v[132:135], v[212:215]
    ds_write_b128 v13, v[232:235] offset:10240
    v_exp_f32 v227, v179
    v_mfma_f32_16x16x32_bf16 v[200:203], a[236:239], v[128:131], v[200:203]
    global_load_dwordx4 a[24:27], v247, s[60:61] offset:2048 sc1
    global_load_dwordx4 a[28:31], v247, s[60:61] offset:3072 sc1
    v_add_f32 v226, 1.0, v226
    v_rcp_f32 v225, v225
    v_mfma_f32_16x16x32_bf16 v[216:219], a[236:239], v[132:135], v[216:219]
    v_mul_f32 v176, v176, v224
    v_exp_f32 v224, v180
    v_mfma_f32_16x16x32_bf16 v[204:207], v[80:83], v[128:131], v[204:207]
    v_add_f32 v227, 1.0, v227
    v_rcp_f32 v226, v226
    v_mfma_f32_16x16x32_bf16 v[220:223], v[80:83], v[132:135], v[220:223]
    v_mul_f32 v177, v177, v225
    v_cvt_pk_bf16_f32 v228, v176, v177
    v_exp_f32 v225, v181
    s_waitcnt vmcnt(49)
    v_add_f32 v224, 1.0, v224
    v_rcp_f32 v227, v227
    v_mfma_f32_16x16x32_bf16 v[192:195], v[84:87], v[136:139], v[192:195]
    v_mul_f32 v178, v178, v226
    v_exp_f32 v226, v182
    v_mfma_f32_16x16x32_bf16 v[208:211], v[84:87], v[140:143], v[208:211]
    v_add_u32 v247, 0x2000, v247
    global_load_dwordx4 a[32:35], v247, s[60:61] offset:-4096 sc1
    global_load_dwordx4 a[36:39], v247, s[60:61] offset:-3072 sc1
    v_add_f32 v225, 1.0, v225
    v_rcp_f32 v224, v224
    v_mfma_f32_16x16x32_bf16 v[196:199], v[88:91], v[136:139], v[196:199]
    v_mul_f32 v179, v179, v227
    v_cvt_pk_bf16_f32 v229, v178, v179
    v_mfma_f32_16x16x32_bf16 v[212:215], v[88:91], v[140:143], v[212:215]
    v_exp_f32 v227, v183
    v_add_f32 v226, 1.0, v226
    v_mfma_f32_16x16x32_bf16 v[200:203], v[92:95], v[136:139], v[200:203]
    v_rcp_f32 v225, v225
    v_mul_f32 v180, v180, v224
    v_mfma_f32_16x16x32_bf16 v[216:219], v[92:95], v[140:143], v[216:219]
    v_exp_f32 v224, v184
    v_add_f32 v227, 1.0, v227
    v_rcp_f32 v226, v226
    v_mfma_f32_16x16x32_bf16 v[204:207], v[248:251], v[136:139], v[204:207]
    global_load_dwordx4 a[40:43], v247, s[60:61] offset:-2048 sc1
    global_load_dwordx4 a[44:47], v247, s[60:61] offset:-1024 sc1
    v_mul_f32 v181, v181, v225
    v_cvt_pk_bf16_f32 v230, v180, v181
    v_mfma_f32_16x16x32_bf16 v[220:223], v[248:251], v[140:143], v[220:223]
    v_exp_f32 v225, v185
    v_add_f32 v224, 1.0, v224
    s_waitcnt vmcnt(49)
    v_rcp_f32 v227, v227
    v_mul_f32 v182, v182, v226
    v_mfma_f32_16x16x32_bf16 v[192:195], v[252:255], v[144:147], v[192:195]
    v_exp_f32 v226, v186
    v_add_f32 v225, 1.0, v225
    v_mfma_f32_16x16x32_bf16 v[208:211], v[252:255], v[148:151], v[208:211]
    v_rcp_f32 v224, v224
    v_mul_f32 v183, v183, v227
    v_mfma_f32_16x16x32_bf16 v[196:199], a[96:99], v[144:147], v[196:199]
    v_cvt_pk_bf16_f32 v231, v182, v183
    ds_write_b128 v13, v[228:231] offset:9216
    v_mfma_f32_16x16x32_bf16 v[212:215], a[96:99], v[148:151], v[212:215]
    v_exp_f32 v227, v187
    v_add_f32 v226, 1.0, v226
    v_rcp_f32 v225, v225
    v_mfma_f32_16x16x32_bf16 v[200:203], a[100:103], v[144:147], v[200:203]
    global_load_dwordx4 a[48:51], v247, s[60:61] offset:0 sc1
    global_load_dwordx4 a[52:55], v247, s[60:61] offset:1024 sc1
    v_mul_f32 v184, v184, v224
    v_exp_f32 v224, v188
    v_mfma_f32_16x16x32_bf16 v[216:219], a[100:103], v[148:151], v[216:219]
    v_add_f32 v227, 1.0, v227
    v_rcp_f32 v226, v226
    v_mfma_f32_16x16x32_bf16 v[204:207], a[104:107], v[144:147], v[204:207]
    v_mul_f32 v185, v185, v225
    v_cvt_pk_bf16_f32 v232, v184, v185
    v_mfma_f32_16x16x32_bf16 v[220:223], a[104:107], v[148:151], v[220:223]
    v_exp_f32 v225, v189
    v_add_f32 v224, 1.0, v224
    s_waitcnt vmcnt(47)
    v_rcp_f32 v227, v227
    v_mul_f32 v186, v186, v226
    v_mfma_f32_16x16x32_bf16 v[192:195], a[108:111], v[152:155], v[192:195]
    v_exp_f32 v226, v190
    v_add_f32 v225, 1.0, v225
    v_mfma_f32_16x16x32_bf16 v[208:211], a[108:111], v[156:159], v[208:211]
    global_load_dwordx4 a[56:59], v247, s[60:61] offset:2048 sc1
    global_load_dwordx4 a[60:63], v247, s[60:61] offset:3072 sc1
    v_rcp_f32 v224, v224
    v_mul_f32 v187, v187, v227
    v_cvt_pk_bf16_f32 v233, v186, v187
    v_mfma_f32_16x16x32_bf16 v[196:199], a[112:115], v[152:155], v[196:199]
    v_exp_f32 v227, v191
    v_add_f32 v226, 1.0, v226
    v_mfma_f32_16x16x32_bf16 v[212:215], a[112:115], v[156:159], v[212:215]
    v_rcp_f32 v225, v225
    v_mul_f32 v188, v188, v224
    v_mfma_f32_16x16x32_bf16 v[200:203], a[116:119], v[152:155], v[200:203]
    v_add_f32 v227, 1.0, v227
    v_rcp_f32 v226, v226
    v_mfma_f32_16x16x32_bf16 v[216:219], a[116:119], v[156:159], v[216:219]
    v_mul_f32 v189, v189, v225
    v_cvt_pk_bf16_f32 v234, v188, v189
    v_mfma_f32_16x16x32_bf16 v[204:207], a[120:123], v[152:155], v[204:207]
    v_rcp_f32 v227, v227
    v_mul_f32 v190, v190, v226
    v_mfma_f32_16x16x32_bf16 v[220:223], a[120:123], v[156:159], v[220:223]
    v_add_u32 v247, 0x2000, v247
    global_load_dwordx4 a[64:67], v247, s[60:61] offset:-4096 sc1
    global_load_dwordx4 a[68:71], v247, s[60:61] offset:-3072 sc1
    v_mul_f32 v191, v191, v227
    v_cvt_pk_bf16_f32 v235, v190, v191
    ds_write_b128 v13, v[232:235] offset:11264
    v_exp_f32 v224, v192
    v_exp_f32 v225, v193
    v_add_f32 v224, 1.0, v224
    v_exp_f32 v226, v194
    v_add_f32 v225, 1.0, v225
    v_rcp_f32 v224, v224
    v_exp_f32 v227, v195
    v_add_f32 v226, 1.0, v226
    v_rcp_f32 v225, v225
    v_mul_f32 v192, v192, v224
    v_exp_f32 v224, v196
    v_add_f32 v227, 1.0, v227
    v_rcp_f32 v226, v226
    v_mul_f32 v193, v193, v225
    v_cvt_pk_bf16_f32 v228, v192, v193
    global_load_dwordx4 a[72:75], v247, s[60:61] offset:-2048 sc1
    global_load_dwordx4 a[76:79], v247, s[60:61] offset:-1024 sc1
    v_exp_f32 v225, v197
    v_add_f32 v224, 1.0, v224
    v_rcp_f32 v227, v227
    v_mul_f32 v194, v194, v226
    v_exp_f32 v226, v198
    v_add_f32 v225, 1.0, v225
    v_rcp_f32 v224, v224
    v_mul_f32 v195, v195, v227
    v_cvt_pk_bf16_f32 v229, v194, v195
    v_exp_f32 v227, v199
    v_add_f32 v226, 1.0, v226
    v_rcp_f32 v225, v225
    v_mul_f32 v196, v196, v224
    v_exp_f32 v224, v200
    v_add_f32 v227, 1.0, v227
    v_rcp_f32 v226, v226
    v_mul_f32 v197, v197, v225
    v_cvt_pk_bf16_f32 v230, v196, v197
    v_exp_f32 v225, v201
    global_load_dwordx4 a[80:83], v247, s[60:61] offset:0 sc1
    global_load_dwordx4 a[84:87], v247, s[60:61] offset:1024 sc1
    v_add_f32 v224, 1.0, v224
    v_rcp_f32 v227, v227
    v_mul_f32 v198, v198, v226
    v_exp_f32 v226, v202
    v_add_f32 v225, 1.0, v225
    v_rcp_f32 v224, v224
    v_mul_f32 v199, v199, v227
    v_cvt_pk_bf16_f32 v231, v198, v199
    ds_write_b128 v13, v[228:231] offset:12288
    v_exp_f32 v227, v203
    v_add_f32 v226, 1.0, v226
    v_rcp_f32 v225, v225
    v_mul_f32 v200, v200, v224
    v_exp_f32 v224, v204
    v_add_f32 v227, 1.0, v227
    v_rcp_f32 v226, v226
    v_mul_f32 v201, v201, v225
    v_cvt_pk_bf16_f32 v232, v200, v201
    v_exp_f32 v225, v205
    v_add_f32 v224, 1.0, v224
    global_load_dwordx4 a[88:91], v247, s[60:61] offset:2048 sc1
    global_load_dwordx4 a[92:95], v247, s[60:61] offset:3072 sc1
    v_rcp_f32 v227, v227
    v_mul_f32 v202, v202, v226
    v_exp_f32 v226, v206
    v_add_f32 v225, 1.0, v225
    v_rcp_f32 v224, v224
    v_mul_f32 v203, v203, v227
    v_cvt_pk_bf16_f32 v233, v202, v203
    v_exp_f32 v227, v207
    v_add_f32 v226, 1.0, v226
    v_rcp_f32 v225, v225
    v_mul_f32 v204, v204, v224
    v_exp_f32 v224, v208
    v_add_f32 v227, 1.0, v227
    v_rcp_f32 v226, v226
    v_mul_f32 v205, v205, v225
    v_cvt_pk_bf16_f32 v234, v204, v205
    v_exp_f32 v225, v209
    v_add_f32 v224, 1.0, v224
    v_rcp_f32 v227, v227
    v_add_u32 v247, 0x2000, v247
    global_load_dwordx4 a[192:195], v247, s[60:61] offset:-4096 sc1
    global_load_dwordx4 a[196:199], v247, s[60:61] offset:-3072 sc1
    v_mul_f32 v206, v206, v226
    v_exp_f32 v226, v210
    v_add_f32 v225, 1.0, v225
    v_rcp_f32 v224, v224
    v_mul_f32 v207, v207, v227
    v_cvt_pk_bf16_f32 v235, v206, v207
    ds_write_b128 v13, v[232:235] offset:14336
    v_exp_f32 v227, v211
    v_add_f32 v226, 1.0, v226
    v_rcp_f32 v225, v225
    v_mul_f32 v208, v208, v224
    v_exp_f32 v224, v212
    v_add_f32 v227, 1.0, v227
    v_rcp_f32 v226, v226
    v_mul_f32 v209, v209, v225
    v_cvt_pk_bf16_f32 v228, v208, v209
    v_exp_f32 v225, v213
    v_add_f32 v224, 1.0, v224
    v_rcp_f32 v227, v227
    global_load_dwordx4 a[200:203], v247, s[60:61] offset:-2048 sc1
    global_load_dwordx4 a[204:207], v247, s[60:61] offset:-1024 sc1
    v_mul_f32 v210, v210, v226
    v_exp_f32 v226, v214
    v_add_f32 v225, 1.0, v225
    v_rcp_f32 v224, v224
    v_mul_f32 v211, v211, v227
    v_cvt_pk_bf16_f32 v229, v210, v211
    v_exp_f32 v227, v215
    v_add_f32 v226, 1.0, v226
    v_rcp_f32 v225, v225
    v_mul_f32 v212, v212, v224
    v_exp_f32 v224, v216
    v_add_f32 v227, 1.0, v227
    v_rcp_f32 v226, v226
    v_mul_f32 v213, v213, v225
    v_cvt_pk_bf16_f32 v230, v212, v213
    v_exp_f32 v225, v217
    v_add_f32 v224, 1.0, v224
    v_rcp_f32 v227, v227
    v_mul_f32 v214, v214, v226
    v_exp_f32 v226, v218
    global_load_dwordx4 a[224:227], v247, s[60:61] offset:0 sc1
    s_waitcnt vmcnt(40)
    global_load_dwordx4 a[228:231], v247, s[60:61] offset:1024 sc1
    v_add_f32 v225, 1.0, v225
    v_rcp_f32 v224, v224
    v_mul_f32 v215, v215, v227
    v_cvt_pk_bf16_f32 v231, v214, v215
    ds_write_b128 v13, v[228:231] offset:13312
    v_exp_f32 v227, v219
    v_add_f32 v226, 1.0, v226
    v_rcp_f32 v225, v225
    v_mul_f32 v216, v216, v224
    v_exp_f32 v224, v220
    v_add_f32 v227, 1.0, v227
    v_rcp_f32 v226, v226
    v_mul_f32 v217, v217, v225
    v_cvt_pk_bf16_f32 v232, v216, v217
    v_exp_f32 v225, v221
    v_add_f32 v224, 1.0, v224
    v_rcp_f32 v227, v227
    v_mul_f32 v218, v218, v226
    v_exp_f32 v226, v222
    global_load_dwordx4 a[232:235], v247, s[60:61] offset:2048 sc1
    global_load_dwordx4 a[236:239], v247, s[60:61] offset:3072 sc1
    v_add_f32 v225, 1.0, v225
    v_rcp_f32 v224, v224
    v_mul_f32 v219, v219, v227
    v_cvt_pk_bf16_f32 v233, v218, v219
    v_exp_f32 v227, v223
    v_add_f32 v226, 1.0, v226
    v_rcp_f32 v225, v225
    v_mul_f32 v220, v220, v224
    v_add_f32 v227, 1.0, v227
    v_rcp_f32 v226, v226
    v_mul_f32 v221, v221, v225
    v_cvt_pk_bf16_f32 v234, v220, v221
    v_rcp_f32 v227, v227
    v_mul_f32 v222, v222, v226
    v_mul_f32 v223, v223, v227
    v_cvt_pk_bf16_f32 v235, v222, v223
    ds_write_b128 v13, v[232:235] offset:15360
    v_add_u32 v240, 83968, v7
    s_waitcnt lgkmcnt(0)
    s_barrier
    v_add_u32 v247, 0x2000, v247
    global_load_dwordx4 v[80:83], v247, s[60:61] offset:-4096 sc1
    global_load_dwordx4 v[84:87], v247, s[60:61] offset:-3072 sc1
    ds_read_b128 v[96:99], v240 offset:0
    ds_read_b128 v[100:103], v240 offset:1024
    ds_read_b128 v[104:107], v240 offset:2048
    ds_read_b128 v[108:111], v240 offset:3072
    ds_read_b128 v[112:115], v240 offset:4096
    ds_read_b128 v[116:119], v240 offset:5120
    s_waitcnt lgkmcnt(5)
    v_mfma_f32_16x16x32_bf16 v[16:19], a[124:127], v[96:99], v[16:19]
    global_load_dwordx4 v[88:91], v247, s[60:61] offset:-2048 sc1
    global_load_dwordx4 v[92:95], v247, s[60:61] offset:-1024 sc1
    ds_read_b128 v[120:123], v240 offset:6144
    ds_read_b128 v[124:127], v240 offset:7168
    s_waitcnt lgkmcnt(6)
    v_mfma_f32_16x16x32_bf16 v[32:35], a[124:127], v[100:103], v[32:35]
    v_mfma_f32_16x16x32_bf16 v[20:23], a[208:211], v[96:99], v[20:23]
    v_mfma_f32_16x16x32_bf16 v[36:39], a[208:211], v[100:103], v[36:39]
    v_mfma_f32_16x16x32_bf16 v[24:27], a[212:215], v[96:99], v[24:27]
    global_load_dwordx4 v[248:251], v247, s[60:61] offset:0 sc1
    global_load_dwordx4 v[252:255], v247, s[60:61] offset:1024 sc1
    v_mfma_f32_16x16x32_bf16 v[40:43], a[212:215], v[100:103], v[40:43]
    v_mfma_f32_16x16x32_bf16 v[28:31], a[216:219], v[96:99], v[28:31]
    v_mfma_f32_16x16x32_bf16 v[44:47], a[216:219], v[100:103], v[44:47]
    s_waitcnt lgkmcnt(5)
    v_mfma_f32_16x16x32_bf16 v[16:19], a[220:223], v[104:107], v[16:19]
    ds_read_b128 v[128:131], v240 offset:8192
    ds_read_b128 v[132:135], v240 offset:9216
    s_waitcnt lgkmcnt(6)
    v_mfma_f32_16x16x32_bf16 v[32:35], a[220:223], v[108:111], v[32:35]
    v_mfma_f32_16x16x32_bf16 v[20:23], a[128:131], v[104:107], v[20:23]
    v_mfma_f32_16x16x32_bf16 v[36:39], a[128:131], v[108:111], v[36:39]
    v_mfma_f32_16x16x32_bf16 v[24:27], a[132:135], v[104:107], v[24:27]
    global_load_dwordx4 a[96:99], v247, s[60:61] offset:2048 sc1
    global_load_dwordx4 a[100:103], v247, s[60:61] offset:3072 sc1
    v_mfma_f32_16x16x32_bf16 v[40:43], a[132:135], v[108:111], v[40:43]
    v_mfma_f32_16x16x32_bf16 v[28:31], a[136:139], v[104:107], v[28:31]
    v_mfma_f32_16x16x32_bf16 v[44:47], a[136:139], v[108:111], v[44:47]
    s_waitcnt lgkmcnt(5)
    v_mfma_f32_16x16x32_bf16 v[16:19], a[140:143], v[112:115], v[16:19]
    ds_read_b128 v[136:139], v240 offset:10240
    ds_read_b128 v[140:143], v240 offset:11264
    s_waitcnt lgkmcnt(6)
    v_mfma_f32_16x16x32_bf16 v[32:35], a[140:143], v[116:119], v[32:35]
    v_mfma_f32_16x16x32_bf16 v[20:23], a[144:147], v[112:115], v[20:23]
    v_mfma_f32_16x16x32_bf16 v[36:39], a[144:147], v[116:119], v[36:39]
    v_mfma_f32_16x16x32_bf16 v[24:27], a[148:151], v[112:115], v[24:27]
    v_add_u32 v247, 0x2000, v247
    global_load_dwordx4 a[104:107], v247, s[60:61] offset:-4096 sc1
    global_load_dwordx4 a[108:111], v247, s[60:61] offset:-3072 sc1
    v_mfma_f32_16x16x32_bf16 v[40:43], a[148:151], v[116:119], v[40:43]
    v_mfma_f32_16x16x32_bf16 v[28:31], v[64:67], v[112:115], v[28:31]
    v_mfma_f32_16x16x32_bf16 v[44:47], v[64:67], v[116:119], v[44:47]
    s_waitcnt lgkmcnt(5)
    v_mfma_f32_16x16x32_bf16 v[16:19], v[68:71], v[120:123], v[16:19]
    ds_read_b128 v[144:147], v240 offset:12288
    ds_read_b128 v[148:151], v240 offset:13312
    s_waitcnt lgkmcnt(6)
    v_mfma_f32_16x16x32_bf16 v[32:35], v[68:71], v[124:127], v[32:35]
    v_mfma_f32_16x16x32_bf16 v[20:23], v[72:75], v[120:123], v[20:23]
    v_mfma_f32_16x16x32_bf16 v[36:39], v[72:75], v[124:127], v[36:39]
    v_mfma_f32_16x16x32_bf16 v[24:27], v[76:79], v[120:123], v[24:27]
    global_load_dwordx4 a[112:115], v247, s[60:61] offset:-2048 sc1
    global_load_dwordx4 a[116:119], v247, s[60:61] offset:-1024 sc1
    v_mfma_f32_16x16x32_bf16 v[40:43], v[76:79], v[124:127], v[40:43]
    v_mfma_f32_16x16x32_bf16 v[28:31], a[152:155], v[120:123], v[28:31]
    v_mfma_f32_16x16x32_bf16 v[44:47], a[152:155], v[124:127], v[44:47]
    s_waitcnt lgkmcnt(5)
    v_mfma_f32_16x16x32_bf16 v[16:19], a[156:159], v[128:131], v[16:19]
    ds_read_b128 v[152:155], v240 offset:14336
    ds_read_b128 v[156:159], v240 offset:15360
    s_waitcnt lgkmcnt(6)
    v_mfma_f32_16x16x32_bf16 v[32:35], a[156:159], v[132:135], v[32:35]
    v_mfma_f32_16x16x32_bf16 v[20:23], a[240:243], v[128:131], v[20:23]
    v_mfma_f32_16x16x32_bf16 v[36:39], a[240:243], v[132:135], v[36:39]
    v_mfma_f32_16x16x32_bf16 v[24:27], a[244:247], v[128:131], v[24:27]
    global_load_dwordx4 a[120:123], v247, s[60:61] offset:0 sc1
    global_load_dwordx4 a[124:127], v247, s[60:61] offset:1024 sc1
    v_mfma_f32_16x16x32_bf16 v[40:43], a[244:247], v[132:135], v[40:43]
    v_mfma_f32_16x16x32_bf16 v[28:31], v[48:51], v[128:131], v[28:31]
    v_mfma_f32_16x16x32_bf16 v[44:47], v[48:51], v[132:135], v[44:47]
    s_waitcnt vmcnt(55)
    s_waitcnt lgkmcnt(5)
    v_mfma_f32_16x16x32_bf16 v[16:19], v[52:55], v[136:139], v[16:19]
    ds_read_b128 v[96:99], v240 offset:16384
    ds_read_b128 v[100:103], v240 offset:17408
    s_waitcnt lgkmcnt(6)
    v_mfma_f32_16x16x32_bf16 v[32:35], v[52:55], v[140:143], v[32:35]
    v_mfma_f32_16x16x32_bf16 v[20:23], v[56:59], v[136:139], v[20:23]
    v_mfma_f32_16x16x32_bf16 v[36:39], v[56:59], v[140:143], v[36:39]
    v_mfma_f32_16x16x32_bf16 v[24:27], v[60:63], v[136:139], v[24:27]
    global_load_dwordx4 a[208:211], v247, s[60:61] offset:2048 sc1
    global_load_dwordx4 a[212:215], v247, s[60:61] offset:3072 sc1
    v_mfma_f32_16x16x32_bf16 v[40:43], v[60:63], v[140:143], v[40:43]
    v_mfma_f32_16x16x32_bf16 v[28:31], a[248:251], v[136:139], v[28:31]
    v_mfma_f32_16x16x32_bf16 v[44:47], a[248:251], v[140:143], v[44:47]
    s_waitcnt vmcnt(53)
    s_waitcnt lgkmcnt(5)
    v_mfma_f32_16x16x32_bf16 v[16:19], a[252:255], v[144:147], v[16:19]
    ds_read_b128 v[104:107], v240 offset:18432
    ds_read_b128 v[108:111], v240 offset:19456
    s_waitcnt lgkmcnt(6)
    v_mfma_f32_16x16x32_bf16 v[32:35], a[252:255], v[148:151], v[32:35]
    v_mfma_f32_16x16x32_bf16 v[20:23], a[160:163], v[144:147], v[20:23]
    v_mfma_f32_16x16x32_bf16 v[36:39], a[160:163], v[148:151], v[36:39]
    v_mfma_f32_16x16x32_bf16 v[24:27], a[164:167], v[144:147], v[24:27]
    v_add_u32 v247, 0x2000, v247
    global_load_dwordx4 a[216:219], v247, s[60:61] offset:-4096 sc1
    global_load_dwordx4 a[220:223], v247, s[60:61] offset:-3072 sc1
    v_mfma_f32_16x16x32_bf16 v[40:43], a[164:167], v[148:151], v[40:43]
    v_mfma_f32_16x16x32_bf16 v[28:31], a[168:171], v[144:147], v[28:31]
    v_mfma_f32_16x16x32_bf16 v[44:47], a[168:171], v[148:151], v[44:47]
    s_waitcnt vmcnt(51)
    s_waitcnt lgkmcnt(5)
    v_mfma_f32_16x16x32_bf16 v[16:19], a[172:175], v[152:155], v[16:19]
    ds_read_b128 v[112:115], v240 offset:20480
    ds_read_b128 v[116:119], v240 offset:21504
    s_waitcnt lgkmcnt(6)
    v_mfma_f32_16x16x32_bf16 v[32:35], a[172:175], v[156:159], v[32:35]
    v_mfma_f32_16x16x32_bf16 v[20:23], a[176:179], v[152:155], v[20:23]
    v_mfma_f32_16x16x32_bf16 v[36:39], a[176:179], v[156:159], v[36:39]
    v_mfma_f32_16x16x32_bf16 v[24:27], a[180:183], v[152:155], v[24:27]
    global_load_dwordx4 a[128:131], v247, s[60:61] offset:-2048 sc1
    global_load_dwordx4 a[132:135], v247, s[60:61] offset:-1024 sc1
    v_mfma_f32_16x16x32_bf16 v[40:43], a[180:183], v[156:159], v[40:43]
    v_mfma_f32_16x16x32_bf16 v[28:31], a[184:187], v[152:155], v[28:31]
    v_mfma_f32_16x16x32_bf16 v[44:47], a[184:187], v[156:159], v[44:47]
    s_waitcnt vmcnt(49)
    s_waitcnt lgkmcnt(5)
    v_mfma_f32_16x16x32_bf16 v[16:19], a[188:191], v[96:99], v[16:19]
    ds_read_b128 v[120:123], v240 offset:22528
    ds_read_b128 v[124:127], v240 offset:23552
    s_waitcnt lgkmcnt(6)
    v_mfma_f32_16x16x32_bf16 v[32:35], a[188:191], v[100:103], v[32:35]
    v_mfma_f32_16x16x32_bf16 v[20:23], a[0:3], v[96:99], v[20:23]
    v_mfma_f32_16x16x32_bf16 v[36:39], a[0:3], v[100:103], v[36:39]
    v_mfma_f32_16x16x32_bf16 v[24:27], a[4:7], v[96:99], v[24:27]
    global_load_dwordx4 a[136:139], v247, s[60:61] offset:0 sc1
    global_load_dwordx4 a[140:143], v247, s[60:61] offset:1024 sc1
    v_mfma_f32_16x16x32_bf16 v[40:43], a[4:7], v[100:103], v[40:43]
    v_mfma_f32_16x16x32_bf16 v[28:31], a[8:11], v[96:99], v[28:31]
    v_mfma_f32_16x16x32_bf16 v[44:47], a[8:11], v[100:103], v[44:47]
    s_waitcnt vmcnt(47)
    s_waitcnt lgkmcnt(5)
    v_mfma_f32_16x16x32_bf16 v[16:19], a[12:15], v[104:107], v[16:19]
    ds_read_b128 v[128:131], v240 offset:24576
    ds_read_b128 v[132:135], v240 offset:25600
    s_waitcnt lgkmcnt(6)
    v_mfma_f32_16x16x32_bf16 v[32:35], a[12:15], v[108:111], v[32:35]
    v_mfma_f32_16x16x32_bf16 v[20:23], a[16:19], v[104:107], v[20:23]
    v_mfma_f32_16x16x32_bf16 v[36:39], a[16:19], v[108:111], v[36:39]
    v_mfma_f32_16x16x32_bf16 v[24:27], a[20:23], v[104:107], v[24:27]
    global_load_dwordx4 a[144:147], v247, s[60:61] offset:2048 sc1
    global_load_dwordx4 a[148:151], v247, s[60:61] offset:3072 sc1
    v_mfma_f32_16x16x32_bf16 v[40:43], a[20:23], v[108:111], v[40:43]
    v_mfma_f32_16x16x32_bf16 v[28:31], a[24:27], v[104:107], v[28:31]
    v_mfma_f32_16x16x32_bf16 v[44:47], a[24:27], v[108:111], v[44:47]
    s_waitcnt vmcnt(45)
    s_waitcnt lgkmcnt(5)
    v_mfma_f32_16x16x32_bf16 v[16:19], a[28:31], v[112:115], v[16:19]
    ds_read_b128 v[136:139], v240 offset:26624
    ds_read_b128 v[140:143], v240 offset:27648
    s_waitcnt lgkmcnt(6)
    v_mfma_f32_16x16x32_bf16 v[32:35], a[28:31], v[116:119], v[32:35]
    v_mfma_f32_16x16x32_bf16 v[20:23], a[32:35], v[112:115], v[20:23]
    v_mfma_f32_16x16x32_bf16 v[36:39], a[32:35], v[116:119], v[36:39]
    v_mfma_f32_16x16x32_bf16 v[24:27], a[36:39], v[112:115], v[24:27]
    v_add_u32 v247, 0x2000, v247
    global_load_dwordx4 v[64:67], v247, s[60:61] offset:-4096 sc1
    global_load_dwordx4 v[68:71], v247, s[60:61] offset:-3072 sc1
    v_mfma_f32_16x16x32_bf16 v[40:43], a[36:39], v[116:119], v[40:43]
    v_mfma_f32_16x16x32_bf16 v[28:31], a[40:43], v[112:115], v[28:31]
    v_mfma_f32_16x16x32_bf16 v[44:47], a[40:43], v[116:119], v[44:47]
    s_waitcnt vmcnt(43)
    s_waitcnt lgkmcnt(5)
    v_mfma_f32_16x16x32_bf16 v[16:19], a[44:47], v[120:123], v[16:19]
    ds_read_b128 v[144:147], v240 offset:28672
    ds_read_b128 v[148:151], v240 offset:29696
    s_waitcnt lgkmcnt(6)
    v_mfma_f32_16x16x32_bf16 v[32:35], a[44:47], v[124:127], v[32:35]
    v_mfma_f32_16x16x32_bf16 v[20:23], a[48:51], v[120:123], v[20:23]
    v_mfma_f32_16x16x32_bf16 v[36:39], a[48:51], v[124:127], v[36:39]
    global_load_dwordx4 v[72:75], v247, s[60:61] offset:-2048 sc1
    global_load_dwordx4 v[76:79], v247, s[60:61] offset:-1024 sc1
    v_mfma_f32_16x16x32_bf16 v[24:27], a[52:55], v[120:123], v[24:27]
    v_mfma_f32_16x16x32_bf16 v[40:43], a[52:55], v[124:127], v[40:43]
    v_mfma_f32_16x16x32_bf16 v[28:31], a[56:59], v[120:123], v[28:31]
    v_mfma_f32_16x16x32_bf16 v[44:47], a[56:59], v[124:127], v[44:47]
    s_waitcnt vmcnt(41)
    s_waitcnt lgkmcnt(5)
    v_mfma_f32_16x16x32_bf16 v[16:19], a[60:63], v[128:131], v[16:19]
    ds_read_b128 v[152:155], v240 offset:30720
    ds_read_b128 v[156:159], v240 offset:31744
    s_waitcnt lgkmcnt(6)
    v_mfma_f32_16x16x32_bf16 v[32:35], a[60:63], v[132:135], v[32:35]
    v_mfma_f32_16x16x32_bf16 v[20:23], a[64:67], v[128:131], v[20:23]
    v_mfma_f32_16x16x32_bf16 v[36:39], a[64:67], v[132:135], v[36:39]
    global_load_dwordx4 a[152:155], v247, s[60:61] offset:0 sc1
    global_load_dwordx4 a[156:159], v247, s[60:61] offset:1024 sc1
    v_mfma_f32_16x16x32_bf16 v[24:27], a[68:71], v[128:131], v[24:27]
    v_mfma_f32_16x16x32_bf16 v[40:43], a[68:71], v[132:135], v[40:43]
    v_mfma_f32_16x16x32_bf16 v[28:31], a[72:75], v[128:131], v[28:31]
    v_mfma_f32_16x16x32_bf16 v[44:47], a[72:75], v[132:135], v[44:47]
    s_waitcnt vmcnt(39)
    s_waitcnt lgkmcnt(5)
    v_mfma_f32_16x16x32_bf16 v[16:19], a[76:79], v[136:139], v[16:19]
    ds_read_b128 v[96:99], v240 offset:32768
    ds_read_b128 v[100:103], v240 offset:33792
    s_waitcnt lgkmcnt(6)
    v_mfma_f32_16x16x32_bf16 v[32:35], a[76:79], v[140:143], v[32:35]
    v_mfma_f32_16x16x32_bf16 v[20:23], a[80:83], v[136:139], v[20:23]
    v_mfma_f32_16x16x32_bf16 v[36:39], a[80:83], v[140:143], v[36:39]
    global_load_dwordx4 a[240:243], v247, s[60:61] offset:2048 sc1
    global_load_dwordx4 a[244:247], v247, s[60:61] offset:3072 sc1
    v_mfma_f32_16x16x32_bf16 v[24:27], a[84:87], v[136:139], v[24:27]
    v_mfma_f32_16x16x32_bf16 v[40:43], a[84:87], v[140:143], v[40:43]
    v_mfma_f32_16x16x32_bf16 v[28:31], a[88:91], v[136:139], v[28:31]
    v_mfma_f32_16x16x32_bf16 v[44:47], a[88:91], v[140:143], v[44:47]
    s_waitcnt vmcnt(37)
    s_waitcnt lgkmcnt(5)
    v_mfma_f32_16x16x32_bf16 v[16:19], a[92:95], v[144:147], v[16:19]
    ds_read_b128 v[104:107], v240 offset:34816
    ds_read_b128 v[108:111], v240 offset:35840
    s_waitcnt lgkmcnt(6)
    v_mfma_f32_16x16x32_bf16 v[32:35], a[92:95], v[148:151], v[32:35]
    v_mfma_f32_16x16x32_bf16 v[20:23], a[192:195], v[144:147], v[20:23]
    v_mfma_f32_16x16x32_bf16 v[36:39], a[192:195], v[148:151], v[36:39]
    v_add_u32 v247, 0x2000, v247
    global_load_dwordx4 v[48:51], v247, s[60:61] offset:-4096 sc1
    global_load_dwordx4 v[52:55], v247, s[60:61] offset:-3072 sc1
    v_mfma_f32_16x16x32_bf16 v[24:27], a[196:199], v[144:147], v[24:27]
    v_mfma_f32_16x16x32_bf16 v[40:43], a[196:199], v[148:151], v[40:43]
    v_mfma_f32_16x16x32_bf16 v[28:31], a[200:203], v[144:147], v[28:31]
    v_mfma_f32_16x16x32_bf16 v[44:47], a[200:203], v[148:151], v[44:47]
    s_waitcnt vmcnt(35)
    s_waitcnt lgkmcnt(5)
    v_mfma_f32_16x16x32_bf16 v[16:19], a[204:207], v[152:155], v[16:19]
    ds_read_b128 v[112:115], v240 offset:36864
    ds_read_b128 v[116:119], v240 offset:37888
    s_waitcnt lgkmcnt(6)
    v_mfma_f32_16x16x32_bf16 v[32:35], a[204:207], v[156:159], v[32:35]
    v_mfma_f32_16x16x32_bf16 v[20:23], a[224:227], v[152:155], v[20:23]
    v_mfma_f32_16x16x32_bf16 v[36:39], a[224:227], v[156:159], v[36:39]
    global_load_dwordx4 v[56:59], v247, s[60:61] offset:-2048 sc1
    global_load_dwordx4 v[60:63], v247, s[60:61] offset:-1024 sc1
    v_mfma_f32_16x16x32_bf16 v[24:27], a[228:231], v[152:155], v[24:27]
    v_mfma_f32_16x16x32_bf16 v[40:43], a[228:231], v[156:159], v[40:43]
    v_mfma_f32_16x16x32_bf16 v[28:31], a[232:235], v[152:155], v[28:31]
    v_mfma_f32_16x16x32_bf16 v[44:47], a[232:235], v[156:159], v[44:47]
    s_waitcnt vmcnt(33)
    s_waitcnt lgkmcnt(5)
    v_mfma_f32_16x16x32_bf16 v[16:19], a[236:239], v[96:99], v[16:19]
    ds_read_b128 v[120:123], v240 offset:38912
    ds_read_b128 v[124:127], v240 offset:39936
    s_waitcnt lgkmcnt(6)
    v_mfma_f32_16x16x32_bf16 v[32:35], a[236:239], v[100:103], v[32:35]
    v_mfma_f32_16x16x32_bf16 v[20:23], v[80:83], v[96:99], v[20:23]
    v_mfma_f32_16x16x32_bf16 v[36:39], v[80:83], v[100:103], v[36:39]
    global_load_dwordx4 a[248:251], v247, s[60:61] offset:0 sc1
    global_load_dwordx4 a[252:255], v247, s[60:61] offset:1024 sc1
    v_mfma_f32_16x16x32_bf16 v[24:27], v[84:87], v[96:99], v[24:27]
    v_mfma_f32_16x16x32_bf16 v[40:43], v[84:87], v[100:103], v[40:43]
    v_mfma_f32_16x16x32_bf16 v[28:31], v[88:91], v[96:99], v[28:31]
    v_mfma_f32_16x16x32_bf16 v[44:47], v[88:91], v[100:103], v[44:47]
    s_waitcnt vmcnt(31)
    s_waitcnt lgkmcnt(5)
    v_mfma_f32_16x16x32_bf16 v[16:19], v[92:95], v[104:107], v[16:19]
    ds_read_b128 v[128:131], v240 offset:40960
    ds_read_b128 v[132:135], v240 offset:41984
    s_waitcnt lgkmcnt(6)
    v_mfma_f32_16x16x32_bf16 v[32:35], v[92:95], v[108:111], v[32:35]
    v_mfma_f32_16x16x32_bf16 v[20:23], v[248:251], v[104:107], v[20:23]
    v_mfma_f32_16x16x32_bf16 v[36:39], v[248:251], v[108:111], v[36:39]
    global_load_dwordx4 a[160:163], v247, s[60:61] offset:2048 sc1
    global_load_dwordx4 a[164:167], v247, s[60:61] offset:3072 sc1
    v_mfma_f32_16x16x32_bf16 v[24:27], v[252:255], v[104:107], v[24:27]
    v_mfma_f32_16x16x32_bf16 v[40:43], v[252:255], v[108:111], v[40:43]
    v_mfma_f32_16x16x32_bf16 v[28:31], a[96:99], v[104:107], v[28:31]
    v_mfma_f32_16x16x32_bf16 v[44:47], a[96:99], v[108:111], v[44:47]
    s_waitcnt vmcnt(29)
    s_waitcnt lgkmcnt(5)
    v_mfma_f32_16x16x32_bf16 v[16:19], a[100:103], v[112:115], v[16:19]
    ds_read_b128 v[136:139], v240 offset:43008
    ds_read_b128 v[140:143], v240 offset:44032
    s_waitcnt lgkmcnt(6)
    v_mfma_f32_16x16x32_bf16 v[32:35], a[100:103], v[116:119], v[32:35]
    v_mfma_f32_16x16x32_bf16 v[20:23], a[104:107], v[112:115], v[20:23]
    v_mfma_f32_16x16x32_bf16 v[36:39], a[104:107], v[116:119], v[36:39]
    v_add_u32 v247, 0x2000, v247
    global_load_dwordx4 a[168:171], v247, s[60:61] offset:-4096 sc1
    global_load_dwordx4 a[172:175], v247, s[60:61] offset:-3072 sc1
    v_mfma_f32_16x16x32_bf16 v[24:27], a[108:111], v[112:115], v[24:27]
    v_mfma_f32_16x16x32_bf16 v[40:43], a[108:111], v[116:119], v[40:43]
    v_mfma_f32_16x16x32_bf16 v[28:31], a[112:115], v[112:115], v[28:31]
    v_mfma_f32_16x16x32_bf16 v[44:47], a[112:115], v[116:119], v[44:47]
    s_waitcnt vmcnt(27)
    s_waitcnt lgkmcnt(5)
    v_mfma_f32_16x16x32_bf16 v[16:19], a[116:119], v[120:123], v[16:19]
    ds_read_b128 v[144:147], v240 offset:45056
    ds_read_b128 v[148:151], v240 offset:46080
    s_waitcnt lgkmcnt(6)
    v_mfma_f32_16x16x32_bf16 v[32:35], a[116:119], v[124:127], v[32:35]
    v_mfma_f32_16x16x32_bf16 v[20:23], a[120:123], v[120:123], v[20:23]
    v_mfma_f32_16x16x32_bf16 v[36:39], a[120:123], v[124:127], v[36:39]
    global_load_dwordx4 a[176:179], v247, s[60:61] offset:-2048 sc1
    global_load_dwordx4 a[180:183], v247, s[60:61] offset:-1024 sc1
    v_mfma_f32_16x16x32_bf16 v[24:27], a[124:127], v[120:123], v[24:27]
    v_mfma_f32_16x16x32_bf16 v[40:43], a[124:127], v[124:127], v[40:43]
    v_mfma_f32_16x16x32_bf16 v[28:31], a[208:211], v[120:123], v[28:31]
    v_mfma_f32_16x16x32_bf16 v[44:47], a[208:211], v[124:127], v[44:47]
    s_waitcnt vmcnt(25)
    s_waitcnt lgkmcnt(5)
    v_mfma_f32_16x16x32_bf16 v[16:19], a[212:215], v[128:131], v[16:19]
    ds_read_b128 v[152:155], v240 offset:47104
    ds_read_b128 v[156:159], v240 offset:48128
    s_waitcnt lgkmcnt(6)
    v_mfma_f32_16x16x32_bf16 v[32:35], a[212:215], v[132:135], v[32:35]
    v_mfma_f32_16x16x32_bf16 v[20:23], a[216:219], v[128:131], v[20:23]
    v_mfma_f32_16x16x32_bf16 v[36:39], a[216:219], v[132:135], v[36:39]
    global_load_dwordx4 a[184:187], v247, s[60:61] offset:0 sc1
    global_load_dwordx4 a[188:191], v247, s[60:61] offset:1024 sc1
    v_mfma_f32_16x16x32_bf16 v[24:27], a[220:223], v[128:131], v[24:27]
    v_mfma_f32_16x16x32_bf16 v[40:43], a[220:223], v[132:135], v[40:43]
    v_mfma_f32_16x16x32_bf16 v[28:31], a[128:131], v[128:131], v[28:31]
    v_mfma_f32_16x16x32_bf16 v[44:47], a[128:131], v[132:135], v[44:47]
    s_waitcnt vmcnt(23)
    s_waitcnt lgkmcnt(5)
    v_mfma_f32_16x16x32_bf16 v[16:19], a[132:135], v[136:139], v[16:19]
    ds_read_b128 v[96:99], v240 offset:49152
    ds_read_b128 v[100:103], v240 offset:50176
    s_waitcnt lgkmcnt(6)
    v_mfma_f32_16x16x32_bf16 v[32:35], a[132:135], v[140:143], v[32:35]
    v_mfma_f32_16x16x32_bf16 v[20:23], a[136:139], v[136:139], v[20:23]
    v_mfma_f32_16x16x32_bf16 v[36:39], a[136:139], v[140:143], v[36:39]
    global_load_dwordx4 a[0:3], v247, s[60:61] offset:2048 sc1
    global_load_dwordx4 a[4:7], v247, s[60:61] offset:3072 sc1
    v_mfma_f32_16x16x32_bf16 v[24:27], a[140:143], v[136:139], v[24:27]
    v_mfma_f32_16x16x32_bf16 v[40:43], a[140:143], v[140:143], v[40:43]
    v_mfma_f32_16x16x32_bf16 v[28:31], a[144:147], v[136:139], v[28:31]
    v_mfma_f32_16x16x32_bf16 v[44:47], a[144:147], v[140:143], v[44:47]
    s_waitcnt vmcnt(21)
    s_waitcnt lgkmcnt(5)
    v_mfma_f32_16x16x32_bf16 v[16:19], a[148:151], v[144:147], v[16:19]
    ds_read_b128 v[104:107], v240 offset:51200
    ds_read_b128 v[108:111], v240 offset:52224
    s_waitcnt lgkmcnt(6)
    v_mfma_f32_16x16x32_bf16 v[32:35], a[148:151], v[148:151], v[32:35]
    v_mfma_f32_16x16x32_bf16 v[20:23], v[64:67], v[144:147], v[20:23]
    v_mfma_f32_16x16x32_bf16 v[36:39], v[64:67], v[148:151], v[36:39]
    v_add_u32 v247, 0x2000, v247
    global_load_dwordx4 a[8:11], v247, s[60:61] offset:-4096 sc1
    global_load_dwordx4 a[12:15], v247, s[60:61] offset:-3072 sc1
    v_mfma_f32_16x16x32_bf16 v[24:27], v[68:71], v[144:147], v[24:27]
    v_mfma_f32_16x16x32_bf16 v[40:43], v[68:71], v[148:151], v[40:43]
    v_mfma_f32_16x16x32_bf16 v[28:31], v[72:75], v[144:147], v[28:31]
    v_mfma_f32_16x16x32_bf16 v[44:47], v[72:75], v[148:151], v[44:47]
    s_waitcnt vmcnt(19)
    s_waitcnt lgkmcnt(5)
    v_mfma_f32_16x16x32_bf16 v[16:19], v[76:79], v[152:155], v[16:19]
    ds_read_b128 v[112:115], v240 offset:53248
    ds_read_b128 v[116:119], v240 offset:54272
    s_waitcnt lgkmcnt(6)
    v_mfma_f32_16x16x32_bf16 v[32:35], v[76:79], v[156:159], v[32:35]
    v_mfma_f32_16x16x32_bf16 v[20:23], a[152:155], v[152:155], v[20:23]
    v_mfma_f32_16x16x32_bf16 v[36:39], a[152:155], v[156:159], v[36:39]
    global_load_dwordx4 a[16:19], v247, s[60:61] offset:-2048 sc1
    global_load_dwordx4 a[20:23], v247, s[60:61] offset:-1024 sc1
    v_mfma_f32_16x16x32_bf16 v[24:27], a[156:159], v[152:155], v[24:27]
    v_mfma_f32_16x16x32_bf16 v[40:43], a[156:159], v[156:159], v[40:43]
    v_mfma_f32_16x16x32_bf16 v[28:31], a[240:243], v[152:155], v[28:31]
    v_mfma_f32_16x16x32_bf16 v[44:47], a[240:243], v[156:159], v[44:47]
    s_waitcnt vmcnt(17)
    s_waitcnt lgkmcnt(5)
    v_mfma_f32_16x16x32_bf16 v[16:19], a[244:247], v[96:99], v[16:19]
    ds_read_b128 v[120:123], v240 offset:55296
    ds_read_b128 v[124:127], v240 offset:56320
    s_waitcnt lgkmcnt(6)
    v_mfma_f32_16x16x32_bf16 v[32:35], a[244:247], v[100:103], v[32:35]
    v_mfma_f32_16x16x32_bf16 v[20:23], v[48:51], v[96:99], v[20:23]
    v_mfma_f32_16x16x32_bf16 v[36:39], v[48:51], v[100:103], v[36:39]
    global_load_dwordx4 a[24:27], v247, s[60:61] offset:0 sc1
    global_load_dwordx4 a[28:31], v247, s[60:61] offset:1024 sc1
    v_mfma_f32_16x16x32_bf16 v[24:27], v[52:55], v[96:99], v[24:27]
    v_mfma_f32_16x16x32_bf16 v[40:43], v[52:55], v[100:103], v[40:43]
    v_mfma_f32_16x16x32_bf16 v[28:31], v[56:59], v[96:99], v[28:31]
    v_mfma_f32_16x16x32_bf16 v[44:47], v[56:59], v[100:103], v[44:47]
    s_waitcnt vmcnt(15)
    s_waitcnt lgkmcnt(5)
    v_mfma_f32_16x16x32_bf16 v[16:19], v[60:63], v[104:107], v[16:19]
    global_load_dwordx4 a[32:35], v247, s[60:61] offset:2048 sc1
    global_load_dwordx4 a[36:39], v247, s[60:61] offset:3072 sc1
    ds_read_b128 v[128:131], v240 offset:57344
    ds_read_b128 v[132:135], v240 offset:58368
    s_waitcnt lgkmcnt(6)
    v_mfma_f32_16x16x32_bf16 v[32:35], v[60:63], v[108:111], v[32:35]
    v_mfma_f32_16x16x32_bf16 v[20:23], a[248:251], v[104:107], v[20:23]
    v_mfma_f32_16x16x32_bf16 v[36:39], a[248:251], v[108:111], v[36:39]
    v_mfma_f32_16x16x32_bf16 v[24:27], a[252:255], v[104:107], v[24:27]
    v_mfma_f32_16x16x32_bf16 v[40:43], a[252:255], v[108:111], v[40:43]
    v_mfma_f32_16x16x32_bf16 v[28:31], a[160:163], v[104:107], v[28:31]
    v_mfma_f32_16x16x32_bf16 v[44:47], a[160:163], v[108:111], v[44:47]
    s_waitcnt vmcnt(13)
    s_waitcnt lgkmcnt(5)
    v_mfma_f32_16x16x32_bf16 v[16:19], a[164:167], v[112:115], v[16:19]
    v_add_u32 v247, 0x2000, v247
    global_load_dwordx4 a[40:43], v247, s[60:61] offset:-4096 sc1
    global_load_dwordx4 a[44:47], v247, s[60:61] offset:-3072 sc1
    ds_read_b128 v[136:139], v240 offset:59392
    ds_read_b128 v[140:143], v240 offset:60416
    s_waitcnt lgkmcnt(6)
    v_mfma_f32_16x16x32_bf16 v[32:35], a[164:167], v[116:119], v[32:35]
    global_load_dwordx4 a[48:51], v247, s[60:61] offset:-2048 sc1
    global_load_dwordx4 a[52:55], v247, s[60:61] offset:-1024 sc1
    v_mfma_f32_16x16x32_bf16 v[20:23], a[168:171], v[112:115], v[20:23]
    v_mfma_f32_16x16x32_bf16 v[36:39], a[168:171], v[116:119], v[36:39]
    v_mfma_f32_16x16x32_bf16 v[24:27], a[172:175], v[112:115], v[24:27]
    v_mfma_f32_16x16x32_bf16 v[40:43], a[172:175], v[116:119], v[40:43]
    v_mfma_f32_16x16x32_bf16 v[28:31], a[176:179], v[112:115], v[28:31]
    v_mfma_f32_16x16x32_bf16 v[44:47], a[176:179], v[116:119], v[44:47]
    s_waitcnt vmcnt(13)
    s_waitcnt lgkmcnt(5)
    v_mfma_f32_16x16x32_bf16 v[16:19], a[180:183], v[120:123], v[16:19]
    global_load_dwordx4 a[56:59], v247, s[60:61] offset:0 sc1
    global_load_dwordx4 a[60:63], v247, s[60:61] offset:1024 sc1
    ds_read_b128 v[144:147], v240 offset:61440
    ds_read_b128 v[148:151], v240 offset:62464
    s_waitcnt lgkmcnt(6)
    v_mfma_f32_16x16x32_bf16 v[32:35], a[180:183], v[124:127], v[32:35]
    global_load_dwordx4 a[64:67], v247, s[60:61] offset:2048 sc1
    v_mfma_f32_16x16x32_bf16 v[20:23], a[184:187], v[120:123], v[20:23]
    v_mfma_f32_16x16x32_bf16 v[36:39], a[184:187], v[124:127], v[36:39]
    v_mfma_f32_16x16x32_bf16 v[24:27], a[188:191], v[120:123], v[24:27]
    v_mfma_f32_16x16x32_bf16 v[40:43], a[188:191], v[124:127], v[40:43]
    v_mfma_f32_16x16x32_bf16 v[28:31], a[0:3], v[120:123], v[28:31]
    v_mfma_f32_16x16x32_bf16 v[44:47], a[0:3], v[124:127], v[44:47]
    s_waitcnt vmcnt(12)
    s_waitcnt lgkmcnt(5)
    v_mfma_f32_16x16x32_bf16 v[16:19], a[4:7], v[128:131], v[16:19]
    ds_read_b128 v[152:155], v240 offset:63488
    ds_read_b128 v[156:159], v240 offset:64512
    s_waitcnt lgkmcnt(6)
    v_mfma_f32_16x16x32_bf16 v[32:35], a[4:7], v[132:135], v[32:35]
    v_mfma_f32_16x16x32_bf16 v[20:23], a[8:11], v[128:131], v[20:23]
    v_mfma_f32_16x16x32_bf16 v[36:39], a[8:11], v[132:135], v[36:39]
    v_mfma_f32_16x16x32_bf16 v[24:27], a[12:15], v[128:131], v[24:27]
    v_mfma_f32_16x16x32_bf16 v[40:43], a[12:15], v[132:135], v[40:43]
    v_mfma_f32_16x16x32_bf16 v[28:31], a[16:19], v[128:131], v[28:31]
    v_mfma_f32_16x16x32_bf16 v[44:47], a[16:19], v[132:135], v[44:47]
    s_add_u32 s8, s8, s12
    s_addc_u32 s9, s9, 0
    v_lshlrev_b32 v9, 9, v3
    v_lshl_add_u32 v9, v1, 7, v9
    v_lshl_add_u32 v9, v4, 4, v9
    v_add_u32 v10, 8192, v9
    s_waitcnt vmcnt(8)
    s_waitcnt lgkmcnt(5)
    v_mfma_f32_16x16x32_bf16 v[16:19], a[20:23], v[136:139], v[16:19]
    s_waitcnt lgkmcnt(4)
    v_mfma_f32_16x16x32_bf16 v[32:35], a[20:23], v[140:143], v[32:35]
    v_mfma_f32_16x16x32_bf16 v[20:23], a[24:27], v[136:139], v[20:23]
    v_mfma_f32_16x16x32_bf16 v[36:39], a[24:27], v[140:143], v[36:39]
    v_mfma_f32_16x16x32_bf16 v[24:27], a[28:31], v[136:139], v[24:27]
    v_mfma_f32_16x16x32_bf16 v[40:43], a[28:31], v[140:143], v[40:43]
    v_mfma_f32_16x16x32_bf16 v[28:31], a[32:35], v[136:139], v[28:31]
    v_mfma_f32_16x16x32_bf16 v[44:47], a[32:35], v[140:143], v[44:47]
    s_waitcnt vmcnt(4)
    s_waitcnt lgkmcnt(3)
    v_mfma_f32_16x16x32_bf16 v[16:19], a[36:39], v[144:147], v[16:19]
    s_waitcnt lgkmcnt(2)
    v_mfma_f32_16x16x32_bf16 v[32:35], a[36:39], v[148:151], v[32:35]
    v_mfma_f32_16x16x32_bf16 v[20:23], a[40:43], v[144:147], v[20:23]
    v_mfma_f32_16x16x32_bf16 v[36:39], a[40:43], v[148:151], v[36:39]
    v_mfma_f32_16x16x32_bf16 v[24:27], a[44:47], v[144:147], v[24:27]
    v_mfma_f32_16x16x32_bf16 v[40:43], a[44:47], v[148:151], v[40:43]
    v_mfma_f32_16x16x32_bf16 v[28:31], a[48:51], v[144:147], v[28:31]
    v_mfma_f32_16x16x32_bf16 v[44:47], a[48:51], v[148:151], v[44:47]
    s_waitcnt vmcnt(0)
    s_waitcnt lgkmcnt(1)
    v_mfma_f32_16x16x32_bf16 v[16:19], a[52:55], v[152:155], v[16:19]
    s_waitcnt lgkmcnt(0)
    v_mfma_f32_16x16x32_bf16 v[32:35], a[52:55], v[156:159], v[32:35]
    v_mfma_f32_16x16x32_bf16 v[20:23], a[56:59], v[152:155], v[20:23]
    v_mfma_f32_16x16x32_bf16 v[36:39], a[56:59], v[156:159], v[36:39]
    v_mfma_f32_16x16x32_bf16 v[24:27], a[60:63], v[152:155], v[24:27]
    v_mfma_f32_16x16x32_bf16 v[40:43], a[60:63], v[156:159], v[40:43]
    v_mfma_f32_16x16x32_bf16 v[28:31], a[64:67], v[152:155], v[28:31]
    v_mfma_f32_16x16x32_bf16 v[44:47], a[64:67], v[156:159], v[44:47]
    v_pk_add_f32 v[192:193], v[16:17], v[18:19]
    s_nop 0
    v_pk_add_f32 v[196:197], v[32:33], v[34:35]
    v_pk_mul_f32 v[194:195], v[16:17], v[16:17]
    v_pk_mul_f32 v[198:199], v[32:33], v[32:33]
    v_pk_fma_f32 v[194:195], v[18:19], v[18:19], v[194:195]
    v_pk_fma_f32 v[198:199], v[34:35], v[34:35], v[198:199]
    v_pk_add_f32 v[192:193], v[192:193], v[20:21]
    v_pk_add_f32 v[196:197], v[196:197], v[36:37]
    v_pk_fma_f32 v[194:195], v[20:21], v[20:21], v[194:195]
    v_pk_fma_f32 v[198:199], v[36:37], v[36:37], v[198:199]
    v_pk_add_f32 v[192:193], v[192:193], v[22:23]
    v_pk_add_f32 v[196:197], v[196:197], v[38:39]
    v_pk_fma_f32 v[194:195], v[22:23], v[22:23], v[194:195]
    v_pk_fma_f32 v[198:199], v[38:39], v[38:39], v[198:199]
    v_pk_add_f32 v[192:193], v[192:193], v[24:25]
    v_pk_add_f32 v[196:197], v[196:197], v[40:41]
    v_pk_fma_f32 v[194:195], v[24:25], v[24:25], v[194:195]
    v_pk_fma_f32 v[198:199], v[40:41], v[40:41], v[198:199]
    v_pk_add_f32 v[192:193], v[192:193], v[26:27]
    v_pk_add_f32 v[196:197], v[196:197], v[42:43]
    v_pk_fma_f32 v[194:195], v[26:27], v[26:27], v[194:195]
    v_pk_fma_f32 v[198:199], v[42:43], v[42:43], v[198:199]
    v_pk_add_f32 v[192:193], v[192:193], v[28:29]
    v_pk_add_f32 v[196:197], v[196:197], v[44:45]
    v_pk_fma_f32 v[194:195], v[28:29], v[28:29], v[194:195]
    v_pk_fma_f32 v[198:199], v[44:45], v[44:45], v[198:199]
    v_pk_add_f32 v[192:193], v[192:193], v[30:31]
    v_pk_add_f32 v[196:197], v[196:197], v[46:47]
    v_pk_fma_f32 v[194:195], v[30:31], v[30:31], v[194:195]
    v_pk_fma_f32 v[198:199], v[46:47], v[46:47], v[198:199]
    v_add_f32 v240, v192, v193
    v_add_f32 v242, v196, v197
    v_add_f32 v241, v194, v195
    v_add_f32 v243, v198, v199
    v_permlane32_swap_b32 v240, v242
    s_nop 0
    v_permlane32_swap_b32 v241, v243
    v_add_f32 v240, v240, v242
    v_add_f32 v241, v241, v243
    s_nop 1
    v_permlane16_swap_b32 v240, v241
    v_add_f32 v240, v240, v241
    ds_write_b32 v14, v240 offset:4096
    s_waitcnt lgkmcnt(0)
    s_barrier
    ds_read_b128 v[192:195], v15 offset:4096
    ds_read_b128 v[196:199], v15 offset:4352
    ds_read_b128 v[200:203], v15 offset:4608
    ds_read_b128 v[204:207], v15 offset:4864
    s_waitcnt lgkmcnt(3)
    v_pk_add_f32 v[192:193], v[192:193], v[194:195]
    s_waitcnt lgkmcnt(1)
    v_pk_add_f32 v[200:201], v[200:201], v[202:203]
    v_pk_add_f32 v[196:197], v[196:197], v[198:199]
    s_waitcnt lgkmcnt(0)
    v_pk_add_f32 v[204:205], v[204:205], v[206:207]
    v_add_f32 v192, v192, v193
    v_add_f32 v200, v200, v201
    v_add_f32 v196, v196, v197
    v_add_f32 v204, v204, v205
    v_mul_f32 v192, s24, v192
    v_mul_f32 v200, s24, v200
    v_mul_f32 v193, v192, v192
    v_mul_f32 v201, v200, v200
    v_fma_f32 v196, v196, s24, -v193
    v_fma_f32 v204, v204, s24, -v201
    v_max_f32 v196, 0, v196
    v_max_f32 v204, 0, v204
    v_add_f32 v196, s25, v196
    v_add_f32 v204, s25, v204
    v_rsq_f32 v196, v196
    v_rsq_f32 v204, v204
    v_mul_f32 v240, 0xbf800000, v196
    v_mul_f32 v242, 0xbf800000, v204
    v_mul_f32_e64 v241, -v192, v240
    v_mul_f32_e64 v243, -v200, v242
    v_pk_fma_f32 v[192:193], v[16:17], v[240:241], v[240:241] op_sel:[0,0,1] op_sel_hi:[1,0,1]
    v_pk_fma_f32 v[194:195], v[18:19], v[240:241], v[240:241] op_sel:[0,0,1] op_sel_hi:[1,0,1]
    v_pk_fma_f32 v[196:197], v[20:21], v[240:241], v[240:241] op_sel:[0,0,1] op_sel_hi:[1,0,1]
    v_pk_fma_f32 v[198:199], v[22:23], v[240:241], v[240:241] op_sel:[0,0,1] op_sel_hi:[1,0,1]
    v_cvt_pk_bf16_f32 v192, v192, v193
    v_cvt_pk_bf16_f32 v193, v194, v195
    v_cvt_pk_bf16_f32 v194, v196, v197
    v_cvt_pk_bf16_f32 v195, v198, v199
    global_store_dwordx4 v9, v[192:195], s[8:9] offset:0 sc1
    v_pk_fma_f32 v[200:201], v[24:25], v[240:241], v[240:241] op_sel:[0,0,1] op_sel_hi:[1,0,1]
    v_pk_fma_f32 v[202:203], v[26:27], v[240:241], v[240:241] op_sel:[0,0,1] op_sel_hi:[1,0,1]
    v_pk_fma_f32 v[204:205], v[28:29], v[240:241], v[240:241] op_sel:[0,0,1] op_sel_hi:[1,0,1]
    v_pk_fma_f32 v[206:207], v[30:31], v[240:241], v[240:241] op_sel:[0,0,1] op_sel_hi:[1,0,1]
    v_cvt_pk_bf16_f32 v200, v200, v201
    v_cvt_pk_bf16_f32 v201, v202, v203
    v_cvt_pk_bf16_f32 v202, v204, v205
    v_cvt_pk_bf16_f32 v203, v206, v207
    global_store_dwordx4 v9, v[200:203], s[8:9] offset:64 sc1
    v_pk_fma_f32 v[208:209], v[32:33], v[242:243], v[242:243] op_sel:[0,0,1] op_sel_hi:[1,0,1]
    v_pk_fma_f32 v[210:211], v[34:35], v[242:243], v[242:243] op_sel:[0,0,1] op_sel_hi:[1,0,1]
    v_pk_fma_f32 v[212:213], v[36:37], v[242:243], v[242:243] op_sel:[0,0,1] op_sel_hi:[1,0,1]
    v_pk_fma_f32 v[214:215], v[38:39], v[242:243], v[242:243] op_sel:[0,0,1] op_sel_hi:[1,0,1]
    v_cvt_pk_bf16_f32 v208, v208, v209
    v_cvt_pk_bf16_f32 v209, v210, v211
    v_cvt_pk_bf16_f32 v210, v212, v213
    v_cvt_pk_bf16_f32 v211, v214, v215
    global_store_dwordx4 v10, v[208:211], s[8:9] offset:0 sc1
    v_pk_fma_f32 v[216:217], v[40:41], v[242:243], v[242:243] op_sel:[0,0,1] op_sel_hi:[1,0,1]
    v_pk_fma_f32 v[218:219], v[42:43], v[242:243], v[242:243] op_sel:[0,0,1] op_sel_hi:[1,0,1]
    v_pk_fma_f32 v[220:221], v[44:45], v[242:243], v[242:243] op_sel:[0,0,1] op_sel_hi:[1,0,1]
    v_pk_fma_f32 v[222:223], v[46:47], v[242:243], v[242:243] op_sel:[0,0,1] op_sel_hi:[1,0,1]
    v_cvt_pk_bf16_f32 v216, v216, v217
    v_cvt_pk_bf16_f32 v217, v218, v219
    v_cvt_pk_bf16_f32 v218, v220, v221
    v_cvt_pk_bf16_f32 v219, v222, v223
    global_store_dwordx4 v10, v[216:219], s[8:9] offset:64 sc1
    s_endpgm
K3_NONE:
    v_mov_b32 v100, 1
    v_mov_b32 v101, 1
    v_mov_b32 v102, 1
    v_mov_b32 v103, 1
    s_waitcnt vmcnt(0)
    s_mov_b64 exec, 1
    buffer_store_dword v100, v7, s[20:23], s46 offen sc1
    s_endpgm
K2_FB:
    s_mov_b32 s36, 1
    s_mov_b32 s63, 0
    s_mov_b32 s29, 13
    s_mov_b32 s28, 0
    v_mov_b32 v8, v7
    s_waitcnt vmcnt(19)
    buffer_load_dwordx4 a[128:131], v7, s[8:11], s32 offen offset:0 sc1
    s_waitcnt vmcnt(19)
    buffer_load_dwordx4 a[132:135], v7, s[8:11], s32 offen offset:1024 sc1
    s_waitcnt vmcnt(19)
    buffer_load_dwordx4 a[136:139], v7, s[8:11], s32 offen offset:2048 sc1
    s_waitcnt vmcnt(19)
    buffer_load_dwordx4 a[140:143], v7, s[8:11], s32 offen offset:3072 sc1
    s_waitcnt vmcnt(19)
    buffer_load_dwordx4 a[144:147], v7, s[8:11], s33 offen offset:0 sc1
    s_waitcnt vmcnt(19)
    buffer_load_dwordx4 a[148:151], v7, s[8:11], s33 offen offset:1024 sc1
    s_waitcnt vmcnt(19)
    buffer_load_dwordx4 a[152:155], v7, s[8:11], s33 offen offset:2048 sc1
    s_waitcnt vmcnt(19)
    buffer_load_dwordx4 a[156:159], v7, s[8:11], s33 offen offset:3072 sc1
    s_waitcnt vmcnt(15)
    buffer_load_dwordx4 a[160:163], v7, s[8:11], s34 offen offset:0 sc1
    s_waitcnt vmcnt(15)
    buffer_load_dwordx4 a[164:167], v7, s[8:11], s34 offen offset:1024 sc1
    s_waitcnt vmcnt(15)
    buffer_load_dwordx4 a[168:171], v7, s[8:11], s34 offen offset:2048 sc1
    s_waitcnt vmcnt(15)
    buffer_load_dwordx4 a[172:175], v7, s[8:11], s34 offen offset:3072 sc1
    s_waitcnt vmcnt(15)
    buffer_load_dwordx4 a[176:179], v7, s[8:11], s35 offen offset:0 sc1
    s_waitcnt vmcnt(15)
    buffer_load_dwordx4 a[180:183], v7, s[8:11], s35 offen offset:1024 sc1
    s_waitcnt vmcnt(15)
    buffer_load_dwordx4 a[184:187], v7, s[8:11], s35 offen offset:2048 sc1
    s_waitcnt vmcnt(15)
    buffer_load_dwordx4 a[188:191], v7, s[8:11], s35 offen offset:3072 sc1
    v_mov_b32 v136, 0xff800000
    v_mov_b32 v137, 0xff800000
    v_mov_b32 v138, 0xff800000
    v_mov_b32 v139, 0xff800000
    v_mov_b32 v140, 0xff800000
    v_mov_b32 v141, 0xff800000
    v_mov_b32 v142, 0xff800000
    v_mov_b32 v143, 0xff800000
K2_FBL:
    global_load_dwordx4 a[192:195], v8, s[12:13] offset:0 sc1
    global_load_dwordx4 a[196:199], v8, s[12:13] offset:1024 sc1
    global_load_dwordx4 a[200:203], v8, s[12:13] offset:2048 sc1
    global_load_dwordx4 a[204:207], v8, s[12:13] offset:3072 sc1
    s_waitcnt vmcnt(3)
    v_mfma_f32_16x16x32_bf16 v[16:19], a[192:195], a[128:131], 0
    s_waitcnt vmcnt(1)
    v_mfma_f32_16x16x32_bf16 v[20:23], a[200:203], a[128:131], 0
    v_mfma_f32_16x16x32_bf16 v[24:27], a[192:195], a[136:139], 0
    v_mfma_f32_16x16x32_bf16 v[28:31], a[200:203], a[136:139], 0
    v_mfma_f32_16x16x32_bf16 v[16:19], a[196:199], a[132:135], v[16:19]
    s_waitcnt vmcnt(0)
    v_mfma_f32_16x16x32_bf16 v[20:23], a[204:207], a[132:135], v[20:23]
    v_mfma_f32_16x16x32_bf16 v[24:27], a[196:199], a[140:143], v[24:27]
    v_mfma_f32_16x16x32_bf16 v[28:31], a[204:207], a[140:143], v[28:31]
    s_nop 3
    v_max3_f32 v136, v136, v16, v17
    v_max3_f32 v136, v136, v18, v19
    v_max3_f32 v136, v136, v20, v21
    v_max3_f32 v136, v136, v22, v23
    v_max3_f32 v137, v137, v24, v25
    v_max3_f32 v137, v137, v26, v27
    v_max3_f32 v137, v137, v28, v29
    v_max3_f32 v137, v137, v30, v31
    s_waitcnt lgkmcnt(7)
    v_mfma_f32_16x16x32_bf16 v[32:35], a[192:195], a[144:147], 0
    s_waitcnt lgkmcnt(6)
    v_mfma_f32_16x16x32_bf16 v[36:39], a[200:203], a[144:147], 0
    s_waitcnt lgkmcnt(5)
    v_mfma_f32_16x16x32_bf16 v[40:43], a[192:195], a[152:155], 0
    s_waitcnt lgkmcnt(4)
    v_mfma_f32_16x16x32_bf16 v[44:47], a[200:203], a[152:155], 0
    v_mfma_f32_16x16x32_bf16 v[32:35], a[196:199], a[148:151], v[32:35]
    v_mfma_f32_16x16x32_bf16 v[36:39], a[204:207], a[148:151], v[36:39]
    v_mfma_f32_16x16x32_bf16 v[40:43], a[196:199], a[156:159], v[40:43]
    v_mfma_f32_16x16x32_bf16 v[44:47], a[204:207], a[156:159], v[44:47]
    s_nop 4
    v_max3_f32 v138, v138, v32, v33
    v_max3_f32 v138, v138, v34, v35
    v_max3_f32 v138, v138, v36, v37
    v_max3_f32 v138, v138, v38, v39
    v_max3_f32 v139, v139, v40, v41
    v_max3_f32 v139, v139, v42, v43
    v_max3_f32 v139, v139, v44, v45
    v_max3_f32 v139, v139, v46, v47
    v_mfma_f32_16x16x32_bf16 v[16:19], a[192:195], a[160:163], 0
    v_mfma_f32_16x16x32_bf16 v[20:23], a[200:203], a[160:163], 0
    v_mfma_f32_16x16x32_bf16 v[24:27], a[192:195], a[168:171], 0
    v_mfma_f32_16x16x32_bf16 v[28:31], a[200:203], a[168:171], 0
    v_mfma_f32_16x16x32_bf16 v[16:19], a[196:199], a[164:167], v[16:19]
    v_mfma_f32_16x16x32_bf16 v[20:23], a[204:207], a[164:167], v[20:23]
    v_mfma_f32_16x16x32_bf16 v[24:27], a[196:199], a[172:175], v[24:27]
    v_mfma_f32_16x16x32_bf16 v[28:31], a[204:207], a[172:175], v[28:31]
    s_nop 4
    v_max3_f32 v140, v140, v16, v17
    v_max3_f32 v140, v140, v18, v19
    v_max3_f32 v140, v140, v20, v21
    v_max3_f32 v140, v140, v22, v23
    v_max3_f32 v141, v141, v24, v25
    v_max3_f32 v141, v141, v26, v27
    v_max3_f32 v141, v141, v28, v29
    v_max3_f32 v141, v141, v30, v31
    v_mfma_f32_16x16x32_bf16 v[32:35], a[192:195], a[176:179], 0
    v_mfma_f32_16x16x32_bf16 v[36:39], a[200:203], a[176:179], 0
    v_mfma_f32_16x16x32_bf16 v[40:43], a[192:195], a[184:187], 0
    v_mfma_f32_16x16x32_bf16 v[44:47], a[200:203], a[184:187], 0
    v_mfma_f32_16x16x32_bf16 v[32:35], a[196:199], a[180:183], v[32:35]
    v_mfma_f32_16x16x32_bf16 v[36:39], a[204:207], a[180:183], v[36:39]
    v_mfma_f32_16x16x32_bf16 v[40:43], a[196:199], a[188:191], v[40:43]
    v_mfma_f32_16x16x32_bf16 v[44:47], a[204:207], a[188:191], v[44:47]
    s_nop 4
    v_max3_f32 v142, v142, v32, v33
    v_max3_f32 v142, v142, v34, v35
    v_max3_f32 v142, v142, v36, v37
    v_max3_f32 v142, v142, v38, v39
    v_max3_f32 v143, v143, v40, v41
    v_max3_f32 v143, v143, v42, v43
    v_max3_f32 v143, v143, v44, v45
    v_max3_f32 v143, v143, v46, v47
    v_lshl_add_u32 v8, v1, 12, v7
    v_add_u32 v8, 4096, v8
    v_add_u32 v8, s28, v8
    s_add_u32 s28, s28, 16384
    s_cmp_le_u32 s28, 507904
    s_cbranch_scc1 K2_FBL
    v_permlane32_swap_b32 v136, v138
    v_permlane32_swap_b32 v137, v139
    v_max_f32 v136, v136, v138
    v_max_f32 v137, v137, v139
    s_nop 1
    v_permlane16_swap_b32 v136, v137
    v_max_f32 v136, v136, v137
    v_permlane32_swap_b32 v140, v142
    v_permlane32_swap_b32 v141, v143
    v_max_f32 v140, v140, v142
    v_max_f32 v141, v141, v143
    s_nop 1
    v_permlane16_swap_b32 v140, v141
    v_max_f32 v140, v140, v141
    s_waitcnt lgkmcnt(0)
    s_barrier
    ds_write_b32 v13, v136 offset:0
    ds_write_b32 v14, v140 offset:0
    s_waitcnt lgkmcnt(0)
    s_barrier
    v_lshl_add_u32 v8, v1, 12, v7
    v_add_u32 v8, 4096, v8
    global_load_dwordx4 a[208:211], v7, s[12:13] offset:0 sc1
    global_load_dwordx4 a[212:215], v7, s[12:13] offset:1024 sc1
    global_load_dwordx4 a[216:219], v7, s[12:13] offset:2048 sc1
    global_load_dwordx4 a[220:223], v7, s[12:13] offset:3072 sc1
    global_load_dwordx4 a[192:195], v8, s[12:13] offset:0 sc1
    global_load_dwordx4 a[196:199], v8, s[12:13] offset:1024 sc1
    global_load_dwordx4 a[200:203], v8, s[12:13] offset:2048 sc1
    global_load_dwordx4 a[204:207], v8, s[12:13] offset:3072 sc1
    s_add_u32 s30, s3, 1
    s_and_b32 s30, s30, 3
    s_lshl_b32 s30, s30, 9
    v_lshl_add_u32 v16, v3, 4, s30
    ds_read_b128 v[20:23], v16 offset:0
    s_waitcnt lgkmcnt(0)
    v_max3_f32 v20, v20, v21, v22
    v_min_f32_e64 v20, -v20, -v23
    v_mov_b32 v96, v20
    v_mov_b32 v97, v20
    v_mov_b32 v98, v20
    v_mov_b32 v99, v20
    ds_read_b128 v[20:23], v16 offset:256
    s_waitcnt lgkmcnt(0)
    v_max3_f32 v20, v20, v21, v22
    v_min_f32_e64 v20, -v20, -v23
    v_mov_b32 v100, v20
    v_mov_b32 v101, v20
    v_mov_b32 v102, v20
    v_mov_b32 v103, v20
    s_add_u32 s30, s3, 2
    s_and_b32 s30, s30, 3
    s_lshl_b32 s30, s30, 9
    v_lshl_add_u32 v16, v3, 4, s30
    ds_read_b128 v[20:23], v16 offset:0
    s_waitcnt lgkmcnt(0)
    v_max3_f32 v20, v20, v21, v22
    v_min_f32_e64 v20, -v20, -v23
    v_mov_b32 v104, v20
    v_mov_b32 v105, v20
    v_mov_b32 v106, v20
    v_mov_b32 v107, v20
    ds_read_b128 v[20:23], v16 offset:256
    s_waitcnt lgkmcnt(0)
    v_max3_f32 v20, v20, v21, v22
    v_min_f32_e64 v20, -v20, -v23
    v_mov_b32 v108, v20
    v_mov_b32 v109, v20
    v_mov_b32 v110, v20
    v_mov_b32 v111, v20
    s_add_u32 s30, s3, 3
    s_and_b32 s30, s30, 3
    s_lshl_b32 s30, s30, 9
    v_lshl_add_u32 v16, v3, 4, s30
    ds_read_b128 v[20:23], v16 offset:0
    s_waitcnt lgkmcnt(0)
    v_max3_f32 v20, v20, v21, v22
    v_min_f32_e64 v20, -v20, -v23
    v_mov_b32 v112, v20
    v_mov_b32 v113, v20
    v_mov_b32 v114, v20
    v_mov_b32 v115, v20
    ds_read_b128 v[20:23], v16 offset:256
    s_waitcnt lgkmcnt(0)
    v_max3_f32 v20, v20, v21, v22
    v_min_f32_e64 v20, -v20, -v23
    v_mov_b32 v116, v20
    v_mov_b32 v117, v20
    v_mov_b32 v118, v20
    v_mov_b32 v119, v20
    s_add_u32 s30, s3, 4
    s_and_b32 s30, s30, 3
    s_lshl_b32 s30, s30, 9
    v_lshl_add_u32 v16, v3, 4, s30
    ds_read_b128 v[20:23], v16 offset:0
    s_waitcnt lgkmcnt(0)
    v_max3_f32 v20, v20, v21, v22
    v_min_f32_e64 v20, -v20, -v23
    v_mov_b32 v120, v20
    v_mov_b32 v121, v20
    v_mov_b32 v122, v20
    v_mov_b32 v123, v20
    ds_read_b128 v[20:23], v16 offset:256
    s_waitcnt lgkmcnt(0)
    v_max3_f32 v20, v20, v21, v22
    v_min_f32_e64 v20, -v20, -v23
    v_mov_b32 v124, v20
    v_mov_b32 v125, v20
    v_mov_b32 v126, v20
    v_mov_b32 v127, v20
    v_mov_b32 v128, 0
    v_mov_b32 v129, 0
    v_mov_b32 v130, 0
    v_mov_b32 v131, 0
    v_mov_b32 v132, 0
    v_mov_b32 v133, 0
    v_mov_b32 v134, 0
    v_mov_b32 v135, 0
    v_mov_b32 v72, 0
    v_mov_b32 v73, 0
    v_mov_b32 v74, 0
    v_mov_b32 v75, 0
    v_mov_b32 v76, 0
    v_mov_b32 v77, 0
    v_mov_b32 v78, 0
    v_mov_b32 v79, 0
    s_barrier
    s_nop 7
    s_branch K2_MAIN
K1_XW:
    s_cmp_eq_u32 s62, 2
    s_cbranch_scc1 K1_XL
    s_mov_b32 s33, 0
K1_XP:
    global_load_dword v14, v12, s[16:17] sc1
    s_add_u32 s33, s33, 1
    s_waitcnt vmcnt(0)
    v_readfirstlane_b32 s34, v14
    s_nop 1
    s_cmp_eq_u32 s34, 0
    s_cselect_b32 s35, s33, 400
    s_cmp_lt_u32 s35, 400
    s_cbranch_scc1 K1_XP
    s_cmp_eq_u32 s34, s64
    s_cbranch_scc1 K1_XL
    v_mov_b32 v14, 52736
    ds_write_b32 v14, v14
    s_branch K1_XL
K1_XM:
    s_cmp_eq_u32 s62, 2
    s_cbranch_scc1 K1_XN
K1_XR:
    s_add_u32 s62, s62, 1
    s_and_b32 s63, s62, 1
    s_lshl_b32 s63, s63, 3
    s_xor_b32 s63, s63, s2
    v_mbcnt_lo_u32_b32 v0, -1, 0
    v_mbcnt_hi_u32_b32 v0, -1, v0
    s_lshl_b32 s33, s3, 6
    v_add_u32 v0, s33, v0
    s_waitcnt vmcnt(0) lgkmcnt(0)
    s_barrier
    s_branch K1_RS
K1_ZS:
    v_mbcnt_lo_u32_b32 v3, -1, 0
    v_mbcnt_hi_u32_b32 v3, -1, v3
    v_min_u32 v3, 23, v3
    v_lshlrev_b32 v3, 2, v3
    s_mov_b32 s33, 0
K1_ZL:
    global_load_dword v16, v3, s[18:19] sc1
    s_add_u32 s33, s33, 1
    s_waitcnt vmcnt(0)
    v_cmp_eq_u32 vcc, 0, v16
    s_cmp_lt_u32 s33, 0x20000
    s_nop 0
    s_cselect_b64 s[34:35], vcc, 0
    s_cmp_lg_u64 s[34:35], 0
    s_cbranch_scc1 K1_ZL
    s_branch K1_ZC
K1_PRE:
    s_cmp_ge_u32 s2, 248
    s_cselect_b32 s61, 5, 0
    s_sub_u32 s61, s2, s61
    s_sub_u32 s61, s61, 245
    s_waitcnt lgkmcnt(0)
    global_load_dword v17, v10, s[10:11]
    global_load_dword v18, v10, s[12:13]
    global_load_dword v19, v11, s[14:15]
    s_mov_b32 s4, s61
    s_lshl_b32 s4, s4, 2
    s_add_u32 s4, s4, s3
    s_lshl_b32 s55, s4, 2
    s_mul_i32 s4, s4, 8192
    s_add_u32 s4, s4, 25169920
    v_add_u32 v12, s4, v7
    v_mov_b32 v20, 0
    v_mov_b32 v21, 0
    v_mov_b32 v22, 0
    v_mov_b32 v23, 0
    global_store_dwordx4 v12, v[20:23], s[16:17] offset:-4096 sc1
    global_store_dwordx4 v12, v[20:23], s[16:17] offset:-3072 sc1
    global_store_dwordx4 v12, v[20:23], s[16:17] offset:-2048 sc1
    global_store_dwordx4 v12, v[20:23], s[16:17] offset:-1024 sc1
    global_store_dwordx4 v12, v[20:23], s[16:17] offset:0 sc1
    global_store_dwordx4 v12, v[20:23], s[16:17] offset:1024 sc1
    global_store_dwordx4 v12, v[20:23], s[16:17] offset:2048 sc1
    global_store_dwordx4 v12, v[20:23], s[16:17] offset:3072 sc1
    v_mov_b32 v12, s55
    s_nop 0
    v_mov_b32 v20, 1
    s_waitcnt vmcnt(0)
    s_mov_b64 exec, 1
    global_store_dword v12, v20, s[18:19] sc1
    s_mov_b64 exec, -1
    s_load_dwordx4 s[8:11], s[0:1], 32
    s_load_dwordx2 s[12:13], s[0:1], 56
    s_load_dwordx4 s[52:55], s[0:1], 64
    s_mov_b32 s4, s61
    s_lshl_b32 s4, s4, 1
    s_mul_i32 s5, s3, 393216
    s_lshl_b32 s6, s4, 15
    s_add_u32 s5, s5, s6
    s_add_u32 s5, s5, 20971520
    v_lshrrev_b32 v8, 3, v2
    v_and_b32 v9, 7, v2
    v_lshlrev_b32 v9, 4, v9
    s_lshl_b32 s7, s3, 15
    v_and_b32 v10, 3, v2
    v_lshlrev_b32 v10, 4, v10
    v_bfe_u32 v11, v2, 2, 2
    v_lshl_add_u32 v11, v4, 3, v11
    v_lshl_add_u32 v10, v11, 7, v10
    v_add_u32 v10, s7, v10
    v_and_b32 v12, 1, v8
    v_lshlrev_b32 v12, 3, v12
    v_and_b32 v13, 6, v8
    v_add_u32 v12, v12, v13
    s_mov_b32 s27, 0x00020000
    s_mov_b32 s36, s16
    s_mov_b32 s37, s17
    s_mov_b32 s38, 22544384
    s_mov_b32 s39, 0x00020000
K1_PB:
    s_waitcnt vmcnt(0)
    s_lshl_b32 s29, s3, 7
    s_mov_b32 s26, 131072
    s_mov_b32 s28, 512
    s_mov_b32 s30, 16384
    s_mov_b32 s31, 32768
    s_waitcnt lgkmcnt(0)
    s_mov_b64 s[24:25], s[12:13]
    s_cmp_eq_u32 s4, 3
    s_cbranch_scc1 K1_PGO
    s_cmp_ge_u32 s4, 8
    s_cbranch_scc1 K1_PF2B
    s_cmp_ge_u32 s4, 4
    s_cbranch_scc1 K1_PF2A
    s_cmp_eq_u32 s4, 0
    s_cbranch_scc1 K1_PWO
    s_mov_b64 s[24:25], s[10:11]
    s_mov_b32 s26, 262144
    s_mov_b32 s28, 1024
    s_mov_b32 s30, 512
    s_sub_u32 s6, s4, 1
    s_lshl_b32 s6, s6, 17
    s_add_u32 s29, s29, s6
    s_branch K1_PGO
K1_PWO:
    s_mov_b64 s[24:25], s[8:9]
    s_mov_b32 s30, 8192
    v_lshl_add_u32 v11, v12, 9, v9
    s_mov_b32 s28, 16384
    s_mov_b32 s33, 0xffffc200
    s_branch K1_PG2
K1_PF2A:
    s_mov_b64 s[24:25], s[52:53]
    s_mov_b32 s26, 524288
    s_mov_b32 s28, 2048
    s_mov_b32 s30, 65536
    s_mov_b32 s31, 131072
    s_lshl_b32 s29, s3, 9
    s_sub_u32 s6, s4, 4
    s_lshl_b32 s6, s6, 7
    s_add_u32 s29, s29, s6
    s_branch K1_PGO
K1_PF2B:
    s_mov_b64 s[24:25], s[54:55]
    s_mov_b32 s26, 524288
    s_sub_u32 s6, s4, 8
    s_lshl_b32 s6, s6, 17
    s_add_u32 s29, s29, s6
K1_PGO:
    v_mul_lo_u32 v11, v8, s28
    v_add_u32 v11, v11, v9
    s_lshl_b32 s28, s28, 3
    s_mov_b32 s33, s28
K1_PG2:
    s_mov_b32 m0, s7
    s_mov_b32 s6, s29
    buffer_load_dwordx4 v11, s[24:27], s6 offen lds
    s_add_u32 m0, m0, 1024
    s_add_u32 s6, s6, s28
    buffer_load_dwordx4 v11, s[24:27], s6 offen lds
    s_add_u32 m0, m0, 1024
    s_add_u32 s6, s6, s33
    buffer_load_dwordx4 v11, s[24:27], s6 offen lds
    s_add_u32 m0, m0, 1024
    s_add_u32 s6, s6, s28
    buffer_load_dwordx4 v11, s[24:27], s6 offen lds
    s_add_u32 m0, m0, 1024
    s_add_u32 s29, s29, s30
    s_mov_b32 s6, s29
    buffer_load_dwordx4 v11, s[24:27], s6 offen lds
    s_add_u32 m0, m0, 1024
    s_add_u32 s6, s6, s28
    buffer_load_dwordx4 v11, s[24:27], s6 offen lds
    s_add_u32 m0, m0, 1024
    s_add_u32 s6, s6, s33
    buffer_load_dwordx4 v11, s[24:27], s6 offen lds
    s_add_u32 m0, m0, 1024
    s_add_u32 s6, s6, s28
    buffer_load_dwordx4 v11, s[24:27], s6 offen lds
    s_add_u32 m0, m0, 1024
    s_sub_u32 s29, s29, s30
    s_add_u32 s29, s29, s31
    s_mov_b32 s6, s29
    buffer_load_dwordx4 v11, s[24:27], s6 offen lds
    s_add_u32 m0, m0, 1024
    s_add_u32 s6, s6, s28
    buffer_load_dwordx4 v11, s[24:27], s6 offen lds
    s_add_u32 m0, m0, 1024
    s_add_u32 s6, s6, s33
    buffer_load_dwordx4 v11, s[24:27], s6 offen lds
    s_add_u32 m0, m0, 1024
    s_add_u32 s6, s6, s28
    buffer_load_dwordx4 v11, s[24:27], s6 offen lds
    s_add_u32 m0, m0, 1024
    s_add_u32 s29, s29, s30
    s_mov_b32 s6, s29
    buffer_load_dwordx4 v11, s[24:27], s6 offen lds
    s_add_u32 m0, m0, 1024
    s_add_u32 s6, s6, s28
    buffer_load_dwordx4 v11, s[24:27], s6 offen lds
    s_add_u32 m0, m0, 1024
    s_add_u32 s6, s6, s33
    buffer_load_dwordx4 v11, s[24:27], s6 offen lds
    s_add_u32 m0, m0, 1024
    s_add_u32 s6, s6, s28
    buffer_load_dwordx4 v11, s[24:27], s6 offen lds
    s_add_u32 m0, m0, 1024
    s_sub_u32 s29, s29, s30
    s_add_u32 s29, s29, s31
    s_mov_b32 s6, s29
    buffer_load_dwordx4 v11, s[24:27], s6 offen lds
    s_add_u32 m0, m0, 1024
    s_add_u32 s6, s6, s28
    buffer_load_dwordx4 v11, s[24:27], s6 offen lds
    s_add_u32 m0, m0, 1024
    s_add_u32 s6, s6, s33
    buffer_load_dwordx4 v11, s[24:27], s6 offen lds
    s_add_u32 m0, m0, 1024
    s_add_u32 s6, s6, s28
    buffer_load_dwordx4 v11, s[24:27], s6 offen lds
    s_add_u32 m0, m0, 1024
    s_add_u32 s29, s29, s30
    s_mov_b32 s6, s29
    buffer_load_dwordx4 v11, s[24:27], s6 offen lds
    s_add_u32 m0, m0, 1024
    s_add_u32 s6, s6, s28
    buffer_load_dwordx4 v11, s[24:27], s6 offen lds
    s_add_u32 m0, m0, 1024
    s_add_u32 s6, s6, s33
    buffer_load_dwordx4 v11, s[24:27], s6 offen lds
    s_add_u32 m0, m0, 1024
    s_add_u32 s6, s6, s28
    buffer_load_dwordx4 v11, s[24:27], s6 offen lds
    s_add_u32 m0, m0, 1024
    s_sub_u32 s29, s29, s30
    s_add_u32 s29, s29, s31
    s_mov_b32 s6, s29
    buffer_load_dwordx4 v11, s[24:27], s6 offen lds
    s_add_u32 m0, m0, 1024
    s_add_u32 s6, s6, s28
    buffer_load_dwordx4 v11, s[24:27], s6 offen lds
    s_add_u32 m0, m0, 1024
    s_add_u32 s6, s6, s33
    buffer_load_dwordx4 v11, s[24:27], s6 offen lds
    s_add_u32 m0, m0, 1024
    s_add_u32 s6, s6, s28
    buffer_load_dwordx4 v11, s[24:27], s6 offen lds
    s_add_u32 m0, m0, 1024
    s_add_u32 s29, s29, s30
    s_mov_b32 s6, s29
    buffer_load_dwordx4 v11, s[24:27], s6 offen lds
    s_add_u32 m0, m0, 1024
    s_add_u32 s6, s6, s28
    buffer_load_dwordx4 v11, s[24:27], s6 offen lds
    s_add_u32 m0, m0, 1024
    s_add_u32 s6, s6, s33
    buffer_load_dwordx4 v11, s[24:27], s6 offen lds
    s_add_u32 m0, m0, 1024
    s_add_u32 s6, s6, s28
    buffer_load_dwordx4 v11, s[24:27], s6 offen lds
    s_add_u32 m0, m0, 1024
    s_sub_u32 s29, s29, s30
    s_add_u32 s29, s29, s31
    s_waitcnt vmcnt(28)
    ds_read_b64_tr_b16 v[16:17], v10 offset:0
    ds_read_b64_tr_b16 v[18:19], v10 offset:512
    ds_read_b64_tr_b16 v[20:21], v10 offset:8
    ds_read_b64_tr_b16 v[22:23], v10 offset:520
    ds_read_b64_tr_b16 v[24:25], v10 offset:64
    ds_read_b64_tr_b16 v[26:27], v10 offset:576
    ds_read_b64_tr_b16 v[28:29], v10 offset:72
    ds_read_b64_tr_b16 v[30:31], v10 offset:584
    s_waitcnt lgkmcnt(6)
    buffer_store_dwordx4 v[16:19], v7, s[36:39], s5 offen offset:0 sc1
    s_waitcnt lgkmcnt(4)
    buffer_store_dwordx4 v[20:23], v7, s[36:39], s5 offen offset:1024 sc1
    s_waitcnt lgkmcnt(2)
    buffer_store_dwordx4 v[24:27], v7, s[36:39], s5 offen offset:2048 sc1
    s_waitcnt lgkmcnt(0)
    buffer_store_dwordx4 v[28:31], v7, s[36:39], s5 offen offset:3072 sc1
    s_add_u32 s5, s5, 4096
    s_waitcnt vmcnt(28)
    ds_read_b64_tr_b16 v[32:33], v10 offset:4096
    ds_read_b64_tr_b16 v[34:35], v10 offset:4608
    ds_read_b64_tr_b16 v[36:37], v10 offset:4104
    ds_read_b64_tr_b16 v[38:39], v10 offset:4616
    ds_read_b64_tr_b16 v[40:41], v10 offset:4160
    ds_read_b64_tr_b16 v[42:43], v10 offset:4672
    ds_read_b64_tr_b16 v[44:45], v10 offset:4168
    ds_read_b64_tr_b16 v[46:47], v10 offset:4680
    s_waitcnt lgkmcnt(6)
    buffer_store_dwordx4 v[32:35], v7, s[36:39], s5 offen offset:0 sc1
    s_waitcnt lgkmcnt(4)
    buffer_store_dwordx4 v[36:39], v7, s[36:39], s5 offen offset:1024 sc1
    s_waitcnt lgkmcnt(2)
    buffer_store_dwordx4 v[40:43], v7, s[36:39], s5 offen offset:2048 sc1
    s_waitcnt lgkmcnt(0)
    buffer_store_dwordx4 v[44:47], v7, s[36:39], s5 offen offset:3072 sc1
    s_add_u32 s5, s5, 4096
    s_waitcnt vmcnt(28)
    ds_read_b64_tr_b16 v[16:17], v10 offset:8192
    ds_read_b64_tr_b16 v[18:19], v10 offset:8704
    ds_read_b64_tr_b16 v[20:21], v10 offset:8200
    ds_read_b64_tr_b16 v[22:23], v10 offset:8712
    ds_read_b64_tr_b16 v[24:25], v10 offset:8256
    ds_read_b64_tr_b16 v[26:27], v10 offset:8768
    ds_read_b64_tr_b16 v[28:29], v10 offset:8264
    ds_read_b64_tr_b16 v[30:31], v10 offset:8776
    s_waitcnt lgkmcnt(6)
    buffer_store_dwordx4 v[16:19], v7, s[36:39], s5 offen offset:0 sc1
    s_waitcnt lgkmcnt(4)
    buffer_store_dwordx4 v[20:23], v7, s[36:39], s5 offen offset:1024 sc1
    s_waitcnt lgkmcnt(2)
    buffer_store_dwordx4 v[24:27], v7, s[36:39], s5 offen offset:2048 sc1
    s_waitcnt lgkmcnt(0)
    buffer_store_dwordx4 v[28:31], v7, s[36:39], s5 offen offset:3072 sc1
    s_add_u32 s5, s5, 4096
    s_waitcnt vmcnt(28)
    ds_read_b64_tr_b16 v[32:33], v10 offset:12288
    ds_read_b64_tr_b16 v[34:35], v10 offset:12800
    ds_read_b64_tr_b16 v[36:37], v10 offset:12296
    ds_read_b64_tr_b16 v[38:39], v10 offset:12808
    ds_read_b64_tr_b16 v[40:41], v10 offset:12352
    ds_read_b64_tr_b16 v[42:43], v10 offset:12864
    ds_read_b64_tr_b16 v[44:45], v10 offset:12360
    ds_read_b64_tr_b16 v[46:47], v10 offset:12872
    s_waitcnt lgkmcnt(6)
    buffer_store_dwordx4 v[32:35], v7, s[36:39], s5 offen offset:0 sc1
    s_waitcnt lgkmcnt(4)
    buffer_store_dwordx4 v[36:39], v7, s[36:39], s5 offen offset:1024 sc1
    s_waitcnt lgkmcnt(2)
    buffer_store_dwordx4 v[40:43], v7, s[36:39], s5 offen offset:2048 sc1
    s_waitcnt lgkmcnt(0)
    buffer_store_dwordx4 v[44:47], v7, s[36:39], s5 offen offset:3072 sc1
    s_add_u32 s5, s5, 4096
    s_waitcnt vmcnt(28)
    ds_read_b64_tr_b16 v[16:17], v10 offset:16384
    ds_read_b64_tr_b16 v[18:19], v10 offset:16896
    ds_read_b64_tr_b16 v[20:21], v10 offset:16392
    ds_read_b64_tr_b16 v[22:23], v10 offset:16904
    ds_read_b64_tr_b16 v[24:25], v10 offset:16448
    ds_read_b64_tr_b16 v[26:27], v10 offset:16960
    ds_read_b64_tr_b16 v[28:29], v10 offset:16456
    ds_read_b64_tr_b16 v[30:31], v10 offset:16968
    s_waitcnt lgkmcnt(6)
    buffer_store_dwordx4 v[16:19], v7, s[36:39], s5 offen offset:0 sc1
    s_waitcnt lgkmcnt(4)
    buffer_store_dwordx4 v[20:23], v7, s[36:39], s5 offen offset:1024 sc1
    s_waitcnt lgkmcnt(2)
    buffer_store_dwordx4 v[24:27], v7, s[36:39], s5 offen offset:2048 sc1
    s_waitcnt lgkmcnt(0)
    buffer_store_dwordx4 v[28:31], v7, s[36:39], s5 offen offset:3072 sc1
    s_add_u32 s5, s5, 4096
    s_waitcnt vmcnt(28)
    ds_read_b64_tr_b16 v[32:33], v10 offset:20480
    ds_read_b64_tr_b16 v[34:35], v10 offset:20992
    ds_read_b64_tr_b16 v[36:37], v10 offset:20488
    ds_read_b64_tr_b16 v[38:39], v10 offset:21000
    ds_read_b64_tr_b16 v[40:41], v10 offset:20544
    ds_read_b64_tr_b16 v[42:43], v10 offset:21056
    ds_read_b64_tr_b16 v[44:45], v10 offset:20552
    ds_read_b64_tr_b16 v[46:47], v10 offset:21064
    s_waitcnt lgkmcnt(6)
    buffer_store_dwordx4 v[32:35], v7, s[36:39], s5 offen offset:0 sc1
    s_waitcnt lgkmcnt(4)
    buffer_store_dwordx4 v[36:39], v7, s[36:39], s5 offen offset:1024 sc1
    s_waitcnt lgkmcnt(2)
    buffer_store_dwordx4 v[40:43], v7, s[36:39], s5 offen offset:2048 sc1
    s_waitcnt lgkmcnt(0)
    buffer_store_dwordx4 v[44:47], v7, s[36:39], s5 offen offset:3072 sc1
    s_add_u32 s5, s5, 4096
    s_waitcnt vmcnt(28)
    ds_read_b64_tr_b16 v[16:17], v10 offset:24576
    ds_read_b64_tr_b16 v[18:19], v10 offset:25088
    ds_read_b64_tr_b16 v[20:21], v10 offset:24584
    ds_read_b64_tr_b16 v[22:23], v10 offset:25096
    ds_read_b64_tr_b16 v[24:25], v10 offset:24640
    ds_read_b64_tr_b16 v[26:27], v10 offset:25152
    ds_read_b64_tr_b16 v[28:29], v10 offset:24648
    ds_read_b64_tr_b16 v[30:31], v10 offset:25160
    s_waitcnt lgkmcnt(6)
    buffer_store_dwordx4 v[16:19], v7, s[36:39], s5 offen offset:0 sc1
    s_waitcnt lgkmcnt(4)
    buffer_store_dwordx4 v[20:23], v7, s[36:39], s5 offen offset:1024 sc1
    s_waitcnt lgkmcnt(2)
    buffer_store_dwordx4 v[24:27], v7, s[36:39], s5 offen offset:2048 sc1
    s_waitcnt lgkmcnt(0)
    buffer_store_dwordx4 v[28:31], v7, s[36:39], s5 offen offset:3072 sc1
    s_add_u32 s5, s5, 4096
    s_waitcnt vmcnt(28)
    ds_read_b64_tr_b16 v[32:33], v10 offset:28672
    ds_read_b64_tr_b16 v[34:35], v10 offset:29184
    ds_read_b64_tr_b16 v[36:37], v10 offset:28680
    ds_read_b64_tr_b16 v[38:39], v10 offset:29192
    ds_read_b64_tr_b16 v[40:41], v10 offset:28736
    ds_read_b64_tr_b16 v[42:43], v10 offset:29248
    ds_read_b64_tr_b16 v[44:45], v10 offset:28744
    ds_read_b64_tr_b16 v[46:47], v10 offset:29256
    s_waitcnt lgkmcnt(6)
    buffer_store_dwordx4 v[32:35], v7, s[36:39], s5 offen offset:0 sc1
    s_waitcnt lgkmcnt(4)
    buffer_store_dwordx4 v[36:39], v7, s[36:39], s5 offen offset:1024 sc1
    s_waitcnt lgkmcnt(2)
    buffer_store_dwordx4 v[40:43], v7, s[36:39], s5 offen offset:2048 sc1
    s_waitcnt lgkmcnt(0)
    buffer_store_dwordx4 v[44:47], v7, s[36:39], s5 offen offset:3072 sc1
    s_add_u32 s5, s5, 4096
    s_add_u32 s4, s4, 1
    s_bitcmp1_b32 s4, 0
    s_cbranch_scc1 K1_PB
    s_mov_b32 s4, s61
    s_lshl_b32 s5, s3, 3
    s_add_u32 s4, s4, s5
    s_lshl_b32 s4, s4, 2
    s_add_u32 s4, s4, 25357824
    v_and_b32 v12, 31, v2
    v_lshl_add_u32 v12, v12, 7, s4
    v_mov_b32 v20, 1
    v_min_u32 v1, 23, v2
    v_lshlrev_b32 v1, 2, v1
    s_lshl_b32 s4, s2, 7
    s_add_u32 s4, s4, 25133056
    v_mov_b32 v13, s4
    v_accvgpr_write_b32 a196, v13
    s_mov_b32 s33, 0
K1_PZ:
    global_load_dword v11, v1, s[18:19] sc1
    s_add_u32 s33, s33, 1
    s_waitcnt vmcnt(0)
    v_cmp_eq_u32 vcc, 0, v11
    s_cmp_lt_u32 s33, 0x20000
    s_nop 0
    s_cselect_b64 s[34:35], vcc, 0
    s_cmp_lg_u64 s[34:35], 0
    s_cbranch_scc1 K1_PZ
    s_waitcnt vmcnt(0)
    global_store_dword v12, v20, s[16:17] sc1
    s_branch K2_START
K1_END:
    s_endpgm
ZF_END:
.section .rodata,"a"
.p2align 6
.amdhsa_kernel zf_k1_kernel
  .amdhsa_next_free_vgpr 512
  .amdhsa_next_free_sgpr 102
  .amdhsa_accum_offset 256
  .amdhsa_group_segment_fixed_size 0
  .amdhsa_kernarg_size 104
  .amdhsa_user_sgpr_count 2
  .amdhsa_user_sgpr_kernarg_segment_ptr 1
  .amdhsa_system_sgpr_workgroup_id_x 1
.end_amdhsa_kernel
```
